```python
import torch

def _softmax(x, axis=-1):
    return torch.softmax(x, dim=axis)
def _gelu(x):
    return torch.nn.functional.gelu(x, approximate="tanh")
def _silu(x):
    return torch.nn.functional.silu(x)
def _sigmoid(x):
    return torch.sigmoid(x)
def _layernorm(x, axis=-1, eps=1e-5):
    m = x.mean(dim=axis, keepdim=True)
    v = x.var(dim=axis, keepdim=True, unbiased=False)
    return (x - m) / torch.sqrt(v + eps)
def _scatter_add(tgt, idx, src, axis=0):
    return tgt.clone().index_add_(axis, idx, src)
def _segment_sum(src, seg, n):
    out = torch.zeros((n,) + src.shape[1:], dtype=src.dtype)
    return out.index_add_(0, seg, src)
def _pad(x, pw):
    flat = tuple(v for pair in reversed(pw) for v in pair)
    return torch.nn.functional.pad(x, flat)

kernel_name = 'interleave_layers__linear_kernel_hedgehog__glu_gated_swiglu__prompt'

def setup_inputs():

    _w = (lambda a: (lambda t: t.to(torch.bfloat16) if t.is_floating_point() else t)(torch.as_tensor(a)))
    def _A_setup():
        B, S, D, H = 1, 2048, 512, 32
        Dh = D // H
        return {
            "x": _w((lambda *s: torch.randn(*s, dtype=torch.bfloat16) * 0.05)(B, S, D)),
            "wqkv": _w((lambda *s: torch.randn(*s, dtype=torch.bfloat16) * 0.4)(D, 3 * D)),
            "w_phi": _w((lambda *s: torch.randn(*s, dtype=torch.bfloat16) * 0.4)(H, Dh, Dh) * (Dh ** -0.5)),
            "wo": _w((lambda *s: torch.randn(*s, dtype=torch.bfloat16) * 0.05)(D, D)),
        }
    _A_in = _A_setup()

    def _B_setup():
        B, S, D, F = 1, 2048, 512, 1792
        return {
            "x": _w((lambda *s: torch.randn(*s, dtype=torch.bfloat16) * 0.05)(B, S, D)),
            "w1": _w((lambda *s: torch.randn(*s, dtype=torch.bfloat16) * 0.8)(D, F) * (2.0 / D) ** 0.5),
            "w3": _w((lambda *s: torch.randn(*s, dtype=torch.bfloat16) * 0.8)(D, F) * (2.0 / D) ** 0.5),
            "w2": _w((lambda *s: torch.randn(*s, dtype=torch.bfloat16) * 0.8)(F, D) * (2.0 / F) ** 0.5),
        }
    _B_in = _B_setup()

    return {
        "A_x": _A_in["x"],
        "A_wqkv": _A_in["wqkv"],
        "A_w_phi": _A_in["w_phi"],
        "A_wo": _A_in["wo"],
        "B_x": _B_in["x"],
        "B_w1": _B_in["w1"],
        "B_w3": _B_in["w3"],
        "B_w2": _B_in["w2"],
    }

def reference(A_x, A_wqkv, A_w_phi, A_wo, B_x, B_w1, B_w3, B_w2):
    def _A_ref(x, wqkv, w_phi, wo):
        B, S, D = x.shape
        H = 32; Dh = D // H
        qkv = (lambda x, *d: x.permute(*d))((x @ wqkv).reshape(B, S, 3, H, Dh), 2, 0, 3, 1, 4)
        q, k, v = qkv[0], qkv[1], qkv[2]
        pq = torch.einsum("bhsd,hdf->bhsf", q, w_phi)
        pk = torch.einsum("bhsd,hdf->bhsf", k, w_phi)
        phi_q = torch.concatenate([_softmax(pq, axis=-1), _softmax(-pq, axis=-1)], axis=-1)
        phi_k = torch.concatenate([_softmax(pk, axis=-1), _softmax(-pk, axis=-1)], axis=-1)
        kv = torch.einsum("bhsf,bhsd->bhfd", phi_k, v)
        z  = torch.einsum("bhsf->bhf", phi_k)
        num = torch.einsum("bhqf,bhfd->bhqd", phi_q, kv)
        den = torch.einsum("bhqf,bhf->bhq", phi_q, z)[..., None] + 1e-6
        o = num / den
        return (lambda x, *d: x.permute(*d))(o, 0, 2, 1, 3).reshape(B, S, D) @ wo

    def _B_ref(x, w1, w3, w2):
        gate = torch.einsum("bsd,df->bsf", x, w1)
        up = torch.einsum("bsd,df->bsf", x, w3)
        h = _silu(gate) * up
        out = torch.einsum("bsf,fd->bsd", h, w2)
        return out

    x = A_x
    x = x + _A_ref(_layernorm(x, axis=-1), A_wqkv, A_w_phi, A_wo)
    x = x + _B_ref(_layernorm(x, axis=-1), B_w1, B_w3, B_w2)
    x = x + _A_ref(_layernorm(x, axis=-1), A_wqkv, A_w_phi, A_wo)
    x = x + _B_ref(_layernorm(x, axis=-1), B_w1, B_w3, B_w2)
    return x
```

```asm
; @launch grid=(256,1,1) block=(256,1,1) lds=163840
.amdgcn_target "amdgcn-amd-amdhsa--gfx950"
.text
.globl interleave_layers__linear_kernel_hedgehog__glu_gated_swiglu__prompt_kernel
.p2align 8
.type interleave_layers__linear_kernel_hedgehog__glu_gated_swiglu__prompt_kernel,@function
interleave_layers__linear_kernel_hedgehog__glu_gated_swiglu__prompt_kernel:
L_code_start:
    s_cmp_ge_u32 s2, 256
    s_cbranch_scc1 L_end
    s_load_dwordx16 s[76:91], s[0:1], 0
    s_load_dwordx4 s[92:95], s[0:1], 64
    s_load_dwordx2 s[96:97], s[0:1], 80
    v_and_b32 v1, 63, v0
    v_and_b32 v2, 31, v0
    v_bfe_u32 v3, v0, 5, 1
    v_lshlrev_b32 v4, 4, v1
    v_lshrrev_b32 v23, 6, v0
    s_nop 0
    v_readfirstlane_b32 s44, v23
    s_getpc_b64 s[6:7]
L_pc:
    s_sub_u32 s6, s6, L_pc-L_code_start
    s_subb_u32 s7, s7, 0
    v_lshlrev_b32 v23, 7, v0
    s_mov_b32 s3, L_code_end-L_code_start-256
    v_cmp_gt_u32 vcc, s3, v23
    s_nop 1
    s_and_saveexec_b64 s[58:59], vcc
    s_cbranch_execz NOPRE_1
    global_load_dword v244, v23, s[6:7]
NOPRE_1:
    s_mov_b64 exec, s[58:59]
    v_add_u32 v23, 0x8000, v23
    v_cmp_gt_u32 vcc, s3, v23
    s_nop 1
    s_and_saveexec_b64 s[58:59], vcc
    s_cbranch_execz NOPRE_2
    global_load_dword v245, v23, s[6:7]
NOPRE_2:
    s_mov_b64 exec, s[58:59]
    v_add_u32 v23, 0x8000, v23
    v_cmp_gt_u32 vcc, s3, v23
    s_nop 1
    s_and_saveexec_b64 s[58:59], vcc
    s_cbranch_execz NOPRE_3
    global_load_dword v246, v23, s[6:7]
NOPRE_3:
    s_mov_b64 exec, s[58:59]
    s_and_b32 s6, s2, 7
    s_lshr_b32 s7, s2, 3
    s_lshr_b32 s45, s6, 2
    s_lshl_b32 s45, s45, 3
    s_and_b32 s3, s7, 7
    s_add_u32 s45, s45, s3
    s_and_b32 s46, s6, 3
    s_lshl_b32 s46, s46, 2
    s_lshr_b32 s3, s7, 3
    s_add_u32 s46, s46, s3
    s_lshr_b32 s47, s6, 0
    s_lshl_b32 s47, s47, 2
    s_and_b32 s3, s7, 3
    s_add_u32 s47, s47, s3
    s_and_b32 s48, s6, 0
    s_lshl_b32 s48, s48, 3
    s_lshr_b32 s3, s7, 2
    s_add_u32 s48, s48, s3
    s_lshl_b32 s62, s44, 13
    s_lshl_b32 s61, s46, 6
    s_mul_i32 s3, s44, 393216
    s_add_u32 s61, s61, s3
    s_lshl_b32 s71, s45, 2
    s_add_u32 s71, s71, s44
    v_lshrrev_b32 v23, 2, v1
    v_mul_u32_u24 v23, 3072, v23
    v_and_b32 v97, 3, v0
    v_lshl_add_u32 v5, v97, 4, v23
    v_lshrrev_b32 v26, 4, v1
    v_and_b32 v27, 15, v1
    v_lshlrev_b32 v28, 10, v26
    v_lshl_add_u32 v28, v27, 4, v28
    v_lshrrev_b32 v99, 3, v1
    v_and_b32 v100, 7, v1
    v_bfe_u32 v101, v1, 4, 1
    v_lshlrev_b32 v101, 2, v101
    v_xor_b32 v100, v100, v101
    v_mul_u32_u24 v102, 3584, v99
    v_lshl_add_u32 v103, v100, 4, v102
    s_mov_b32 s50, 0x3fb8aa3b
    s_mov_b32 s51, 0x3b000000
    s_mov_b32 s52, 0x3727c5ac
    s_mov_b32 s53, 0x358637bd
    s_mov_b32 s54, -1
    s_mov_b32 s55, 0
    s_mov_b32 s56, 0xffff
    s_mov_b32 s57, 0xffff
    s_lshl_b32 s63, s44, 17
    s_lshl_b32 s3, s48, 7
    s_add_u32 s63, s63, s3
    s_and_b32 s4, s44, 1
    s_mul_i32 s65, s4, 229376
    s_lshl_b32 s66, s46, 1
    s_lshr_b32 s5, s44, 1
    s_add_u32 s66, s66, s5
    s_mul_i32 s66, s66, 49152
    s_mul_i32 s5, s4, 6144
    s_add_u32 s66, s66, s5
    s_add_u32 s66, s66, 33554432
    s_lshl_b32 s5, s46, 7
    s_add_u32 s65, s65, s5
    s_mul_i32 s67, s4, 6144
    s_cmp_lt_u32 s44, 2
    s_cselect_b32 s5, 0, 12416
    s_add_u32 s67, s67, s5
    s_lshr_b32 s74, s44, 1
    s_lshl_b32 s68, s4, 19
    s_lshl_b32 s75, s74, 16
    s_add_u32 s68, s68, s75
    s_add_u32 s68, s68, s3
    s_mul_i32 s49, s4, 393216
    s_add_u32 s49, s49, s3
    s_add_u32 s49, s49, 1048576
    s_lshl_b32 s5, s74, 17
    s_add_u32 s69, s49, s5
    s_add_u32 s69, s69, 131072
    s_add_u32 s49, s49, s75
    s_lshl_b32 s70, s2, 2
    s_add_u32 s70, s70, s44
    s_lshl_b32 s70, s70, 7
    s_lshr_b32 s72, s44, 1
    s_lshl_b32 s5, s47, 1
    s_add_u32 s72, s72, s5
    s_lshl_b32 s73, s48, 1
    s_add_u32 s73, s73, s4
    v_bfe_u32 v96, v0, 2, 2
    v_bfe_u32 v98, v0, 4, 1
    v_lshlrev_b32 v23, 10, v99
    v_lshl_add_u32 v6, v100, 4, v23
    s_lshr_b32 s5, s44, 1
    s_lshl_b32 s5, s5, 1
    v_xor_b32 v104, s5, v100
    v_lshl_add_u32 v7, v104, 4, v102
    v_add_u32 v23, 0, v1
    v_mul_u32_u24 v24, 0x2aab, v23
    v_lshrrev_b32 v24, 16, v24
    v_mul_u32_u24 v25, 6, v24
    v_sub_u32 v25, v23, v25
    v_mul_u32_u24 v24, 3584, v24
    v_lshl_add_u32 v9, v25, 4, v24
    v_add_u32 v23, 64, v1
    v_mul_u32_u24 v24, 0x2aab, v23
    v_lshrrev_b32 v24, 16, v24
    v_mul_u32_u24 v25, 6, v24
    v_sub_u32 v25, v23, v25
    v_mul_u32_u24 v24, 3584, v24
    v_lshl_add_u32 v10, v25, 4, v24
    v_subrev_u32 v10, 1024, v10
    v_add_u32 v23, 128, v1
    v_mul_u32_u24 v24, 0x2aab, v23
    v_lshrrev_b32 v24, 16, v24
    v_mul_u32_u24 v25, 6, v24
    v_sub_u32 v25, v23, v25
    v_mul_u32_u24 v24, 3584, v24
    v_lshl_add_u32 v11, v25, 4, v24
    v_subrev_u32 v11, 2048, v11
    v_lshlrev_b32 v105, 3, v97
    v_lshl_add_u32 v105, v98, 5, v105
    v_lshl_add_u32 v106, v3, 2, v96
    v_lshl_add_u32 v12, v106, 6, v105
    v_add_u32 v13, 65536, v12
    v_lshrrev_b32 v107, 1, v96
    v_lshl_add_u32 v108, v106, 7, v105
    v_xor_b32 v109, s4, v107
    v_lshl_add_u32 v14, v109, 6, v108
    v_xor_b32 v109, 1, v109
    v_lshl_add_u32 v15, v109, 6, v108
    v_lshlrev_b32 v108, 7, v106
    v_lshl_add_u32 v108, v98, 14, v108
    v_lshl_add_u32 v108, v97, 3, v108
    v_lshlrev_b32 v109, 1, v107
    v_xor_b32 v109, v109, v98
    v_xor_b32 v110, 0, v109
    v_lshl_add_u32 v16, v110, 5, v108
    v_xor_b32 v110, 1, v109
    v_lshl_add_u32 v17, v110, 5, v108
    v_xor_b32 v110, 2, v109
    v_lshl_add_u32 v18, v110, 5, v108
    v_xor_b32 v110, 3, v109
    v_lshl_add_u32 v19, v110, 5, v108
    v_mul_u32_u24 v108, 12416, v98
    v_mul_u32_u24 v109, 96, v106
    v_add_u32 v108, v108, v109
    v_lshl_add_u32 v20, v97, 3, v108
    v_mul_u32_u24 v108, 0x788, v0
    v_lshrrev_b32 v108, 16, v108
    v_mul_u32_u24 v109, 34, v108
    v_sub_u32 v109, v0, v109
    v_lshrrev_b32 v110, 1, v108
    v_mul_u32_u24 v110, 34, v110
    v_add_u32 v110, v110, v109
    v_and_b32 v108, 1, v108
    v_lshlrev_b32 v108, 3, v108
    v_lshl_add_u32 v108, v110, 4, v108
    v_add_u32 v108, 32768, v108
    v_accvgpr_write_b32 a239, v108
    v_min_u32 v108, 16, v2
    v_mul_u32_u24 v109, 17, v3
    v_add_u32 v108, v108, v109
    v_lshlrev_b32 v108, 4, v108
    v_add_u32 v108, 32768, v108
    v_accvgpr_write_b32 a237, v108
    v_mov_b32 v109, s46
    v_lshrrev_b32 v8, 3, v1
    v_lshlrev_b32 v8, 2, v8
    v_lshrrev_b32 v110, 2, v109
    v_add_u32 v8, v8, v110
    v_and_b32 v110, 3, v109
    v_lshlrev_b32 v110, 3, v110
    v_and_b32 v111, 7, v1
    v_add_u32 v110, v110, v111
    v_lshl_add_u32 v8, v110, 3, v8
    v_lshlrev_b32 v8, 9, v8
    s_lshr_b32 s5, s71, 1
    v_mov_b32 v108, s5
    v_lshrrev_b32 v109, 2, v108
    v_lshlrev_b32 v109, 0, v109
    v_lshrrev_b32 v110, 3, v1
    v_add_u32 v109, v109, v110
    v_and_b32 v110, 7, v1
    v_lshlrev_b32 v110, 2, v110
    v_and_b32 v111, 3, v108
    v_add_u32 v110, v110, v111
    v_lshl_add_u32 v109, v110, 3, v109
    s_and_b32 s5, s71, 1
    s_lshl_b32 s5, s5, 1
    s_lshr_b32 s4, s46, 3
    s_add_u32 s5, s5, s4
    v_lshlrev_b32 v109, 2, v109
    v_add_u32 v109, s5, v109
    v_lshlrev_b32 v109, 7, v109
    v_accvgpr_write_b32 a235, v109
    s_lshr_b32 s5, s72, 2
    v_mov_b32 v108, s5
    v_lshrrev_b32 v109, 3, v108
    v_lshlrev_b32 v109, 2, v109
    v_lshrrev_b32 v110, 2, v1
    v_add_u32 v109, v109, v110
    v_and_b32 v110, 3, v1
    v_lshlrev_b32 v110, 3, v110
    v_and_b32 v111, 7, v108
    v_add_u32 v110, v110, v111
    v_lshl_add_u32 v109, v110, 3, v109
    s_and_b32 s5, s72, 3
    v_lshlrev_b32 v109, 2, v109
    v_add_u32 v109, s5, v109
    v_lshlrev_b32 v109, 7, v109
    v_accvgpr_write_b32 a234, v109
    s_waitcnt lgkmcnt(0)
    s_mov_b32 s32, s96
    s_and_b32 s33, s97, 0xffff
    s_mov_b32 s34, 35651584
    s_mov_b32 s35, 0x00020000
    s_mov_b32 s36, s94
    s_and_b32 s37, s95, 0xffff
    s_mov_b32 s38, 256
    s_mov_b32 s39, 0x00020000
    s_cmp_ge_u32 s2, 16
    s_cbranch_scc1 NOZERO_4
    v_mov_b32 v108, 0
    v_mov_b32 v109, 0
    v_mov_b32 v110, 0
    v_mov_b32 v111, 0
    v_lshlrev_b32 v23, 4, v0
    s_lshl_b32 s3, s2, 13
    buffer_store_dwordx4 v[108:111], v23, s[32:35], s3 offen sc1
    s_add_u32 s3, s3, 4096
    buffer_store_dwordx4 v[108:111], v23, s[32:35], s3 offen sc1
NOZERO_4:
    s_mov_b32 s12, s78
    s_and_b32 s13, s79, 0xffff
    s_mov_b32 s14, 1572864
    s_mov_b32 s15, 0x00020000
    s_mov_b32 s8, s76
    s_and_b32 s9, s77, 0xffff
    s_mov_b32 s10, 2097152
    s_mov_b32 s11, 0x00020000
    s_lshl_b32 s96, s71, 15
    s_lshl_b32 s64, s44, 14
    s_add_u32 s64, s64, 98304
    v_add_u32 v120, 0, v26
    v_xor_b32 v120, v120, v27
    v_lshlrev_b32 v120, 4, v120
    v_lshl_add_u32 v120, v26, 10, v120
    v_add_u32 v121, 4, v26
    v_xor_b32 v121, v121, v27
    v_lshlrev_b32 v121, 4, v121
    v_lshl_add_u32 v121, v26, 10, v121
    v_add_u32 v122, 8, v26
    v_xor_b32 v122, v122, v27
    v_lshlrev_b32 v122, 4, v122
    v_lshl_add_u32 v122, v26, 10, v122
    v_add_u32 v123, 12, v26
    v_xor_b32 v123, v123, v27
    v_lshlrev_b32 v123, 4, v123
    v_lshl_add_u32 v123, v26, 10, v123
    s_add_u32 s99, s96, 0
    s_add_u32 m0, s64, 0
    s_nop 0
    buffer_load_dwordx4 v120, s[8:11], s99 offen lds
    s_add_u32 s99, s96, 4096
    s_add_u32 m0, s64, 1024
    s_nop 0
    buffer_load_dwordx4 v121, s[8:11], s99 offen lds
    s_add_u32 s99, s96, 8192
    s_add_u32 m0, s64, 2048
    s_nop 0
    buffer_load_dwordx4 v122, s[8:11], s99 offen lds
    s_add_u32 s99, s96, 12288
    s_add_u32 m0, s64, 3072
    s_nop 0
    buffer_load_dwordx4 v123, s[8:11], s99 offen lds
    s_add_u32 s99, s96, 16384
    s_add_u32 m0, s64, 4096
    s_nop 0
    buffer_load_dwordx4 v120, s[8:11], s99 offen lds
    s_add_u32 s99, s96, 20480
    s_add_u32 m0, s64, 5120
    s_nop 0
    buffer_load_dwordx4 v121, s[8:11], s99 offen lds
    s_add_u32 s99, s96, 24576
    s_add_u32 m0, s64, 6144
    s_nop 0
    buffer_load_dwordx4 v122, s[8:11], s99 offen lds
    s_add_u32 s99, s96, 28672
    s_add_u32 m0, s64, 7168
    s_nop 0
    buffer_load_dwordx4 v123, s[8:11], s99 offen lds
    s_add_u32 s99, s61, 1024
    s_add_u32 m0, s62, 0
    s_nop 0
    buffer_load_dwordx4 v5, s[12:15], s99 offen lds
    s_add_u32 s99, s61, 50176
    s_add_u32 m0, s62, 1024
    s_nop 0
    buffer_load_dwordx4 v5, s[12:15], s99 offen lds
    s_add_u32 s99, s61, 99328
    s_add_u32 m0, s62, 2048
    s_nop 0
    buffer_load_dwordx4 v5, s[12:15], s99 offen lds
    s_add_u32 s99, s61, 148480
    s_add_u32 m0, s62, 3072
    s_nop 0
    buffer_load_dwordx4 v5, s[12:15], s99 offen lds
    s_add_u32 s99, s61, 197632
    s_add_u32 m0, s62, 4096
    s_nop 0
    buffer_load_dwordx4 v5, s[12:15], s99 offen lds
    s_add_u32 s99, s61, 246784
    s_add_u32 m0, s62, 5120
    s_nop 0
    buffer_load_dwordx4 v5, s[12:15], s99 offen lds
    s_add_u32 s99, s61, 295936
    s_add_u32 m0, s62, 6144
    s_nop 0
    buffer_load_dwordx4 v5, s[12:15], s99 offen lds
    s_add_u32 s99, s61, 345088
    s_add_u32 m0, s62, 7168
    s_nop 0
    buffer_load_dwordx4 v5, s[12:15], s99 offen lds
    s_cmp_ge_u32 s2, 16
    s_cbranch_scc1 NOZ2_5
    s_waitcnt vmcnt(16)
    s_mov_b64 s[58:59], exec
    s_mov_b64 exec, 1
    v_mov_b32 v23, 0
    v_mov_b32 v24, 1
    buffer_atomic_add v24, v23, s[36:39], 0 offen sc1
    s_mov_b64 exec, s[58:59]
NOZ2_5:
    s_add_u32 s99, s61, 2048
    s_add_u32 m0, s62, 32768
    s_nop 0
    buffer_load_dwordx4 v5, s[12:15], s99 offen lds
    s_add_u32 s99, s61, 51200
    s_add_u32 m0, s62, 33792
    s_nop 0
    buffer_load_dwordx4 v5, s[12:15], s99 offen lds
    s_add_u32 s99, s61, 100352
    s_add_u32 m0, s62, 34816
    s_nop 0
    buffer_load_dwordx4 v5, s[12:15], s99 offen lds
    s_add_u32 s99, s61, 149504
    s_add_u32 m0, s62, 35840
    s_nop 0
    buffer_load_dwordx4 v5, s[12:15], s99 offen lds
    s_add_u32 s99, s61, 198656
    s_add_u32 m0, s62, 36864
    s_nop 0
    buffer_load_dwordx4 v5, s[12:15], s99 offen lds
    s_add_u32 s99, s61, 247808
    s_add_u32 m0, s62, 37888
    s_nop 0
    buffer_load_dwordx4 v5, s[12:15], s99 offen lds
    s_add_u32 s99, s61, 296960
    s_add_u32 m0, s62, 38912
    s_nop 0
    buffer_load_dwordx4 v5, s[12:15], s99 offen lds
    s_add_u32 s99, s61, 346112
    s_add_u32 m0, s62, 39936
    s_nop 0
    buffer_load_dwordx4 v5, s[12:15], s99 offen lds
    s_add_u32 s99, s96, 256
    s_add_u32 m0, s64, 8192
    s_nop 0
    buffer_load_dwordx4 v120, s[8:11], s99 offen lds
    s_add_u32 s99, s96, 4352
    s_add_u32 m0, s64, 9216
    s_nop 0
    buffer_load_dwordx4 v121, s[8:11], s99 offen lds
    s_add_u32 s99, s96, 8448
    s_add_u32 m0, s64, 10240
    s_nop 0
    buffer_load_dwordx4 v122, s[8:11], s99 offen lds
    s_add_u32 s99, s96, 12544
    s_add_u32 m0, s64, 11264
    s_nop 0
    buffer_load_dwordx4 v123, s[8:11], s99 offen lds
    s_add_u32 s99, s96, 16640
    s_add_u32 m0, s64, 12288
    s_nop 0
    buffer_load_dwordx4 v120, s[8:11], s99 offen lds
    s_add_u32 s99, s96, 20736
    s_add_u32 m0, s64, 13312
    s_nop 0
    buffer_load_dwordx4 v121, s[8:11], s99 offen lds
    s_add_u32 s99, s96, 24832
    s_add_u32 m0, s64, 14336
    s_nop 0
    buffer_load_dwordx4 v122, s[8:11], s99 offen lds
    s_add_u32 s99, s96, 28928
    s_add_u32 m0, s64, 15360
    s_nop 0
    buffer_load_dwordx4 v123, s[8:11], s99 offen lds
    s_mov_b32 s16, s82
    s_and_b32 s17, s83, 0xffff
    s_mov_b32 s18, 524288
    s_mov_b32 s19, 0x00020000
    s_mov_b32 s24, s90
    s_and_b32 s25, s91, 0xffff
    s_mov_b32 s26, 1835008
    s_mov_b32 s27, 0x00020000
    s_mov_b32 s28, s92
    s_and_b32 s29, s93, 0xffff
    s_mov_b32 s30, 2097152
    s_mov_b32 s31, 0x00020000
    s_mov_b32 s40, s80
    s_and_b32 s41, s81, 0xffff
    s_mov_b32 s42, 16384
    s_mov_b32 s43, 0x00020000
    s_lshl_b32 s3, s46, 10
    s_mov_b32 m0, 86016
    s_nop 0
    buffer_load_dwordx4 v4, s[40:43], s3 offen lds
    s_cmp_lt_u32 s44, 2
    s_cselect_b32 s20, s86, s88
    s_cselect_b32 s21, s87, s89
    s_and_b32 s21, s21, 0xffff
    s_mov_b32 s22, 1835008
    s_mov_b32 s23, 0x00020000
    s_cmp_ge_u32 s2, 112
    s_cselect_b32 s82, 1, 0
    s_mul_i32 s83, s82, 112
    s_sub_u32 s83, s2, s83
    s_lshr_b32 s84, s83, 2
    s_and_b32 s85, s83, 3
    s_cmp_eq_u32 s82, 0
    s_cselect_b32 s40, s86, s88
    s_cselect_b32 s41, s87, s89
    s_and_b32 s41, s41, 0xffff
    s_cmp_lt_u32 s2, 224
    s_cselect_b32 s42, 1835008, 0
    s_mov_b32 s43, 0x00020000
    s_lshl_b32 s6, s85, 7
    s_lshl_b32 s3, s44, 5
    s_add_u32 s6, s6, s3
    s_mul_i32 s6, s6, 3584
    s_lshl_b32 s3, s84, 7
    s_add_u32 s6, s6, s3
    s_lshl_b32 s7, s44, 12
    v_mov_b32 v115, v103
    s_mul_i32 s92, s45, 114688
    s_mul_i32 s3, s46, 96
    s_add_u32 s92, s92, s3
    s_add_u32 s92, s92, 2048
    s_min_u32 s93, s44, 2
    s_add_u32 s94, s93, 1
    s_cmp_eq_u32 s93, 2
    s_cselect_b32 s94, 0, s94
    s_lshl_b32 s94, s94, 10
    s_mul_i32 s3, s45, 98304
    s_add_u32 s94, s94, s3
    s_lshl_b32 s3, s46, 6
    s_add_u32 s94, s94, s3
    s_and_b32 s4, s44, 1
    s_lshl_b32 s5, s4, 14
    s_lshr_b32 s4, s44, 1
    s_lshl_b32 s4, s4, 13
    s_add_u32 s5, s5, s4
    s_waitcnt vmcnt(9)
    s_barrier
    v_lshlrev_b32 v108, 5, v106
    v_lshl_add_u32 v108, v97, 3, v108
    v_add_u32 v30, 86016, v108
    v_lshlrev_b32 v31, 8, v3
    v_add_u32 v31, v31, v12
    v_and_b32 v112, 15, v2
    v_xor_b32 v112, v112, v3
    v_lshlrev_b32 v112, 4, v112
    v_lshl_add_u32 v112, v2, 8, v112
    v_add_u32 v112, s64, v112
    v_add_u32 v113, s64, v4
    v_mov_b32 v116, 0
    v_mov_b32 v117, 0
    v_mov_b32 v118, 0
    v_mov_b32 v119, 0
    v_mov_b32 v114, 0x3f803f80
    v_mov_b32 v124, 0x3f803f80
    v_mov_b32 v125, 0x3f803f80
    v_mov_b32 v126, 0x3f803f80
    v_mov_b32 v127, 0x3f803f80
    v_xor_b32 v26, 0, v112
    ds_read_b128 v[128:131], v26 offset:0
    v_xor_b32 v27, 32, v112
    ds_read_b128 v[132:135], v27 offset:0
    v_xor_b32 v26, 64, v112
    ds_read_b128 v[136:139], v26 offset:0
    v_xor_b32 v27, 96, v112
    ds_read_b128 v[140:143], v27 offset:0
    v_xor_b32 v26, 128, v112
    ds_read_b128 v[144:147], v26 offset:0
    v_xor_b32 v27, 160, v112
    ds_read_b128 v[148:151], v27 offset:0
    v_xor_b32 v26, 192, v112
    ds_read_b128 v[152:155], v26 offset:0
    v_xor_b32 v27, 224, v112
    ds_read_b128 v[156:159], v27 offset:0
    ds_read_b64_tr_b16 v[96:97], v31 offset:0
    ds_read_b64_tr_b16 v[98:99], v31 offset:256
    ds_read_b64_tr_b16 v[100:101], v31 offset:32768
    ds_read_b64_tr_b16 v[102:103], v31 offset:33024
    s_waitcnt lgkmcnt(11)
    v_dot2c_f32_bf16 v116, v128, v114
    v_dot2c_f32_bf16 v118, v128, v128
    v_dot2c_f32_bf16 v117, v129, v114
    v_dot2c_f32_bf16 v119, v129, v129
    v_dot2c_f32_bf16 v116, v130, v114
    v_dot2c_f32_bf16 v118, v130, v130
    v_dot2c_f32_bf16 v117, v131, v114
    v_dot2c_f32_bf16 v119, v131, v131
    s_waitcnt lgkmcnt(10)
    v_dot2c_f32_bf16 v116, v132, v114
    v_dot2c_f32_bf16 v118, v132, v132
    v_dot2c_f32_bf16 v117, v133, v114
    v_dot2c_f32_bf16 v119, v133, v133
    v_dot2c_f32_bf16 v116, v134, v114
    v_dot2c_f32_bf16 v118, v134, v134
    v_dot2c_f32_bf16 v117, v135, v114
    v_dot2c_f32_bf16 v119, v135, v135
    s_waitcnt lgkmcnt(9)
    v_dot2c_f32_bf16 v116, v136, v114
    v_dot2c_f32_bf16 v118, v136, v136
    v_dot2c_f32_bf16 v117, v137, v114
    v_dot2c_f32_bf16 v119, v137, v137
    v_dot2c_f32_bf16 v116, v138, v114
    v_dot2c_f32_bf16 v118, v138, v138
    v_dot2c_f32_bf16 v117, v139, v114
    v_dot2c_f32_bf16 v119, v139, v139
    s_waitcnt lgkmcnt(8)
    v_dot2c_f32_bf16 v116, v140, v114
    v_dot2c_f32_bf16 v118, v140, v140
    v_dot2c_f32_bf16 v117, v141, v114
    v_dot2c_f32_bf16 v119, v141, v141
    v_dot2c_f32_bf16 v116, v142, v114
    v_dot2c_f32_bf16 v118, v142, v142
    v_dot2c_f32_bf16 v117, v143, v114
    v_dot2c_f32_bf16 v119, v143, v143
    s_waitcnt lgkmcnt(7)
    v_dot2c_f32_bf16 v116, v144, v114
    v_dot2c_f32_bf16 v118, v144, v144
    v_dot2c_f32_bf16 v117, v145, v114
    v_dot2c_f32_bf16 v119, v145, v145
    v_dot2c_f32_bf16 v116, v146, v114
    v_dot2c_f32_bf16 v118, v146, v146
    v_dot2c_f32_bf16 v117, v147, v114
    v_dot2c_f32_bf16 v119, v147, v147
    s_waitcnt lgkmcnt(6)
    v_dot2c_f32_bf16 v116, v148, v114
    v_dot2c_f32_bf16 v118, v148, v148
    v_dot2c_f32_bf16 v117, v149, v114
    v_dot2c_f32_bf16 v119, v149, v149
    v_dot2c_f32_bf16 v116, v150, v114
    v_dot2c_f32_bf16 v118, v150, v150
    v_dot2c_f32_bf16 v117, v151, v114
    v_dot2c_f32_bf16 v119, v151, v151
    s_waitcnt lgkmcnt(5)
    v_dot2c_f32_bf16 v116, v152, v114
    v_dot2c_f32_bf16 v118, v152, v152
    v_dot2c_f32_bf16 v117, v153, v114
    v_dot2c_f32_bf16 v119, v153, v153
    v_dot2c_f32_bf16 v116, v154, v114
    v_dot2c_f32_bf16 v118, v154, v154
    v_dot2c_f32_bf16 v117, v155, v114
    v_dot2c_f32_bf16 v119, v155, v155
    s_waitcnt lgkmcnt(4)
    v_dot2c_f32_bf16 v116, v156, v114
    v_dot2c_f32_bf16 v118, v156, v156
    v_dot2c_f32_bf16 v117, v157, v114
    v_dot2c_f32_bf16 v119, v157, v157
    v_dot2c_f32_bf16 v116, v158, v114
    v_dot2c_f32_bf16 v118, v158, v158
    v_dot2c_f32_bf16 v117, v159, v114
    v_dot2c_f32_bf16 v119, v159, v159
    s_waitcnt lgkmcnt(2)
    v_mfma_f32_32x32x16_bf16 v[32:47], v[96:99], v[128:131], 0
    ds_read_b64_tr_b16 v[104:105], v31 offset:1024
    ds_read_b64_tr_b16 v[106:107], v31 offset:1280
    s_add_u32 s98, s96, 512
    buffer_load_dwordx4 a[0:3], v120, s[8:11], s98 offen
    s_waitcnt vmcnt(2)
    s_waitcnt lgkmcnt(2)
    v_mfma_f32_32x32x16_bf16 v[48:63], v[100:103], v[128:131], 0
    ds_read_b64_tr_b16 v[108:109], v31 offset:33792
    ds_read_b64_tr_b16 v[110:111], v31 offset:34048
    s_add_u32 s98, s96, 4608
    buffer_load_dwordx4 a[4:7], v121, s[8:11], s98 offen
    v_xor_b32 v26, 0, v112
    ds_read_b128 v[160:163], v26 offset:8192
    s_cmp_lg_u32 s44, 0
    s_cbranch_scc1 CSS_6
    v_mfma_f32_32x32x16_bf16 v[64:79], v[124:127], v[96:99], 0
    v_mfma_f32_32x32x16_bf16 v[80:95], v[124:127], v[100:103], 0
CSS_6:
    s_waitcnt lgkmcnt(3)
    v_mfma_f32_32x32x16_bf16 v[32:47], v[104:107], v[132:135], v[32:47]
    ds_read_b64_tr_b16 v[96:97], v31 offset:2048
    ds_read_b64_tr_b16 v[98:99], v31 offset:2304
    s_add_u32 s98, s96, 8704
    buffer_load_dwordx4 a[8:11], v122, s[8:11], s98 offen
    v_xor_b32 v27, 32, v112
    ds_read_b128 v[164:167], v27 offset:8192
    s_waitcnt lgkmcnt(4)
    v_mfma_f32_32x32x16_bf16 v[48:63], v[108:111], v[132:135], v[48:63]
    ds_read_b64_tr_b16 v[100:101], v31 offset:34816
    ds_read_b64_tr_b16 v[102:103], v31 offset:35072
    s_add_u32 s98, s96, 12800
    buffer_load_dwordx4 a[12:15], v123, s[8:11], s98 offen
    v_xor_b32 v26, 64, v112
    ds_read_b128 v[168:171], v26 offset:8192
    s_cmp_lg_u32 s44, 1
    s_cbranch_scc1 CSS_7
    v_mfma_f32_32x32x16_bf16 v[64:79], v[124:127], v[104:107], 0
    v_mfma_f32_32x32x16_bf16 v[80:95], v[124:127], v[108:111], 0
CSS_7:
    s_waitcnt lgkmcnt(4)
    v_mfma_f32_32x32x16_bf16 v[32:47], v[96:99], v[136:139], v[32:47]
    ds_read_b64_tr_b16 v[104:105], v31 offset:3072
    ds_read_b64_tr_b16 v[106:107], v31 offset:3328
    s_add_u32 s98, s96, 16896
    buffer_load_dwordx4 a[16:19], v120, s[8:11], s98 offen
    v_xor_b32 v27, 96, v112
    ds_read_b128 v[172:175], v27 offset:8192
    s_waitcnt lgkmcnt(4)
    v_mfma_f32_32x32x16_bf16 v[48:63], v[100:103], v[136:139], v[48:63]
    ds_read_b64_tr_b16 v[108:109], v31 offset:35840
    ds_read_b64_tr_b16 v[110:111], v31 offset:36096
    s_add_u32 s98, s96, 20992
    buffer_load_dwordx4 a[20:23], v121, s[8:11], s98 offen
    v_xor_b32 v26, 128, v112
    ds_read_b128 v[176:179], v26 offset:8192
    s_cmp_lg_u32 s44, 2
    s_cbranch_scc1 CSS_8
    v_mfma_f32_32x32x16_bf16 v[64:79], v[124:127], v[96:99], 0
    v_mfma_f32_32x32x16_bf16 v[80:95], v[124:127], v[100:103], 0
CSS_8:
    s_waitcnt lgkmcnt(4)
    v_mfma_f32_32x32x16_bf16 v[32:47], v[104:107], v[140:143], v[32:47]
    ds_read_b64_tr_b16 v[96:97], v31 offset:4096
    ds_read_b64_tr_b16 v[98:99], v31 offset:4352
    s_add_u32 s98, s96, 25088
    buffer_load_dwordx4 a[24:27], v122, s[8:11], s98 offen
    v_xor_b32 v27, 160, v112
    ds_read_b128 v[180:183], v27 offset:8192
    s_waitcnt lgkmcnt(4)
    v_mfma_f32_32x32x16_bf16 v[48:63], v[108:111], v[140:143], v[48:63]
    ds_read_b64_tr_b16 v[100:101], v31 offset:36864
    ds_read_b64_tr_b16 v[102:103], v31 offset:37120
    s_add_u32 s98, s96, 29184
    buffer_load_dwordx4 a[28:31], v123, s[8:11], s98 offen
    v_xor_b32 v26, 192, v112
    ds_read_b128 v[184:187], v26 offset:8192
    s_cmp_lg_u32 s44, 3
    s_cbranch_scc1 CSS_9
    v_mfma_f32_32x32x16_bf16 v[64:79], v[124:127], v[104:107], 0
    v_mfma_f32_32x32x16_bf16 v[80:95], v[124:127], v[108:111], 0
CSS_9:
    s_waitcnt lgkmcnt(4)
    v_mfma_f32_32x32x16_bf16 v[32:47], v[96:99], v[144:147], v[32:47]
    ds_read_b64_tr_b16 v[104:105], v31 offset:5120
    ds_read_b64_tr_b16 v[106:107], v31 offset:5376
    s_add_u32 s98, s96, 768
    buffer_load_dwordx4 a[32:35], v120, s[8:11], s98 offen
    v_xor_b32 v27, 224, v112
    ds_read_b128 v[188:191], v27 offset:8192
    s_waitcnt lgkmcnt(4)
    v_mfma_f32_32x32x16_bf16 v[48:63], v[100:103], v[144:147], v[48:63]
    ds_read_b64_tr_b16 v[108:109], v31 offset:37888
    ds_read_b64_tr_b16 v[110:111], v31 offset:38144
    s_add_u32 s98, s96, 4864
    buffer_load_dwordx4 a[36:39], v121, s[8:11], s98 offen
    s_cmp_lg_u32 s44, 0
    s_cbranch_scc1 CSS_10
    v_mfma_f32_32x32x16_bf16 v[64:79], v[124:127], v[96:99], v[64:79]
    v_mfma_f32_32x32x16_bf16 v[80:95], v[124:127], v[100:103], v[80:95]
CSS_10:
    s_waitcnt lgkmcnt(3)
    v_mfma_f32_32x32x16_bf16 v[32:47], v[104:107], v[148:151], v[32:47]
    ds_read_b64_tr_b16 v[96:97], v31 offset:6144
    ds_read_b64_tr_b16 v[98:99], v31 offset:6400
    s_add_u32 s98, s96, 8960
    buffer_load_dwordx4 a[40:43], v122, s[8:11], s98 offen
    s_waitcnt lgkmcnt(2)
    v_mfma_f32_32x32x16_bf16 v[48:63], v[108:111], v[148:151], v[48:63]
    ds_read_b64_tr_b16 v[100:101], v31 offset:38912
    ds_read_b64_tr_b16 v[102:103], v31 offset:39168
    s_add_u32 s98, s96, 13056
    buffer_load_dwordx4 a[44:47], v123, s[8:11], s98 offen
    s_cmp_lg_u32 s44, 1
    s_cbranch_scc1 CSS_11
    v_mfma_f32_32x32x16_bf16 v[64:79], v[124:127], v[104:107], v[64:79]
    v_mfma_f32_32x32x16_bf16 v[80:95], v[124:127], v[108:111], v[80:95]
CSS_11:
    s_waitcnt lgkmcnt(2)
    v_mfma_f32_32x32x16_bf16 v[32:47], v[96:99], v[152:155], v[32:47]
    ds_read_b64_tr_b16 v[104:105], v31 offset:7168
    ds_read_b64_tr_b16 v[106:107], v31 offset:7424
    s_add_u32 s98, s96, 17152
    buffer_load_dwordx4 a[48:51], v120, s[8:11], s98 offen
    s_waitcnt lgkmcnt(2)
    v_mfma_f32_32x32x16_bf16 v[48:63], v[100:103], v[152:155], v[48:63]
    ds_read_b64_tr_b16 v[108:109], v31 offset:39936
    ds_read_b64_tr_b16 v[110:111], v31 offset:40192
    s_add_u32 s98, s96, 21248
    buffer_load_dwordx4 a[52:55], v121, s[8:11], s98 offen
    s_cmp_lg_u32 s44, 2
    s_cbranch_scc1 CSS_12
    v_mfma_f32_32x32x16_bf16 v[64:79], v[124:127], v[96:99], v[64:79]
    v_mfma_f32_32x32x16_bf16 v[80:95], v[124:127], v[100:103], v[80:95]
CSS_12:
    s_waitcnt lgkmcnt(2)
    v_mfma_f32_32x32x16_bf16 v[32:47], v[104:107], v[156:159], v[32:47]
    ds_read_b64_tr_b16 v[96:97], v31 offset:8192
    ds_read_b64_tr_b16 v[98:99], v31 offset:8448
    s_add_u32 s98, s96, 25344
    buffer_load_dwordx4 a[56:59], v122, s[8:11], s98 offen
    s_waitcnt lgkmcnt(2)
    v_mfma_f32_32x32x16_bf16 v[48:63], v[108:111], v[156:159], v[48:63]
    ds_read_b64_tr_b16 v[100:101], v31 offset:40960
    ds_read_b64_tr_b16 v[102:103], v31 offset:41216
    s_add_u32 s98, s96, 29440
    buffer_load_dwordx4 a[60:63], v123, s[8:11], s98 offen
    s_cmp_lg_u32 s44, 3
    s_cbranch_scc1 CSS_13
    v_mfma_f32_32x32x16_bf16 v[64:79], v[124:127], v[104:107], v[64:79]
    v_mfma_f32_32x32x16_bf16 v[80:95], v[124:127], v[108:111], v[80:95]
CSS_13:
    v_dot2c_f32_bf16 v116, v160, v114
    v_dot2c_f32_bf16 v118, v160, v160
    v_dot2c_f32_bf16 v117, v161, v114
    v_dot2c_f32_bf16 v119, v161, v161
    v_dot2c_f32_bf16 v116, v162, v114
    v_dot2c_f32_bf16 v118, v162, v162
    v_dot2c_f32_bf16 v117, v163, v114
    v_dot2c_f32_bf16 v119, v163, v163
    v_dot2c_f32_bf16 v116, v164, v114
    v_dot2c_f32_bf16 v118, v164, v164
    v_dot2c_f32_bf16 v117, v165, v114
    v_dot2c_f32_bf16 v119, v165, v165
    v_dot2c_f32_bf16 v116, v166, v114
    v_dot2c_f32_bf16 v118, v166, v166
    v_dot2c_f32_bf16 v117, v167, v114
    v_dot2c_f32_bf16 v119, v167, v167
    v_dot2c_f32_bf16 v116, v168, v114
    v_dot2c_f32_bf16 v118, v168, v168
    v_dot2c_f32_bf16 v117, v169, v114
    v_dot2c_f32_bf16 v119, v169, v169
    v_dot2c_f32_bf16 v116, v170, v114
    v_dot2c_f32_bf16 v118, v170, v170
    v_dot2c_f32_bf16 v117, v171, v114
    v_dot2c_f32_bf16 v119, v171, v171
    v_dot2c_f32_bf16 v116, v172, v114
    v_dot2c_f32_bf16 v118, v172, v172
    v_dot2c_f32_bf16 v117, v173, v114
    v_dot2c_f32_bf16 v119, v173, v173
    v_dot2c_f32_bf16 v116, v174, v114
    v_dot2c_f32_bf16 v118, v174, v174
    v_dot2c_f32_bf16 v117, v175, v114
    v_dot2c_f32_bf16 v119, v175, v175
    v_dot2c_f32_bf16 v116, v176, v114
    v_dot2c_f32_bf16 v118, v176, v176
    v_dot2c_f32_bf16 v117, v177, v114
    v_dot2c_f32_bf16 v119, v177, v177
    v_dot2c_f32_bf16 v116, v178, v114
    v_dot2c_f32_bf16 v118, v178, v178
    v_dot2c_f32_bf16 v117, v179, v114
    v_dot2c_f32_bf16 v119, v179, v179
    v_dot2c_f32_bf16 v116, v180, v114
    v_dot2c_f32_bf16 v118, v180, v180
    v_dot2c_f32_bf16 v117, v181, v114
    v_dot2c_f32_bf16 v119, v181, v181
    v_dot2c_f32_bf16 v116, v182, v114
    v_dot2c_f32_bf16 v118, v182, v182
    v_dot2c_f32_bf16 v117, v183, v114
    v_dot2c_f32_bf16 v119, v183, v183
    v_dot2c_f32_bf16 v116, v184, v114
    v_dot2c_f32_bf16 v118, v184, v184
    v_dot2c_f32_bf16 v117, v185, v114
    v_dot2c_f32_bf16 v119, v185, v185
    v_dot2c_f32_bf16 v116, v186, v114
    v_dot2c_f32_bf16 v118, v186, v186
    v_dot2c_f32_bf16 v117, v187, v114
    v_dot2c_f32_bf16 v119, v187, v187
    v_dot2c_f32_bf16 v116, v188, v114
    v_dot2c_f32_bf16 v118, v188, v188
    v_dot2c_f32_bf16 v117, v189, v114
    v_dot2c_f32_bf16 v119, v189, v189
    v_dot2c_f32_bf16 v116, v190, v114
    v_dot2c_f32_bf16 v118, v190, v190
    v_dot2c_f32_bf16 v117, v191, v114
    v_dot2c_f32_bf16 v119, v191, v191
    s_waitcnt lgkmcnt(2)
    v_mfma_f32_32x32x16_bf16 v[32:47], v[96:99], v[160:163], v[32:47]
    ds_read_b64_tr_b16 v[104:105], v31 offset:9216
    ds_read_b64_tr_b16 v[106:107], v31 offset:9472
    s_add_u32 s99, s6, 0
    s_add_u32 m0, s7, 65536
    s_nop 0
    buffer_load_dwordx4 v115, s[40:43], s99 offen lds
    s_waitcnt vmcnt(16)
    ds_write_b128 v113, a[0:3] offset:0
    s_waitcnt lgkmcnt(3)
    v_mfma_f32_32x32x16_bf16 v[48:63], v[100:103], v[160:163], v[48:63]
    ds_read_b64_tr_b16 v[108:109], v31 offset:41984
    ds_read_b64_tr_b16 v[110:111], v31 offset:42240
    s_add_u32 s99, s6, 28672
    s_add_u32 m0, s7, 66560
    s_nop 0
    buffer_load_dwordx4 v115, s[40:43], s99 offen lds
    s_waitcnt vmcnt(16)
    ds_write_b128 v113, a[4:7] offset:1024
    s_cmp_lg_u32 s44, 0
    s_cbranch_scc1 CSS_14
    v_mfma_f32_32x32x16_bf16 v[64:79], v[124:127], v[96:99], v[64:79]
    v_mfma_f32_32x32x16_bf16 v[80:95], v[124:127], v[100:103], v[80:95]
CSS_14:
    s_waitcnt lgkmcnt(4)
    v_mfma_f32_32x32x16_bf16 v[32:47], v[104:107], v[164:167], v[32:47]
    ds_read_b64_tr_b16 v[96:97], v31 offset:10240
    ds_read_b64_tr_b16 v[98:99], v31 offset:10496
    s_add_u32 s99, s6, 57344
    s_add_u32 m0, s7, 67584
    s_nop 0
    buffer_load_dwordx4 v115, s[40:43], s99 offen lds
    s_waitcnt vmcnt(16)
    ds_write_b128 v113, a[8:11] offset:2048
    s_waitcnt lgkmcnt(4)
    v_mfma_f32_32x32x16_bf16 v[48:63], v[108:111], v[164:167], v[48:63]
    ds_read_b64_tr_b16 v[100:101], v31 offset:43008
    ds_read_b64_tr_b16 v[102:103], v31 offset:43264
    s_add_u32 s99, s6, 86016
    s_add_u32 m0, s7, 68608
    s_nop 0
    buffer_load_dwordx4 v115, s[40:43], s99 offen lds
    s_waitcnt vmcnt(16)
    ds_write_b128 v113, a[12:15] offset:3072
    s_cmp_lg_u32 s44, 1
    s_cbranch_scc1 CSS_15
    v_mfma_f32_32x32x16_bf16 v[64:79], v[124:127], v[104:107], v[64:79]
    v_mfma_f32_32x32x16_bf16 v[80:95], v[124:127], v[108:111], v[80:95]
CSS_15:
    s_waitcnt lgkmcnt(4)
    v_mfma_f32_32x32x16_bf16 v[32:47], v[96:99], v[168:171], v[32:47]
    ds_read_b64_tr_b16 v[104:105], v31 offset:11264
    ds_read_b64_tr_b16 v[106:107], v31 offset:11520
    buffer_load_dwordx4 a[64:67], v9, s[20:23], s92 offen offset:0
    s_waitcnt vmcnt(16)
    ds_write_b128 v113, a[16:19] offset:4096
    s_waitcnt lgkmcnt(4)
    v_mfma_f32_32x32x16_bf16 v[48:63], v[100:103], v[168:171], v[48:63]
    ds_read_b64_tr_b16 v[108:109], v31 offset:44032
    ds_read_b64_tr_b16 v[110:111], v31 offset:44288
    buffer_load_dwordx4 a[68:71], v10, s[20:23], s92 offen offset:1024
    s_waitcnt vmcnt(16)
    ds_write_b128 v113, a[20:23] offset:5120
    s_cmp_lg_u32 s44, 2
    s_cbranch_scc1 CSS_16
    v_mfma_f32_32x32x16_bf16 v[64:79], v[124:127], v[96:99], v[64:79]
    v_mfma_f32_32x32x16_bf16 v[80:95], v[124:127], v[100:103], v[80:95]
CSS_16:
    s_waitcnt lgkmcnt(4)
    v_mfma_f32_32x32x16_bf16 v[32:47], v[104:107], v[172:175], v[32:47]
    ds_read_b64_tr_b16 v[96:97], v31 offset:12288
    ds_read_b64_tr_b16 v[98:99], v31 offset:12544
    buffer_load_dwordx4 a[72:75], v11, s[20:23], s92 offen offset:2048
    s_waitcnt vmcnt(16)
    ds_write_b128 v113, a[24:27] offset:6144
    s_waitcnt lgkmcnt(4)
    v_mfma_f32_32x32x16_bf16 v[48:63], v[108:111], v[172:175], v[48:63]
    ds_read_b64_tr_b16 v[100:101], v31 offset:45056
    ds_read_b64_tr_b16 v[102:103], v31 offset:45312
    s_add_u32 s98, s94, 0
    buffer_load_dwordx4 a[76:79], v5, s[12:15], s98 offen
    s_waitcnt vmcnt(16)
    ds_write_b128 v113, a[28:31] offset:7168
    s_cmp_lg_u32 s44, 3
    s_cbranch_scc1 CSS_17
    v_mfma_f32_32x32x16_bf16 v[64:79], v[124:127], v[104:107], v[64:79]
    v_mfma_f32_32x32x16_bf16 v[80:95], v[124:127], v[108:111], v[80:95]
CSS_17:
    s_waitcnt lgkmcnt(4)
    v_mfma_f32_32x32x16_bf16 v[32:47], v[96:99], v[176:179], v[32:47]
    ds_read_b64_tr_b16 v[104:105], v31 offset:13312
    ds_read_b64_tr_b16 v[106:107], v31 offset:13568
    s_add_u32 s98, s94, 49152
    buffer_load_dwordx4 a[80:83], v5, s[12:15], s98 offen
    v_xor_b32 v26, 0, v112
    ds_read_b128 v[192:195], v26 offset:0
    s_waitcnt lgkmcnt(4)
    v_mfma_f32_32x32x16_bf16 v[48:63], v[100:103], v[176:179], v[48:63]
    ds_read_b64_tr_b16 v[108:109], v31 offset:46080
    ds_read_b64_tr_b16 v[110:111], v31 offset:46336
    v_xor_b32 v27, 32, v112
    ds_read_b128 v[196:199], v27 offset:0
    s_cmp_lg_u32 s44, 0
    s_cbranch_scc1 CSS_18
    v_mfma_f32_32x32x16_bf16 v[64:79], v[124:127], v[96:99], v[64:79]
    v_mfma_f32_32x32x16_bf16 v[80:95], v[124:127], v[100:103], v[80:95]
CSS_18:
    s_waitcnt lgkmcnt(4)
    v_mfma_f32_32x32x16_bf16 v[32:47], v[104:107], v[180:183], v[32:47]
    ds_read_b64_tr_b16 v[96:97], v31 offset:14336
    ds_read_b64_tr_b16 v[98:99], v31 offset:14592
    v_xor_b32 v26, 64, v112
    ds_read_b128 v[200:203], v26 offset:0
    s_waitcnt lgkmcnt(4)
    v_mfma_f32_32x32x16_bf16 v[48:63], v[108:111], v[180:183], v[48:63]
    ds_read_b64_tr_b16 v[100:101], v31 offset:47104
    ds_read_b64_tr_b16 v[102:103], v31 offset:47360
    v_xor_b32 v27, 96, v112
    ds_read_b128 v[204:207], v27 offset:0
    s_cmp_lg_u32 s44, 1
    s_cbranch_scc1 CSS_19
    v_mfma_f32_32x32x16_bf16 v[64:79], v[124:127], v[104:107], v[64:79]
    v_mfma_f32_32x32x16_bf16 v[80:95], v[124:127], v[108:111], v[80:95]
CSS_19:
    s_waitcnt lgkmcnt(4)
    v_mfma_f32_32x32x16_bf16 v[32:47], v[96:99], v[184:187], v[32:47]
    ds_read_b64_tr_b16 v[104:105], v31 offset:15360
    ds_read_b64_tr_b16 v[106:107], v31 offset:15616
    v_xor_b32 v26, 128, v112
    ds_read_b128 v[208:211], v26 offset:0
    s_waitcnt lgkmcnt(4)
    v_mfma_f32_32x32x16_bf16 v[48:63], v[100:103], v[184:187], v[48:63]
    ds_read_b64_tr_b16 v[108:109], v31 offset:48128
    ds_read_b64_tr_b16 v[110:111], v31 offset:48384
    v_xor_b32 v27, 160, v112
    ds_read_b128 v[212:215], v27 offset:0
    s_cmp_lg_u32 s44, 2
    s_cbranch_scc1 CSS_20
    v_mfma_f32_32x32x16_bf16 v[64:79], v[124:127], v[96:99], v[64:79]
    v_mfma_f32_32x32x16_bf16 v[80:95], v[124:127], v[100:103], v[80:95]
CSS_20:
    s_waitcnt lgkmcnt(4)
    v_mfma_f32_32x32x16_bf16 v[32:47], v[104:107], v[188:191], v[32:47]
    ds_read_b64_tr_b16 v[96:97], v31 offset:16384
    ds_read_b64_tr_b16 v[98:99], v31 offset:16640
    v_xor_b32 v26, 192, v112
    ds_read_b128 v[216:219], v26 offset:0
    s_waitcnt lgkmcnt(4)
    v_mfma_f32_32x32x16_bf16 v[48:63], v[108:111], v[188:191], v[48:63]
    ds_read_b64_tr_b16 v[100:101], v31 offset:49152
    ds_read_b64_tr_b16 v[102:103], v31 offset:49408
    v_xor_b32 v27, 224, v112
    ds_read_b128 v[220:223], v27 offset:0
    s_cmp_lg_u32 s44, 3
    s_cbranch_scc1 CSS_21
    v_mfma_f32_32x32x16_bf16 v[64:79], v[124:127], v[104:107], v[64:79]
    v_mfma_f32_32x32x16_bf16 v[80:95], v[124:127], v[108:111], v[80:95]
CSS_21:
    v_dot2c_f32_bf16 v116, v192, v114
    v_dot2c_f32_bf16 v118, v192, v192
    v_dot2c_f32_bf16 v117, v193, v114
    v_dot2c_f32_bf16 v119, v193, v193
    v_dot2c_f32_bf16 v116, v194, v114
    v_dot2c_f32_bf16 v118, v194, v194
    v_dot2c_f32_bf16 v117, v195, v114
    v_dot2c_f32_bf16 v119, v195, v195
    v_dot2c_f32_bf16 v116, v196, v114
    v_dot2c_f32_bf16 v118, v196, v196
    v_dot2c_f32_bf16 v117, v197, v114
    v_dot2c_f32_bf16 v119, v197, v197
    v_dot2c_f32_bf16 v116, v198, v114
    v_dot2c_f32_bf16 v118, v198, v198
    v_dot2c_f32_bf16 v117, v199, v114
    v_dot2c_f32_bf16 v119, v199, v199
    v_dot2c_f32_bf16 v116, v200, v114
    v_dot2c_f32_bf16 v118, v200, v200
    v_dot2c_f32_bf16 v117, v201, v114
    v_dot2c_f32_bf16 v119, v201, v201
    v_dot2c_f32_bf16 v116, v202, v114
    v_dot2c_f32_bf16 v118, v202, v202
    v_dot2c_f32_bf16 v117, v203, v114
    v_dot2c_f32_bf16 v119, v203, v203
    v_dot2c_f32_bf16 v116, v204, v114
    v_dot2c_f32_bf16 v118, v204, v204
    v_dot2c_f32_bf16 v117, v205, v114
    v_dot2c_f32_bf16 v119, v205, v205
    v_dot2c_f32_bf16 v116, v206, v114
    v_dot2c_f32_bf16 v118, v206, v206
    v_dot2c_f32_bf16 v117, v207, v114
    v_dot2c_f32_bf16 v119, v207, v207
    v_dot2c_f32_bf16 v116, v208, v114
    v_dot2c_f32_bf16 v118, v208, v208
    v_dot2c_f32_bf16 v117, v209, v114
    v_dot2c_f32_bf16 v119, v209, v209
    v_dot2c_f32_bf16 v116, v210, v114
    v_dot2c_f32_bf16 v118, v210, v210
    v_dot2c_f32_bf16 v117, v211, v114
    v_dot2c_f32_bf16 v119, v211, v211
    s_waitcnt lgkmcnt(6)
    v_dot2c_f32_bf16 v116, v212, v114
    v_dot2c_f32_bf16 v118, v212, v212
    v_dot2c_f32_bf16 v117, v213, v114
    v_dot2c_f32_bf16 v119, v213, v213
    v_dot2c_f32_bf16 v116, v214, v114
    v_dot2c_f32_bf16 v118, v214, v214
    v_dot2c_f32_bf16 v117, v215, v114
    v_dot2c_f32_bf16 v119, v215, v215
    s_waitcnt lgkmcnt(3)
    v_dot2c_f32_bf16 v116, v216, v114
    v_dot2c_f32_bf16 v118, v216, v216
    v_dot2c_f32_bf16 v117, v217, v114
    v_dot2c_f32_bf16 v119, v217, v217
    v_dot2c_f32_bf16 v116, v218, v114
    v_dot2c_f32_bf16 v118, v218, v218
    v_dot2c_f32_bf16 v117, v219, v114
    v_dot2c_f32_bf16 v119, v219, v219
    s_waitcnt lgkmcnt(0)
    v_dot2c_f32_bf16 v116, v220, v114
    v_dot2c_f32_bf16 v118, v220, v220
    v_dot2c_f32_bf16 v117, v221, v114
    v_dot2c_f32_bf16 v119, v221, v221
    v_dot2c_f32_bf16 v116, v222, v114
    v_dot2c_f32_bf16 v118, v222, v222
    v_dot2c_f32_bf16 v117, v223, v114
    v_dot2c_f32_bf16 v119, v223, v223
    v_mfma_f32_32x32x16_bf16 v[32:47], v[96:99], v[192:195], v[32:47]
    ds_read_b64_tr_b16 v[104:105], v31 offset:17408
    ds_read_b64_tr_b16 v[106:107], v31 offset:17664
    s_waitcnt vmcnt(16)
    ds_write_b128 v113, a[32:35] offset:8192
    v_mfma_f32_32x32x16_bf16 v[48:63], v[100:103], v[192:195], v[48:63]
    ds_read_b64_tr_b16 v[108:109], v31 offset:50176
    ds_read_b64_tr_b16 v[110:111], v31 offset:50432
    s_waitcnt vmcnt(15)
    ds_write_b128 v113, a[36:39] offset:9216
    s_cmp_lg_u32 s44, 0
    s_cbranch_scc1 CSS_22
    v_mfma_f32_32x32x16_bf16 v[64:79], v[124:127], v[96:99], v[64:79]
    v_mfma_f32_32x32x16_bf16 v[80:95], v[124:127], v[100:103], v[80:95]
CSS_22:
    s_waitcnt lgkmcnt(4)
    v_mfma_f32_32x32x16_bf16 v[32:47], v[104:107], v[196:199], v[32:47]
    ds_read_b64_tr_b16 v[96:97], v31 offset:18432
    ds_read_b64_tr_b16 v[98:99], v31 offset:18688
    s_waitcnt vmcnt(14)
    ds_write_b128 v113, a[40:43] offset:10240
    s_waitcnt lgkmcnt(4)
    v_mfma_f32_32x32x16_bf16 v[48:63], v[108:111], v[196:199], v[48:63]
    ds_read_b64_tr_b16 v[100:101], v31 offset:51200
    ds_read_b64_tr_b16 v[102:103], v31 offset:51456
    s_waitcnt vmcnt(13)
    ds_write_b128 v113, a[44:47] offset:11264
    s_cmp_lg_u32 s44, 1
    s_cbranch_scc1 CSS_23
    v_mfma_f32_32x32x16_bf16 v[64:79], v[124:127], v[104:107], v[64:79]
    v_mfma_f32_32x32x16_bf16 v[80:95], v[124:127], v[108:111], v[80:95]
CSS_23:
    s_waitcnt lgkmcnt(4)
    v_mfma_f32_32x32x16_bf16 v[32:47], v[96:99], v[200:203], v[32:47]
    ds_read_b64_tr_b16 v[104:105], v31 offset:19456
    ds_read_b64_tr_b16 v[106:107], v31 offset:19712
    s_waitcnt vmcnt(12)
    ds_write_b128 v113, a[48:51] offset:12288
    s_waitcnt lgkmcnt(4)
    v_mfma_f32_32x32x16_bf16 v[48:63], v[100:103], v[200:203], v[48:63]
    ds_read_b64_tr_b16 v[108:109], v31 offset:52224
    ds_read_b64_tr_b16 v[110:111], v31 offset:52480
    s_waitcnt vmcnt(11)
    ds_write_b128 v113, a[52:55] offset:13312
    s_cmp_lg_u32 s44, 2
    s_cbranch_scc1 CSS_24
    v_mfma_f32_32x32x16_bf16 v[64:79], v[124:127], v[96:99], v[64:79]
    v_mfma_f32_32x32x16_bf16 v[80:95], v[124:127], v[100:103], v[80:95]
CSS_24:
    s_waitcnt lgkmcnt(4)
    v_mfma_f32_32x32x16_bf16 v[32:47], v[104:107], v[204:207], v[32:47]
    ds_read_b64_tr_b16 v[96:97], v31 offset:20480
    ds_read_b64_tr_b16 v[98:99], v31 offset:20736
    s_waitcnt vmcnt(10)
    ds_write_b128 v113, a[56:59] offset:14336
    s_waitcnt lgkmcnt(4)
    v_mfma_f32_32x32x16_bf16 v[48:63], v[108:111], v[204:207], v[48:63]
    ds_read_b64_tr_b16 v[100:101], v31 offset:53248
    ds_read_b64_tr_b16 v[102:103], v31 offset:53504
    s_waitcnt vmcnt(9)
    ds_write_b128 v113, a[60:63] offset:15360
    s_cmp_lg_u32 s44, 3
    s_cbranch_scc1 CSS_25
    v_mfma_f32_32x32x16_bf16 v[64:79], v[124:127], v[104:107], v[64:79]
    v_mfma_f32_32x32x16_bf16 v[80:95], v[124:127], v[108:111], v[80:95]
CSS_25:
    s_waitcnt lgkmcnt(4)
    v_mfma_f32_32x32x16_bf16 v[32:47], v[96:99], v[208:211], v[32:47]
    ds_read_b64_tr_b16 v[104:105], v31 offset:21504
    ds_read_b64_tr_b16 v[106:107], v31 offset:21760
    v_xor_b32 v26, 0, v112
    ds_read_b128 v[224:227], v26 offset:8192
    s_waitcnt lgkmcnt(4)
    v_mfma_f32_32x32x16_bf16 v[48:63], v[100:103], v[208:211], v[48:63]
    ds_read_b64_tr_b16 v[108:109], v31 offset:54272
    ds_read_b64_tr_b16 v[110:111], v31 offset:54528
    v_xor_b32 v27, 32, v112
    ds_read_b128 v[228:231], v27 offset:8192
    s_cmp_lg_u32 s44, 0
    s_cbranch_scc1 CSS_26
    v_mfma_f32_32x32x16_bf16 v[64:79], v[124:127], v[96:99], v[64:79]
    v_mfma_f32_32x32x16_bf16 v[80:95], v[124:127], v[100:103], v[80:95]
CSS_26:
    s_waitcnt lgkmcnt(4)
    v_mfma_f32_32x32x16_bf16 v[32:47], v[104:107], v[212:215], v[32:47]
    ds_read_b64_tr_b16 v[96:97], v31 offset:22528
    ds_read_b64_tr_b16 v[98:99], v31 offset:22784
    v_xor_b32 v26, 64, v112
    ds_read_b128 v[232:235], v26 offset:8192
    s_waitcnt lgkmcnt(4)
    v_mfma_f32_32x32x16_bf16 v[48:63], v[108:111], v[212:215], v[48:63]
    ds_read_b64_tr_b16 v[100:101], v31 offset:55296
    ds_read_b64_tr_b16 v[102:103], v31 offset:55552
    v_xor_b32 v27, 96, v112
    ds_read_b128 v[236:239], v27 offset:8192
    s_cmp_lg_u32 s44, 1
    s_cbranch_scc1 CSS_27
    v_mfma_f32_32x32x16_bf16 v[64:79], v[124:127], v[104:107], v[64:79]
    v_mfma_f32_32x32x16_bf16 v[80:95], v[124:127], v[108:111], v[80:95]
CSS_27:
    s_waitcnt lgkmcnt(4)
    v_mfma_f32_32x32x16_bf16 v[32:47], v[96:99], v[216:219], v[32:47]
    ds_read_b64_tr_b16 v[104:105], v31 offset:23552
    ds_read_b64_tr_b16 v[106:107], v31 offset:23808
    v_xor_b32 v26, 128, v112
    ds_read_b128 v[240:243], v26 offset:8192
    s_waitcnt lgkmcnt(4)
    v_mfma_f32_32x32x16_bf16 v[48:63], v[100:103], v[216:219], v[48:63]
    ds_read_b64_tr_b16 v[108:109], v31 offset:56320
    ds_read_b64_tr_b16 v[110:111], v31 offset:56576
    v_xor_b32 v27, 160, v112
    ds_read_b128 v[244:247], v27 offset:8192
    s_cmp_lg_u32 s44, 2
    s_cbranch_scc1 CSS_28
    v_mfma_f32_32x32x16_bf16 v[64:79], v[124:127], v[96:99], v[64:79]
    v_mfma_f32_32x32x16_bf16 v[80:95], v[124:127], v[100:103], v[80:95]
CSS_28:
    s_waitcnt lgkmcnt(4)
    v_mfma_f32_32x32x16_bf16 v[32:47], v[104:107], v[220:223], v[32:47]
    ds_read_b64_tr_b16 v[96:97], v31 offset:24576
    ds_read_b64_tr_b16 v[98:99], v31 offset:24832
    v_xor_b32 v26, 192, v112
    ds_read_b128 v[248:251], v26 offset:8192
    s_waitcnt lgkmcnt(4)
    v_mfma_f32_32x32x16_bf16 v[48:63], v[108:111], v[220:223], v[48:63]
    ds_read_b64_tr_b16 v[100:101], v31 offset:57344
    ds_read_b64_tr_b16 v[102:103], v31 offset:57600
    v_xor_b32 v27, 224, v112
    ds_read_b128 v[252:255], v27 offset:8192
    s_cmp_lg_u32 s44, 3
    s_cbranch_scc1 CSS_29
    v_mfma_f32_32x32x16_bf16 v[64:79], v[124:127], v[104:107], v[64:79]
    v_mfma_f32_32x32x16_bf16 v[80:95], v[124:127], v[108:111], v[80:95]
CSS_29:
    v_dot2c_f32_bf16 v116, v224, v114
    v_dot2c_f32_bf16 v118, v224, v224
    v_dot2c_f32_bf16 v117, v225, v114
    v_dot2c_f32_bf16 v119, v225, v225
    v_dot2c_f32_bf16 v116, v226, v114
    v_dot2c_f32_bf16 v118, v226, v226
    v_dot2c_f32_bf16 v117, v227, v114
    v_dot2c_f32_bf16 v119, v227, v227
    v_dot2c_f32_bf16 v116, v228, v114
    v_dot2c_f32_bf16 v118, v228, v228
    v_dot2c_f32_bf16 v117, v229, v114
    v_dot2c_f32_bf16 v119, v229, v229
    v_dot2c_f32_bf16 v116, v230, v114
    v_dot2c_f32_bf16 v118, v230, v230
    v_dot2c_f32_bf16 v117, v231, v114
    v_dot2c_f32_bf16 v119, v231, v231
    v_dot2c_f32_bf16 v116, v232, v114
    v_dot2c_f32_bf16 v118, v232, v232
    v_dot2c_f32_bf16 v117, v233, v114
    v_dot2c_f32_bf16 v119, v233, v233
    v_dot2c_f32_bf16 v116, v234, v114
    v_dot2c_f32_bf16 v118, v234, v234
    v_dot2c_f32_bf16 v117, v235, v114
    v_dot2c_f32_bf16 v119, v235, v235
    v_dot2c_f32_bf16 v116, v236, v114
    v_dot2c_f32_bf16 v118, v236, v236
    v_dot2c_f32_bf16 v117, v237, v114
    v_dot2c_f32_bf16 v119, v237, v237
    v_dot2c_f32_bf16 v116, v238, v114
    v_dot2c_f32_bf16 v118, v238, v238
    v_dot2c_f32_bf16 v117, v239, v114
    v_dot2c_f32_bf16 v119, v239, v239
    v_dot2c_f32_bf16 v116, v240, v114
    v_dot2c_f32_bf16 v118, v240, v240
    v_dot2c_f32_bf16 v117, v241, v114
    v_dot2c_f32_bf16 v119, v241, v241
    v_dot2c_f32_bf16 v116, v242, v114
    v_dot2c_f32_bf16 v118, v242, v242
    v_dot2c_f32_bf16 v117, v243, v114
    v_dot2c_f32_bf16 v119, v243, v243
    s_waitcnt lgkmcnt(6)
    v_dot2c_f32_bf16 v116, v244, v114
    v_dot2c_f32_bf16 v118, v244, v244
    v_dot2c_f32_bf16 v117, v245, v114
    v_dot2c_f32_bf16 v119, v245, v245
    v_dot2c_f32_bf16 v116, v246, v114
    v_dot2c_f32_bf16 v118, v246, v246
    v_dot2c_f32_bf16 v117, v247, v114
    v_dot2c_f32_bf16 v119, v247, v247
    s_waitcnt lgkmcnt(3)
    v_dot2c_f32_bf16 v116, v248, v114
    v_dot2c_f32_bf16 v118, v248, v248
    v_dot2c_f32_bf16 v117, v249, v114
    v_dot2c_f32_bf16 v119, v249, v249
    v_dot2c_f32_bf16 v116, v250, v114
    v_dot2c_f32_bf16 v118, v250, v250
    v_dot2c_f32_bf16 v117, v251, v114
    v_dot2c_f32_bf16 v119, v251, v251
    s_waitcnt lgkmcnt(0)
    v_dot2c_f32_bf16 v116, v252, v114
    v_dot2c_f32_bf16 v118, v252, v252
    v_dot2c_f32_bf16 v117, v253, v114
    v_dot2c_f32_bf16 v119, v253, v253
    v_dot2c_f32_bf16 v116, v254, v114
    v_dot2c_f32_bf16 v118, v254, v254
    v_dot2c_f32_bf16 v117, v255, v114
    v_dot2c_f32_bf16 v119, v255, v255
    v_mfma_f32_32x32x16_bf16 v[32:47], v[96:99], v[224:227], v[32:47]
    ds_read_b64_tr_b16 v[104:105], v31 offset:25600
    ds_read_b64_tr_b16 v[106:107], v31 offset:25856
    v_mfma_f32_32x32x16_bf16 v[48:63], v[100:103], v[224:227], v[48:63]
    ds_read_b64_tr_b16 v[108:109], v31 offset:58368
    ds_read_b64_tr_b16 v[110:111], v31 offset:58624
    s_cmp_lg_u32 s44, 0
    s_cbranch_scc1 CSS_30
    v_mfma_f32_32x32x16_bf16 v[64:79], v[124:127], v[96:99], v[64:79]
    v_mfma_f32_32x32x16_bf16 v[80:95], v[124:127], v[100:103], v[80:95]
CSS_30:
    s_waitcnt lgkmcnt(2)
    v_mfma_f32_32x32x16_bf16 v[32:47], v[104:107], v[228:231], v[32:47]
    ds_read_b64_tr_b16 v[96:97], v31 offset:26624
    ds_read_b64_tr_b16 v[98:99], v31 offset:26880
    s_waitcnt lgkmcnt(2)
    v_mfma_f32_32x32x16_bf16 v[48:63], v[108:111], v[228:231], v[48:63]
    ds_read_b64_tr_b16 v[100:101], v31 offset:59392
    ds_read_b64_tr_b16 v[102:103], v31 offset:59648
    s_cmp_lg_u32 s44, 1
    s_cbranch_scc1 CSS_31
    v_mfma_f32_32x32x16_bf16 v[64:79], v[124:127], v[104:107], v[64:79]
    v_mfma_f32_32x32x16_bf16 v[80:95], v[124:127], v[108:111], v[80:95]
CSS_31:
    s_waitcnt lgkmcnt(2)
    v_mfma_f32_32x32x16_bf16 v[32:47], v[96:99], v[232:235], v[32:47]
    ds_read_b64_tr_b16 v[104:105], v31 offset:27648
    ds_read_b64_tr_b16 v[106:107], v31 offset:27904
    s_waitcnt lgkmcnt(2)
    v_mfma_f32_32x32x16_bf16 v[48:63], v[100:103], v[232:235], v[48:63]
    ds_read_b64_tr_b16 v[108:109], v31 offset:60416
    ds_read_b64_tr_b16 v[110:111], v31 offset:60672
    s_cmp_lg_u32 s44, 2
    s_cbranch_scc1 CSS_32
    v_mfma_f32_32x32x16_bf16 v[64:79], v[124:127], v[96:99], v[64:79]
    v_mfma_f32_32x32x16_bf16 v[80:95], v[124:127], v[100:103], v[80:95]
CSS_32:
    s_waitcnt lgkmcnt(2)
    v_mfma_f32_32x32x16_bf16 v[32:47], v[104:107], v[236:239], v[32:47]
    ds_read_b64_tr_b16 v[96:97], v31 offset:28672
    ds_read_b64_tr_b16 v[98:99], v31 offset:28928
    s_waitcnt lgkmcnt(2)
    v_mfma_f32_32x32x16_bf16 v[48:63], v[108:111], v[236:239], v[48:63]
    ds_read_b64_tr_b16 v[100:101], v31 offset:61440
    ds_read_b64_tr_b16 v[102:103], v31 offset:61696
    s_cmp_lg_u32 s44, 3
    s_cbranch_scc1 CSS_33
    v_mfma_f32_32x32x16_bf16 v[64:79], v[124:127], v[104:107], v[64:79]
    v_mfma_f32_32x32x16_bf16 v[80:95], v[124:127], v[108:111], v[80:95]
CSS_33:
    s_waitcnt lgkmcnt(2)
    v_mfma_f32_32x32x16_bf16 v[32:47], v[96:99], v[240:243], v[32:47]
    ds_read_b64_tr_b16 v[104:105], v31 offset:29696
    ds_read_b64_tr_b16 v[106:107], v31 offset:29952
    s_waitcnt lgkmcnt(2)
    v_mfma_f32_32x32x16_bf16 v[48:63], v[100:103], v[240:243], v[48:63]
    ds_read_b64_tr_b16 v[108:109], v31 offset:62464
    ds_read_b64_tr_b16 v[110:111], v31 offset:62720
    s_cmp_lg_u32 s44, 0
    s_cbranch_scc1 CSS_34
    v_mfma_f32_32x32x16_bf16 v[64:79], v[124:127], v[96:99], v[64:79]
    v_mfma_f32_32x32x16_bf16 v[80:95], v[124:127], v[100:103], v[80:95]
CSS_34:
    s_waitcnt lgkmcnt(2)
    v_mfma_f32_32x32x16_bf16 v[32:47], v[104:107], v[244:247], v[32:47]
    ds_read_b64_tr_b16 v[96:97], v31 offset:30720
    ds_read_b64_tr_b16 v[98:99], v31 offset:30976
    s_waitcnt lgkmcnt(2)
    v_mfma_f32_32x32x16_bf16 v[48:63], v[108:111], v[244:247], v[48:63]
    ds_read_b64_tr_b16 v[100:101], v31 offset:63488
    ds_read_b64_tr_b16 v[102:103], v31 offset:63744
    s_cmp_lg_u32 s44, 1
    s_cbranch_scc1 CSS_35
    v_mfma_f32_32x32x16_bf16 v[64:79], v[124:127], v[104:107], v[64:79]
    v_mfma_f32_32x32x16_bf16 v[80:95], v[124:127], v[108:111], v[80:95]
CSS_35:
    s_waitcnt lgkmcnt(2)
    v_mfma_f32_32x32x16_bf16 v[32:47], v[96:99], v[248:251], v[32:47]
    ds_read_b64_tr_b16 v[104:105], v31 offset:31744
    ds_read_b64_tr_b16 v[106:107], v31 offset:32000
    s_waitcnt lgkmcnt(2)
    v_mfma_f32_32x32x16_bf16 v[48:63], v[100:103], v[248:251], v[48:63]
    ds_read_b64_tr_b16 v[108:109], v31 offset:64512
    ds_read_b64_tr_b16 v[110:111], v31 offset:64768
    s_cmp_lg_u32 s44, 2
    s_cbranch_scc1 CSS_36
    v_mfma_f32_32x32x16_bf16 v[64:79], v[124:127], v[96:99], v[64:79]
    v_mfma_f32_32x32x16_bf16 v[80:95], v[124:127], v[100:103], v[80:95]
CSS_36:
    s_waitcnt lgkmcnt(2)
    v_mfma_f32_32x32x16_bf16 v[32:47], v[104:107], v[252:255], v[32:47]
    s_waitcnt lgkmcnt(0)
    v_mfma_f32_32x32x16_bf16 v[48:63], v[108:111], v[252:255], v[48:63]
    s_cmp_lg_u32 s44, 3
    s_cbranch_scc1 CSS_37
    v_mfma_f32_32x32x16_bf16 v[64:79], v[124:127], v[104:107], v[64:79]
    v_mfma_f32_32x32x16_bf16 v[80:95], v[124:127], v[108:111], v[80:95]
CSS_37:
    s_lshl_b32 s92, s46, 1
    s_lshr_b32 s3, s44, 1
    s_add_u32 s92, s92, s3
    s_mul_i32 s92, s92, 49152
    s_mul_i32 s3, s45, 3072
    s_add_u32 s92, s92, s3
    s_add_u32 s92, s92, 33554432
    s_waitcnt vmcnt(4)
    buffer_store_dwordx4 a[64:67], v4, s[32:35], s92 offen offset:0 sc1
    s_waitcnt vmcnt(4)
    buffer_store_dwordx4 a[68:71], v4, s[32:35], s92 offen offset:1024 sc1
    s_waitcnt vmcnt(4)
    buffer_store_dwordx4 a[72:75], v4, s[32:35], s92 offen offset:2048 sc1
    s_mul_i32 s94, s46, 98304
    s_lshl_b32 s3, s93, 15
    s_add_u32 s94, s94, s3
    s_lshl_b32 s3, s45, 11
    s_add_u32 s94, s94, s3
    s_add_u32 s94, s94, 14680064
    s_waitcnt vmcnt(4)
    buffer_store_dwordx4 a[76:79], v4, s[32:35], s94 offen offset:0 sc1
    s_waitcnt vmcnt(4)
    buffer_store_dwordx4 a[80:83], v4, s[32:35], s94 offen offset:1024 sc1
    v_mov_b32 v23, 0
    buffer_load_dword a233, v23, s[36:39], 0 offen sc1
    v_lshlrev_b32 v23, 7, v1
    s_cmp_gt_u32 s44, 1
    s_cbranch_scc1 NOWARM_38
    s_mul_i32 s3, s2, 7168
    s_cmp_eq_u32 s44, 0
    s_cselect_b32 s74, 0xffffffff, 0xffff
    s_cselect_b32 s75, 0xffffff, 0
    s_mov_b64 s[58:59], exec
    s_mov_b32 exec_lo, s74
    s_mov_b32 exec_hi, s75
    s_cmp_eq_u32 s44, 0
    s_cbranch_scc0 WARM1_39
    buffer_load_dword a232, v23, s[24:27], s3 offen
    s_branch WARM1_39_e
WARM1_39:
    s_lshl_b32 s3, s2, 11
    buffer_load_dword a232, v23, s[16:19], s3 offen
WARM1_39_e:
    s_mov_b64 exec, s[58:59]
NOWARM_38:
    v_add_f32 v116, v116, v117
    v_add_f32 v118, v118, v119
    v_mov_b32 v26, v116
    v_mov_b32 v27, v118
    v_nop
    v_permlane32_swap_b32 v116, v26
    v_permlane32_swap_b32 v118, v27
    v_add_f32 v116, v116, v26
    v_add_f32 v118, v118, v27
    v_mul_f32 v22, s51, v116
    v_mul_f32 v118, s51, v118
    v_fma_f32 v118, -v22, v22, v118
    v_max_f32 v118, 0, v118
    v_add_f32 v118, s52, v118
    v_rsq_f32 v21, v118
    v_lshlrev_b32 v28, 4, v2
    s_lshl_b32 s74, s44, 2
    v_add_u32 v28, s74, v28
    v_add_u32 v28, 81920, v28
    ds_write_b32 v28, v64 offset:0
    ds_write_b32 v28, v80 offset:512
    s_waitcnt lgkmcnt(0)
    s_barrier
    v_lshlrev_b32 v28, 4, v2
    v_add_u32 v28, 81920, v28
    ds_read_b128 v[96:99], v28 offset:0
    ds_read_b128 v[100:103], v28 offset:512
    s_waitcnt lgkmcnt(1)
    v_add_f32 v96, v96, v97
    v_add_f32 v98, v98, v99
    v_add_f32 v96, v96, v98
    v_cndmask_b32 v96, 0, v96, s[54:55]
    v_cvt_pk_bf16_f32 v108, v96, v96
    v_lshlrev_b32 v26, 16, v108
    v_sub_f32 v26, v96, v26
    v_cvt_pk_bf16_f32 v109, v26, v26
    v_accvgpr_write_b32 a220, v108
    v_accvgpr_write_b32 a221, v109
    v_accvgpr_write_b32 a222, 0
    v_accvgpr_write_b32 a223, 0
    s_waitcnt lgkmcnt(0)
    v_add_f32 v100, v100, v101
    v_add_f32 v102, v102, v103
    v_add_f32 v100, v100, v102
    v_cndmask_b32 v100, 0, v100, s[54:55]
    v_cvt_pk_bf16_f32 v108, v100, v100
    v_lshlrev_b32 v26, 16, v108
    v_sub_f32 v26, v100, v26
    v_cvt_pk_bf16_f32 v109, v26, v26
    v_accvgpr_write_b32 a224, v108
    v_accvgpr_write_b32 a225, v109
    v_accvgpr_write_b32 a226, 0
    v_accvgpr_write_b32 a227, 0
    ds_read_b64_tr_b16 v[112:113], v30
    ds_read_b64_tr_b16 v[114:115], v30 offset:256
    ds_read_b64_tr_b16 v[116:117], v30 offset:512
    ds_read_b64_tr_b16 v[118:119], v30 offset:768
    v_bfe_u32 v26, v0, 4, 1
    v_cmp_eq_u32 vcc, 0, v26
    s_waitcnt lgkmcnt(3)
    s_nop 0
    v_cndmask_b32 v112, 0, v112, vcc
    v_cndmask_b32 v113, 0, v113, vcc
    s_waitcnt lgkmcnt(2)
    v_cndmask_b32 v114, 0, v114, vcc
    v_cndmask_b32 v115, 0, v115, vcc
    s_waitcnt lgkmcnt(1)
    v_cndmask_b32 v116, v116, 0, vcc
    v_cndmask_b32 v117, v117, 0, vcc
    s_waitcnt lgkmcnt(0)
    v_cndmask_b32 v118, v118, 0, vcc
    v_cndmask_b32 v119, v119, 0, vcc
    v_accvgpr_write_b32 a248, v112
    v_accvgpr_write_b32 a249, v113
    v_accvgpr_write_b32 a250, v114
    v_accvgpr_write_b32 a251, v115
    v_accvgpr_write_b32 a252, v116
    v_accvgpr_write_b32 a253, v117
    v_accvgpr_write_b32 a254, v118
    v_accvgpr_write_b32 a255, v119
    s_cmp_ge_u32 s2, 224
    s_cbranch_scc1 NOCS3J_40
    v_mov_b32 v104, 0x3f803f80
    v_mov_b32 v105, 0x3f803f80
    v_mov_b32 v106, 0x3f803f80
    v_mov_b32 v107, 0x3f803f80
    s_lshr_b32 s74, s44, 1
    s_lshl_b32 s74, s74, 13
    s_add_u32 s74, s74, 65536
    v_add_u32 v29, s74, v14
    ds_read_b64_tr_b16 v[112:113], v29 offset:0
    ds_read_b64_tr_b16 v[114:115], v29 offset:1024
    ds_read_b64_tr_b16 v[116:117], v29 offset:2048
    ds_read_b64_tr_b16 v[118:119], v29 offset:3072
    ds_read_b64_tr_b16 v[120:121], v29 offset:4096
    ds_read_b64_tr_b16 v[122:123], v29 offset:5120
    ds_read_b64_tr_b16 v[96:97], v29 offset:6144
    ds_read_b64_tr_b16 v[98:99], v29 offset:7168
    s_waitcnt lgkmcnt(6)
    v_mfma_f32_32x32x16_bf16 v[80:95], v[104:107], v[112:115], 0
    s_waitcnt lgkmcnt(4)
    v_mfma_f32_32x32x16_bf16 v[80:95], v[104:107], v[116:119], v[80:95]
    s_waitcnt lgkmcnt(2)
    v_mfma_f32_32x32x16_bf16 v[80:95], v[104:107], v[120:123], v[80:95]
    s_waitcnt lgkmcnt(0)
    v_mfma_f32_32x32x16_bf16 v[80:95], v[104:107], v[96:99], v[80:95]
    s_cmp_ge_u32 s2, 112
    s_cselect_b32 s82, 1, 0
    s_mul_i32 s83, s82, 112
    s_sub_u32 s83, s2, s83
    s_lshr_b32 s84, s83, 2
    s_and_b32 s85, s83, 3
    s_mul_i32 s74, s82, 1792
    s_lshl_b32 s75, s84, 6
    s_add_u32 s74, s74, s75
    s_and_b32 s75, s44, 1
    s_lshl_b32 s75, s75, 5
    s_add_u32 s74, s74, s75
    s_lshl_b32 s74, s74, 5
    s_lshl_b32 s75, s85, 1
    s_lshr_b32 s76, s44, 1
    s_add_u32 s75, s75, s76
    s_lshl_b32 s75, s75, 2
    s_add_u32 s74, s74, s75
    s_add_u32 s74, s74, 262144
    v_lshlrev_b32 v29, 5, v2
    s_mov_b64 s[58:59], exec
    s_mov_b32 exec_hi, 0
    buffer_store_dword v80, v29, s[32:35], s74 offen sc1
    s_mov_b64 exec, s[58:59]
NOCS3J_40:
    s_barrier
    v_sub_f32 v28, 0, v22
    v_cndmask_b32 v28, 0, v28, s[54:55]
    v_cvt_pk_bf16_f32 v124, v28, v28
    v_lshlrev_b32 v26, 16, v124
    v_sub_f32 v26, v28, v26
    v_cvt_pk_bf16_f32 v124, v28, v26
    v_mov_b32 v125, v124
    v_mov_b32 v126, 0
    v_mov_b32 v127, 0
    s_lshl_b32 s74, s44, 5
    v_add_u32 v26, s74, v2
    v_mul_u32_u24 v112, 104, v26
    v_lshl_add_u32 v112, v3, 3, v112
    v_add_u32 v112, 149504, v112
    v_mul_u32_u24 v113, 136, v26
    v_lshl_add_u32 v113, v3, 3, v113
    v_add_u32 v113, 132096, v113
    v_mov_b32 v114, 0x3f803f80
    v_mov_b32 v115, 0x3f803f80
    v_bfe_u32 v26, v0, 2, 2
    v_lshl_add_u32 v26, v3, 3, v26
    v_and_b32 v27, 3, v0
    v_lshlrev_b32 v27, 3, v27
    v_bfe_u32 v28, v0, 4, 1
    v_mul_u32_u24 v116, 136, v26
    v_add_u32 v116, v116, v27
    v_lshl_add_u32 v116, v28, 5, v116
    s_lshl_b32 s74, s44, 6
    s_add_u32 s74, s74, 132096
    v_add_u32 v116, s74, v116
    s_lshl_b32 s74, s44, 5
    v_mov_b32 v29, s74
    v_cmp_eq_u32 vcc, 0, v28
    s_nop 1
    v_cndmask_b32 v29, 64, v29, vcc
    v_mul_u32_u24 v117, 104, v26
    v_add_u32 v117, v117, v27
    v_add_u32 v117, v117, v29
    v_add_u32 v117, 149504, v117
    v_mul_u32_u24 v118, 17, v3
    v_add_u32 v118, v118, v2
    v_lshlrev_b32 v118, 4, v118
    v_mfma_f32_32x32x16_bf16 v[32:47], a[220:223], v[124:127], v[32:47]
    v_mfma_f32_32x32x16_bf16 v[48:63], a[224:227], v[124:127], v[48:63]
    s_nop 10
    v_pk_mul_f32 v[32:33], v[32:33], v[20:21] op_sel:[0,1] op_sel_hi:[1,1]
    v_pk_mul_f32 v[34:35], v[34:35], v[20:21] op_sel:[0,1] op_sel_hi:[1,1]
    v_pk_mul_f32 v[36:37], v[36:37], v[20:21] op_sel:[0,1] op_sel_hi:[1,1]
    v_pk_mul_f32 v[38:39], v[38:39], v[20:21] op_sel:[0,1] op_sel_hi:[1,1]
    v_pk_mul_f32 v[40:41], v[40:41], v[20:21] op_sel:[0,1] op_sel_hi:[1,1]
    v_pk_mul_f32 v[42:43], v[42:43], v[20:21] op_sel:[0,1] op_sel_hi:[1,1]
    v_pk_mul_f32 v[44:45], v[44:45], v[20:21] op_sel:[0,1] op_sel_hi:[1,1]
    v_pk_mul_f32 v[46:47], v[46:47], v[20:21] op_sel:[0,1] op_sel_hi:[1,1]
    v_cvt_pk_bf16_f32 v96, v32, v33
    v_cvt_pk_bf16_f32 v97, v34, v35
    v_cvt_pk_bf16_f32 v98, v36, v37
    v_cvt_pk_bf16_f32 v99, v38, v39
    v_cvt_pk_bf16_f32 v100, v40, v41
    v_cvt_pk_bf16_f32 v101, v42, v43
    v_cvt_pk_bf16_f32 v102, v44, v45
    v_cvt_pk_bf16_f32 v103, v46, v47
    v_mfma_f32_32x32x16_bf16 v[80:95], a[248:251], v[96:99], 0
    s_nop 0
    v_mfma_f32_32x32x16_bf16 v[80:95], a[252:255], v[100:103], v[80:95]
    v_mul_f32 v48, v48, v21
    v_mul_f32 v49, v49, v21
    v_mul_f32 v50, v50, v21
    v_mul_f32 v51, v51, v21
    v_mul_f32 v52, v52, v21
    v_mul_f32 v53, v53, v21
    v_mul_f32 v54, v54, v21
    v_mul_f32 v55, v55, v21
    v_mul_f32 v56, v56, v21
    v_mul_f32 v57, v57, v21
    v_mul_f32 v58, v58, v21
    v_mul_f32 v59, v59, v21
    v_mul_f32 v60, v60, v21
    v_mul_f32 v61, v61, v21
    v_mul_f32 v62, v62, v21
    v_mul_f32 v63, v63, v21
    v_cvt_pk_bf16_f32 v104, v48, v49
    v_cvt_pk_bf16_f32 v105, v50, v51
    v_cvt_pk_bf16_f32 v106, v52, v53
    v_cvt_pk_bf16_f32 v107, v54, v55
    v_cvt_pk_bf16_f32 v108, v56, v57
    v_cvt_pk_bf16_f32 v109, v58, v59
    v_cvt_pk_bf16_f32 v110, v60, v61
    v_cvt_pk_bf16_f32 v111, v62, v63
    ds_write_b64 v112, v[104:105] offset:0
    ds_write_b64 v112, v[106:107] offset:16
    ds_write_b64 v112, v[108:109] offset:32
    ds_write_b64 v112, v[110:111] offset:48
    ds_write_b64 v112, v[114:115] offset:64
    ds_write_b64 v112, v[114:115] offset:80
    v_max3_f32 v24, v80, v81, v82
    v_min3_f32 v26, v80, v81, v82
    v_max3_f32 v24, v24, v83, v84
    v_min3_f32 v26, v26, v83, v84
    v_max3_f32 v24, v24, v85, v86
    s_add_u32 s99, s61, 0
    s_add_u32 m0, s62, 65536
    s_nop 0
    buffer_load_dwordx4 v5, s[12:15], s99 offen lds
    v_min3_f32 v26, v26, v85, v86
    v_max_f32 v24, v24, v87
    v_min_f32 v26, v26, v87
    v_mov_b32 v25, v24
    v_mov_b32 v27, v26
    v_nop
    v_permlane32_swap_b32 v24, v25
    v_permlane32_swap_b32 v26, v27
    v_max_f32 v24, v24, v25
    v_min_f32 v26, v26, v27
    v_mul_f32 v24, s50, v24
    v_mul_f32 v26, s50, v26
    s_add_u32 s99, s61, 49152
    s_add_u32 m0, s62, 66560
    s_nop 0
    buffer_load_dwordx4 v5, s[12:15], s99 offen lds
    v_pk_fma_f32 v[64:65], v[80:81], s[50:51], v[24:25] op_sel_hi:[1,0,0] neg_lo:[0,0,1] neg_hi:[0,0,1]
    v_pk_fma_f32 v[72:73], v[80:81], s[50:51], v[26:27] op_sel_hi:[1,0,0] neg_lo:[1,0,0] neg_hi:[1,0,0]
    v_pk_fma_f32 v[66:67], v[82:83], s[50:51], v[24:25] op_sel_hi:[1,0,0] neg_lo:[0,0,1] neg_hi:[0,0,1]
    v_pk_fma_f32 v[74:75], v[82:83], s[50:51], v[26:27] op_sel_hi:[1,0,0] neg_lo:[1,0,0] neg_hi:[1,0,0]
    v_pk_fma_f32 v[68:69], v[84:85], s[50:51], v[24:25] op_sel_hi:[1,0,0] neg_lo:[0,0,1] neg_hi:[0,0,1]
    v_pk_fma_f32 v[76:77], v[84:85], s[50:51], v[26:27] op_sel_hi:[1,0,0] neg_lo:[1,0,0] neg_hi:[1,0,0]
    v_pk_fma_f32 v[70:71], v[86:87], s[50:51], v[24:25] op_sel_hi:[1,0,0] neg_lo:[0,0,1] neg_hi:[0,0,1]
    v_pk_fma_f32 v[78:79], v[86:87], s[50:51], v[26:27] op_sel_hi:[1,0,0] neg_lo:[1,0,0] neg_hi:[1,0,0]
    v_exp_f32 v64, v64
    v_exp_f32 v72, v72
    v_exp_f32 v65, v65
    v_exp_f32 v73, v73
    s_add_u32 s99, s61, 98304
    s_add_u32 m0, s62, 67584
    s_nop 0
    buffer_load_dwordx4 v5, s[12:15], s99 offen lds
    v_exp_f32 v66, v66
    v_exp_f32 v74, v74
    v_exp_f32 v67, v67
    v_exp_f32 v75, v75
    v_exp_f32 v68, v68
    v_exp_f32 v76, v76
    v_exp_f32 v69, v69
    v_exp_f32 v77, v77
    v_exp_f32 v70, v70
    v_exp_f32 v78, v78
    v_exp_f32 v71, v71
    v_exp_f32 v79, v79
    s_add_u32 s99, s61, 147456
    s_add_u32 m0, s62, 68608
    s_nop 0
    buffer_load_dwordx4 v5, s[12:15], s99 offen lds
    v_pk_add_f32 v[24:25], v[64:65], v[66:67]
    v_pk_add_f32 v[26:27], v[72:73], v[74:75]
    v_pk_add_f32 v[24:25], v[24:25], v[68:69]
    v_pk_add_f32 v[26:27], v[26:27], v[76:77]
    v_pk_add_f32 v[24:25], v[24:25], v[70:71]
    v_pk_add_f32 v[26:27], v[26:27], v[78:79]
    v_add_f32 v28, v24, v25
    v_add_f32 v29, v26, v27
    v_mov_b32 v25, v28
    v_mov_b32 v27, v29
    v_nop
    v_permlane32_swap_b32 v28, v25
    s_add_u32 s99, s61, 196608
    s_add_u32 m0, s62, 69632
    s_nop 0
    buffer_load_dwordx4 v5, s[12:15], s99 offen lds
    v_permlane32_swap_b32 v29, v27
    v_add_f32 v28, v28, v25
    v_add_f32 v29, v29, v27
    v_rcp_f32 v24, v28
    v_rcp_f32 v26, v29
    v_nop
    v_pk_mul_f32 v[64:65], v[64:65], v[24:25] op_sel_hi:[1,0]
    v_pk_mul_f32 v[72:73], v[72:73], v[26:27] op_sel_hi:[1,0]
    v_pk_mul_f32 v[66:67], v[66:67], v[24:25] op_sel_hi:[1,0]
    v_pk_mul_f32 v[74:75], v[74:75], v[26:27] op_sel_hi:[1,0]
    v_pk_mul_f32 v[68:69], v[68:69], v[24:25] op_sel_hi:[1,0]
    v_pk_mul_f32 v[76:77], v[76:77], v[26:27] op_sel_hi:[1,0]
    s_add_u32 s99, s61, 245760
    s_add_u32 m0, s62, 70656
    s_nop 0
    buffer_load_dwordx4 v5, s[12:15], s99 offen lds
    v_pk_mul_f32 v[70:71], v[70:71], v[24:25] op_sel_hi:[1,0]
    v_pk_mul_f32 v[78:79], v[78:79], v[26:27] op_sel_hi:[1,0]
    v_cvt_pk_bf16_f32 v32, v64, v65
    v_cvt_pk_bf16_f32 v36, v72, v73
    v_cvt_pk_bf16_f32 v33, v66, v67
    v_cvt_pk_bf16_f32 v37, v74, v75
    v_cvt_pk_bf16_f32 v34, v68, v69
    v_cvt_pk_bf16_f32 v38, v76, v77
    v_cvt_pk_bf16_f32 v35, v70, v71
    v_cvt_pk_bf16_f32 v39, v78, v79
    v_max3_f32 v24, v88, v89, v90
    v_min3_f32 v26, v88, v89, v90
    s_add_u32 s99, s61, 294912
    s_add_u32 m0, s62, 71680
    s_nop 0
    buffer_load_dwordx4 v5, s[12:15], s99 offen lds
    v_max3_f32 v24, v24, v91, v92
    v_min3_f32 v26, v26, v91, v92
    v_max3_f32 v24, v24, v93, v94
    v_min3_f32 v26, v26, v93, v94
    v_max_f32 v24, v24, v95
    v_min_f32 v26, v26, v95
    v_mov_b32 v25, v24
    v_mov_b32 v27, v26
    v_nop
    v_permlane32_swap_b32 v24, v25
    v_permlane32_swap_b32 v26, v27
    v_max_f32 v24, v24, v25
    s_add_u32 s99, s61, 344064
    s_add_u32 m0, s62, 72704
    s_nop 0
    buffer_load_dwordx4 v5, s[12:15], s99 offen lds
    v_min_f32 v26, v26, v27
    v_mul_f32 v24, s50, v24
    v_mul_f32 v26, s50, v26
    v_pk_fma_f32 v[64:65], v[88:89], s[50:51], v[24:25] op_sel_hi:[1,0,0] neg_lo:[0,0,1] neg_hi:[0,0,1]
    v_pk_fma_f32 v[72:73], v[88:89], s[50:51], v[26:27] op_sel_hi:[1,0,0] neg_lo:[1,0,0] neg_hi:[1,0,0]
    v_pk_fma_f32 v[66:67], v[90:91], s[50:51], v[24:25] op_sel_hi:[1,0,0] neg_lo:[0,0,1] neg_hi:[0,0,1]
    v_pk_fma_f32 v[74:75], v[90:91], s[50:51], v[26:27] op_sel_hi:[1,0,0] neg_lo:[1,0,0] neg_hi:[1,0,0]
    v_pk_fma_f32 v[68:69], v[92:93], s[50:51], v[24:25] op_sel_hi:[1,0,0] neg_lo:[0,0,1] neg_hi:[0,0,1]
    v_pk_fma_f32 v[76:77], v[92:93], s[50:51], v[26:27] op_sel_hi:[1,0,0] neg_lo:[1,0,0] neg_hi:[1,0,0]
    v_pk_fma_f32 v[70:71], v[94:95], s[50:51], v[24:25] op_sel_hi:[1,0,0] neg_lo:[0,0,1] neg_hi:[0,0,1]
    v_pk_fma_f32 v[78:79], v[94:95], s[50:51], v[26:27] op_sel_hi:[1,0,0] neg_lo:[1,0,0] neg_hi:[1,0,0]
    v_exp_f32 v64, v64
    v_exp_f32 v72, v72
    v_exp_f32 v65, v65
    v_exp_f32 v73, v73
    v_exp_f32 v66, v66
    v_exp_f32 v74, v74
    v_exp_f32 v67, v67
    v_exp_f32 v75, v75
    v_exp_f32 v68, v68
    v_exp_f32 v76, v76
    v_exp_f32 v69, v69
    v_exp_f32 v77, v77
    v_exp_f32 v70, v70
    v_exp_f32 v78, v78
    v_exp_f32 v71, v71
    v_exp_f32 v79, v79
    v_pk_add_f32 v[24:25], v[64:65], v[66:67]
    v_pk_add_f32 v[26:27], v[72:73], v[74:75]
    v_pk_add_f32 v[24:25], v[24:25], v[68:69]
    v_pk_add_f32 v[26:27], v[26:27], v[76:77]
    v_pk_add_f32 v[24:25], v[24:25], v[70:71]
    v_pk_add_f32 v[26:27], v[26:27], v[78:79]
    v_add_f32 v28, v24, v25
    v_add_f32 v29, v26, v27
    v_mov_b32 v25, v28
    v_mov_b32 v27, v29
    v_nop
    v_permlane32_swap_b32 v28, v25
    v_permlane32_swap_b32 v29, v27
    v_add_f32 v28, v28, v25
    v_add_f32 v29, v29, v27
    v_rcp_f32 v24, v28
    v_rcp_f32 v26, v29
    v_nop
    v_pk_mul_f32 v[64:65], v[64:65], v[24:25] op_sel_hi:[1,0]
    v_pk_mul_f32 v[72:73], v[72:73], v[26:27] op_sel_hi:[1,0]
    v_pk_mul_f32 v[66:67], v[66:67], v[24:25] op_sel_hi:[1,0]
    v_pk_mul_f32 v[74:75], v[74:75], v[26:27] op_sel_hi:[1,0]
    v_pk_mul_f32 v[68:69], v[68:69], v[24:25] op_sel_hi:[1,0]
    v_pk_mul_f32 v[76:77], v[76:77], v[26:27] op_sel_hi:[1,0]
    v_pk_mul_f32 v[70:71], v[70:71], v[24:25] op_sel_hi:[1,0]
    v_pk_mul_f32 v[78:79], v[78:79], v[26:27] op_sel_hi:[1,0]
    v_cvt_pk_bf16_f32 v40, v64, v65
    v_cvt_pk_bf16_f32 v44, v72, v73
    v_cvt_pk_bf16_f32 v41, v66, v67
    v_cvt_pk_bf16_f32 v45, v74, v75
    v_cvt_pk_bf16_f32 v42, v68, v69
    v_cvt_pk_bf16_f32 v46, v76, v77
    v_cvt_pk_bf16_f32 v43, v70, v71
    v_cvt_pk_bf16_f32 v47, v78, v79
    ds_write_b64 v113, v[32:33] offset:0
    ds_write_b64 v113, v[34:35] offset:16
    ds_write_b64 v113, v[36:37] offset:32
    ds_write_b64 v113, v[38:39] offset:48
    ds_write_b64 v113, v[40:41] offset:64
    ds_write_b64 v113, v[42:43] offset:80
    ds_write_b64 v113, v[44:45] offset:96
    ds_write_b64 v113, v[46:47] offset:112
    s_waitcnt vmcnt(8)
    s_waitcnt lgkmcnt(0)
    s_barrier
    s_cmp_ge_u32 s44, 2
    s_cbranch_scc1 W23_41
    ds_read_b64_tr_b16 v[32:33], v116 offset:0
    ds_read_b64_tr_b16 v[34:35], v116 offset:544
    ds_read_b64_tr_b16 v[36:37], v117 offset:0
    ds_read_b64_tr_b16 v[38:39], v117 offset:416
    ds_read_b64_tr_b16 v[40:41], v116 offset:2176
    ds_read_b64_tr_b16 v[42:43], v116 offset:2720
    ds_read_b64_tr_b16 v[44:45], v117 offset:1664
    ds_read_b64_tr_b16 v[46:47], v117 offset:2080
    ds_read_b64_tr_b16 v[48:49], v116 offset:4352
    ds_read_b64_tr_b16 v[50:51], v116 offset:4896
    ds_read_b64_tr_b16 v[52:53], v117 offset:3328
    ds_read_b64_tr_b16 v[54:55], v117 offset:3744
    s_lshl_b32 s74, s46, 4
    s_add_u32 s74, s74, s45
    s_mul_i32 s74, s74, 4352
    s_mul_i32 s75, s44, 2176
    s_add_u32 s74, s74, s75
    s_add_u32 s74, s74, 524288
    s_waitcnt lgkmcnt(8)
    v_mfma_f32_32x32x16_bf16 v[80:95], v[32:35], v[36:39], 0
    ds_read_b64_tr_b16 v[56:57], v116 offset:6528
    ds_read_b64_tr_b16 v[58:59], v116 offset:7072
    ds_read_b64_tr_b16 v[60:61], v117 offset:4992
    ds_read_b64_tr_b16 v[62:63], v117 offset:5408
    s_waitcnt lgkmcnt(8)
    v_mfma_f32_32x32x16_bf16 v[80:95], v[40:43], v[44:47], v[80:95]
    ds_read_b64_tr_b16 v[64:65], v116 offset:8704
    ds_read_b64_tr_b16 v[66:67], v116 offset:9248
    ds_read_b64_tr_b16 v[68:69], v117 offset:6656
    ds_read_b64_tr_b16 v[70:71], v117 offset:7072
    s_waitcnt lgkmcnt(8)
    v_mfma_f32_32x32x16_bf16 v[80:95], v[48:51], v[52:55], v[80:95]
    ds_read_b64_tr_b16 v[72:73], v116 offset:10880
    ds_read_b64_tr_b16 v[74:75], v116 offset:11424
    ds_read_b64_tr_b16 v[76:77], v117 offset:8320
    ds_read_b64_tr_b16 v[78:79], v117 offset:8736
    s_waitcnt lgkmcnt(8)
    v_mfma_f32_32x32x16_bf16 v[80:95], v[56:59], v[60:63], v[80:95]
    ds_read_b64_tr_b16 v[96:97], v116 offset:13056
    ds_read_b64_tr_b16 v[98:99], v116 offset:13600
    ds_read_b64_tr_b16 v[100:101], v117 offset:9984
    ds_read_b64_tr_b16 v[102:103], v117 offset:10400
    s_waitcnt lgkmcnt(8)
    v_mfma_f32_32x32x16_bf16 v[80:95], v[64:67], v[68:71], v[80:95]
    ds_read_b64_tr_b16 v[104:105], v116 offset:15232
    ds_read_b64_tr_b16 v[106:107], v116 offset:15776
    ds_read_b64_tr_b16 v[108:109], v117 offset:11648
    ds_read_b64_tr_b16 v[110:111], v117 offset:12064
    s_waitcnt lgkmcnt(8)
    v_mfma_f32_32x32x16_bf16 v[80:95], v[72:75], v[76:79], v[80:95]
    s_waitcnt lgkmcnt(4)
    v_mfma_f32_32x32x16_bf16 v[80:95], v[96:99], v[100:103], v[80:95]
    s_waitcnt lgkmcnt(0)
    v_mfma_f32_32x32x16_bf16 v[80:95], v[104:107], v[108:111], v[80:95]
    s_mov_b64 s[58:59], exec
    s_mov_b32 exec_lo, 0x1ffff
    s_mov_b32 exec_hi, 0x1ffff
    s_nop 8
    buffer_store_dwordx4 v[80:83], v118, s[32:35], s74 offen offset:0 sc1
    buffer_store_dwordx4 v[84:87], v118, s[32:35], s74 offen offset:544 sc1
    buffer_store_dwordx4 v[88:91], v118, s[32:35], s74 offen offset:1088 sc1
    buffer_store_dwordx4 v[92:95], v118, s[32:35], s74 offen offset:1632 sc1
    s_mov_b64 exec, s[58:59]
    v_lshlrev_b32 v119, 8, v3
    v_add_u32 v119, v119, v13
    s_waitcnt vmcnt(4)
    s_barrier
    v_mov_b32 v120, 0x3f803f80
    v_mov_b32 v121, 0x3f803f80
    v_mov_b32 v122, 0x3f803f80
    v_mov_b32 v123, 0x3f803f80
    ds_read_b64_tr_b16 v[96:97], v119 offset:0
    ds_read_b64_tr_b16 v[98:99], v119 offset:256
    ds_read_b64_tr_b16 v[100:101], v119 offset:1024
    ds_read_b64_tr_b16 v[102:103], v119 offset:1280
    s_waitcnt lgkmcnt(2)
    v_mfma_f32_32x32x16_bf16 v[64:79], v[96:99], v[128:131], 0
    s_cmp_lg_u32 s44, 0
    s_cbranch_scc1 CSQ_43
    v_mfma_f32_32x32x16_bf16 v[48:63], v[120:123], v[96:99], 0
CSQ_43:
    ds_read_b64_tr_b16 v[104:105], v119 offset:2048
    ds_read_b64_tr_b16 v[106:107], v119 offset:2304
    s_add_u32 s99, s65, 0
    s_add_u32 m0, s62, 0
    s_nop 0
    buffer_load_dwordx4 v7, s[20:23], s99 offen lds
    s_waitcnt lgkmcnt(2)
    v_mfma_f32_32x32x16_bf16 v[64:79], v[100:103], v[132:135], v[64:79]
    s_cmp_lg_u32 s44, 1
    s_cbranch_scc1 CSQ_44
    s_nop 1
    v_mfma_f32_32x32x16_bf16 v[48:63], v[120:123], v[100:103], 0
CSQ_44:
    ds_read_b64_tr_b16 v[108:109], v119 offset:3072
    ds_read_b64_tr_b16 v[110:111], v119 offset:3328
    s_waitcnt lgkmcnt(2)
    v_mfma_f32_32x32x16_bf16 v[64:79], v[104:107], v[136:139], v[64:79]
    s_cmp_lg_u32 s44, 2
    s_cbranch_scc1 CSQ_45
    s_nop 5
    v_mfma_f32_32x32x16_bf16 v[48:63], v[120:123], v[104:107], 0
CSQ_45:
    ds_read_b64_tr_b16 v[96:97], v119 offset:4096
    ds_read_b64_tr_b16 v[98:99], v119 offset:4352
    s_add_u32 s99, s65, 28672
    s_add_u32 m0, s62, 1024
    s_nop 0
    buffer_load_dwordx4 v7, s[20:23], s99 offen lds
    s_waitcnt lgkmcnt(2)
    v_mfma_f32_32x32x16_bf16 v[64:79], v[108:111], v[140:143], v[64:79]
    s_cmp_lg_u32 s44, 3
    s_cbranch_scc1 CSQ_46
    s_nop 1
    v_mfma_f32_32x32x16_bf16 v[48:63], v[120:123], v[108:111], 0
CSQ_46:
    ds_read_b64_tr_b16 v[100:101], v119 offset:5120
    ds_read_b64_tr_b16 v[102:103], v119 offset:5376
    s_waitcnt lgkmcnt(2)
    v_mfma_f32_32x32x16_bf16 v[64:79], v[96:99], v[144:147], v[64:79]
    s_cmp_lg_u32 s44, 0
    s_cbranch_scc1 CSQ_47
    v_mfma_f32_32x32x16_bf16 v[48:63], v[120:123], v[96:99], v[48:63]
CSQ_47:
    ds_read_b64_tr_b16 v[104:105], v119 offset:6144
    ds_read_b64_tr_b16 v[106:107], v119 offset:6400
    s_add_u32 s99, s65, 57344
    s_add_u32 m0, s62, 2048
    s_nop 0
    buffer_load_dwordx4 v7, s[20:23], s99 offen lds
    s_waitcnt lgkmcnt(2)
    v_mfma_f32_32x32x16_bf16 v[64:79], v[100:103], v[148:151], v[64:79]
    s_cmp_lg_u32 s44, 1
    s_cbranch_scc1 CSQ_48
    v_mfma_f32_32x32x16_bf16 v[48:63], v[120:123], v[100:103], v[48:63]
CSQ_48:
    ds_read_b64_tr_b16 v[108:109], v119 offset:7168
    ds_read_b64_tr_b16 v[110:111], v119 offset:7424
    s_waitcnt lgkmcnt(2)
    v_mfma_f32_32x32x16_bf16 v[64:79], v[104:107], v[152:155], v[64:79]
    s_cmp_lg_u32 s44, 2
    s_cbranch_scc1 CSQ_49
    v_mfma_f32_32x32x16_bf16 v[48:63], v[120:123], v[104:107], v[48:63]
CSQ_49:
    ds_read_b64_tr_b16 v[96:97], v119 offset:8192
    ds_read_b64_tr_b16 v[98:99], v119 offset:8448
    s_add_u32 s99, s65, 86016
    s_add_u32 m0, s62, 3072
    s_nop 0
    buffer_load_dwordx4 v7, s[20:23], s99 offen lds
    s_waitcnt lgkmcnt(2)
    v_mfma_f32_32x32x16_bf16 v[64:79], v[108:111], v[156:159], v[64:79]
    s_cmp_lg_u32 s44, 3
    s_cbranch_scc1 CSQ_50
    v_mfma_f32_32x32x16_bf16 v[48:63], v[120:123], v[108:111], v[48:63]
CSQ_50:
    ds_read_b64_tr_b16 v[100:101], v119 offset:9216
    ds_read_b64_tr_b16 v[102:103], v119 offset:9472
    s_waitcnt lgkmcnt(2)
    v_mfma_f32_32x32x16_bf16 v[64:79], v[96:99], v[160:163], v[64:79]
    s_cmp_lg_u32 s44, 0
    s_cbranch_scc1 CSQ_51
    v_mfma_f32_32x32x16_bf16 v[48:63], v[120:123], v[96:99], v[48:63]
CSQ_51:
    ds_read_b64_tr_b16 v[104:105], v119 offset:10240
    ds_read_b64_tr_b16 v[106:107], v119 offset:10496
    s_add_u32 s99, s65, 114688
    s_add_u32 m0, s62, 4096
    s_nop 0
    buffer_load_dwordx4 v7, s[20:23], s99 offen lds
    s_waitcnt lgkmcnt(2)
    v_mfma_f32_32x32x16_bf16 v[64:79], v[100:103], v[164:167], v[64:79]
    s_cmp_lg_u32 s44, 1
    s_cbranch_scc1 CSQ_52
    v_mfma_f32_32x32x16_bf16 v[48:63], v[120:123], v[100:103], v[48:63]
CSQ_52:
    ds_read_b64_tr_b16 v[108:109], v119 offset:11264
    ds_read_b64_tr_b16 v[110:111], v119 offset:11520
    s_waitcnt lgkmcnt(2)
    v_mfma_f32_32x32x16_bf16 v[64:79], v[104:107], v[168:171], v[64:79]
    s_cmp_lg_u32 s44, 2
    s_cbranch_scc1 CSQ_53
    v_mfma_f32_32x32x16_bf16 v[48:63], v[120:123], v[104:107], v[48:63]
CSQ_53:
    ds_read_b64_tr_b16 v[96:97], v119 offset:12288
    ds_read_b64_tr_b16 v[98:99], v119 offset:12544
    s_add_u32 s99, s65, 143360
    s_add_u32 m0, s62, 5120
    s_nop 0
    buffer_load_dwordx4 v7, s[20:23], s99 offen lds
    s_waitcnt lgkmcnt(2)
    v_mfma_f32_32x32x16_bf16 v[64:79], v[108:111], v[172:175], v[64:79]
    s_cmp_lg_u32 s44, 3
    s_cbranch_scc1 CSQ_54
    v_mfma_f32_32x32x16_bf16 v[48:63], v[120:123], v[108:111], v[48:63]
CSQ_54:
    ds_read_b64_tr_b16 v[100:101], v119 offset:13312
    ds_read_b64_tr_b16 v[102:103], v119 offset:13568
    s_waitcnt lgkmcnt(2)
    v_mfma_f32_32x32x16_bf16 v[64:79], v[96:99], v[176:179], v[64:79]
    s_cmp_lg_u32 s44, 0
    s_cbranch_scc1 CSQ_55
    v_mfma_f32_32x32x16_bf16 v[48:63], v[120:123], v[96:99], v[48:63]
CSQ_55:
    ds_read_b64_tr_b16 v[104:105], v119 offset:14336
    ds_read_b64_tr_b16 v[106:107], v119 offset:14592
    s_add_u32 s99, s65, 172032
    s_add_u32 m0, s62, 6144
    s_nop 0
    buffer_load_dwordx4 v7, s[20:23], s99 offen lds
    s_waitcnt lgkmcnt(2)
    v_mfma_f32_32x32x16_bf16 v[64:79], v[100:103], v[180:183], v[64:79]
    s_cmp_lg_u32 s44, 1
    s_cbranch_scc1 CSQ_56
    v_mfma_f32_32x32x16_bf16 v[48:63], v[120:123], v[100:103], v[48:63]
CSQ_56:
    ds_read_b64_tr_b16 v[108:109], v119 offset:15360
    ds_read_b64_tr_b16 v[110:111], v119 offset:15616
    s_waitcnt lgkmcnt(2)
    v_mfma_f32_32x32x16_bf16 v[64:79], v[104:107], v[184:187], v[64:79]
    s_cmp_lg_u32 s44, 2
    s_cbranch_scc1 CSQ_57
    v_mfma_f32_32x32x16_bf16 v[48:63], v[120:123], v[104:107], v[48:63]
CSQ_57:
    ds_read_b64_tr_b16 v[96:97], v119 offset:16384
    ds_read_b64_tr_b16 v[98:99], v119 offset:16640
    s_add_u32 s99, s65, 200704
    s_add_u32 m0, s62, 7168
    s_nop 0
    buffer_load_dwordx4 v7, s[20:23], s99 offen lds
    s_waitcnt lgkmcnt(2)
    v_mfma_f32_32x32x16_bf16 v[64:79], v[108:111], v[188:191], v[64:79]
    s_cmp_lg_u32 s44, 3
    s_cbranch_scc1 CSQ_58
    v_mfma_f32_32x32x16_bf16 v[48:63], v[120:123], v[108:111], v[48:63]
CSQ_58:
    ds_read_b64_tr_b16 v[100:101], v119 offset:17408
    ds_read_b64_tr_b16 v[102:103], v119 offset:17664
    s_waitcnt lgkmcnt(2)
    v_mfma_f32_32x32x16_bf16 v[64:79], v[96:99], v[192:195], v[64:79]
    s_cmp_lg_u32 s44, 0
    s_cbranch_scc1 CSQ_59
    v_mfma_f32_32x32x16_bf16 v[48:63], v[120:123], v[96:99], v[48:63]
CSQ_59:
    ds_read_b64_tr_b16 v[104:105], v119 offset:18432
    ds_read_b64_tr_b16 v[106:107], v119 offset:18688
    s_lshl_b32 s76, s72, 15
    s_lshl_b32 s77, s73, 6
    s_add_u32 s76, s76, s77
    v_lshlrev_b32 v25, 10, v2
    v_lshl_add_u32 v25, v3, 3, v25
    buffer_load_dwordx2 a[240:241], v25, s[8:11], s76 offen offset:0
    buffer_load_dwordx2 a[242:243], v25, s[8:11], s76 offen offset:16
    buffer_load_dwordx2 a[244:245], v25, s[8:11], s76 offen offset:32
    buffer_load_dwordx2 a[246:247], v25, s[8:11], s76 offen offset:48
    s_waitcnt lgkmcnt(2)
    v_mfma_f32_32x32x16_bf16 v[64:79], v[100:103], v[196:199], v[64:79]
    s_cmp_lg_u32 s44, 1
    s_cbranch_scc1 CSQ_60
    v_mfma_f32_32x32x16_bf16 v[48:63], v[120:123], v[100:103], v[48:63]
CSQ_60:
    ds_read_b64_tr_b16 v[108:109], v119 offset:19456
    ds_read_b64_tr_b16 v[110:111], v119 offset:19712
    s_waitcnt lgkmcnt(2)
    v_mfma_f32_32x32x16_bf16 v[64:79], v[104:107], v[200:203], v[64:79]
    s_cmp_lg_u32 s44, 2
    s_cbranch_scc1 CSQ_61
    v_mfma_f32_32x32x16_bf16 v[48:63], v[120:123], v[104:107], v[48:63]
CSQ_61:
    ds_read_b64_tr_b16 v[96:97], v119 offset:20480
    ds_read_b64_tr_b16 v[98:99], v119 offset:20736
    s_waitcnt lgkmcnt(2)
    v_mfma_f32_32x32x16_bf16 v[64:79], v[108:111], v[204:207], v[64:79]
    s_cmp_lg_u32 s44, 3
    s_cbranch_scc1 CSQ_62
    v_mfma_f32_32x32x16_bf16 v[48:63], v[120:123], v[108:111], v[48:63]
CSQ_62:
    ds_read_b64_tr_b16 v[100:101], v119 offset:21504
    ds_read_b64_tr_b16 v[102:103], v119 offset:21760
    s_waitcnt lgkmcnt(2)
    v_mfma_f32_32x32x16_bf16 v[64:79], v[96:99], v[208:211], v[64:79]
    s_cmp_lg_u32 s44, 0
    s_cbranch_scc1 CSQ_63
    v_mfma_f32_32x32x16_bf16 v[48:63], v[120:123], v[96:99], v[48:63]
CSQ_63:
    ds_read_b64_tr_b16 v[104:105], v119 offset:22528
    ds_read_b64_tr_b16 v[106:107], v119 offset:22784
    s_waitcnt vmcnt(12)
    v_accvgpr_read_b32 v23, a233
    s_nop 0
    v_readfirstlane_b32 s74, v23
    s_nop 1
    s_cmp_ge_u32 s74, 64
    s_cbranch_scc1 ID_65
    s_mov_b32 s60, 0
IL_64:
    s_sleep 16
    s_buffer_load_dword s4, s[36:39], 0 glc
    s_add_u32 s60, s60, 1
    s_cmp_gt_u32 s60, 0x80000
    s_cbranch_scc1 L_bail
    s_waitcnt lgkmcnt(0)
    s_cmp_lt_u32 s4, 64
    s_cbranch_scc1 IL_64
ID_65:
    s_mov_b64 s[58:59], exec
    s_mov_b32 exec_lo, 65535
    s_mov_b32 exec_hi, 0
    v_mov_b32 v24, 1
    buffer_atomic_add v24, v8, s[32:35], 0 offen offset:0 sc1
    s_mov_b64 exec, s[58:59]
    s_waitcnt lgkmcnt(2)
    v_mfma_f32_32x32x16_bf16 v[64:79], v[100:103], v[212:215], v[64:79]
    s_cmp_lg_u32 s44, 1
    s_cbranch_scc1 CSQ_66
    v_mfma_f32_32x32x16_bf16 v[48:63], v[120:123], v[100:103], v[48:63]
CSQ_66:
    ds_read_b64_tr_b16 v[108:109], v119 offset:23552
    ds_read_b64_tr_b16 v[110:111], v119 offset:23808
    s_waitcnt lgkmcnt(2)
    v_mfma_f32_32x32x16_bf16 v[64:79], v[104:107], v[216:219], v[64:79]
    s_cmp_lg_u32 s44, 2
    s_cbranch_scc1 CSQ_67
    v_mfma_f32_32x32x16_bf16 v[48:63], v[120:123], v[104:107], v[48:63]
CSQ_67:
    ds_read_b64_tr_b16 v[96:97], v119 offset:24576
    ds_read_b64_tr_b16 v[98:99], v119 offset:24832
    s_waitcnt lgkmcnt(2)
    v_mfma_f32_32x32x16_bf16 v[64:79], v[108:111], v[220:223], v[64:79]
    s_cmp_lg_u32 s44, 3
    s_cbranch_scc1 CSQ_68
    v_mfma_f32_32x32x16_bf16 v[48:63], v[120:123], v[108:111], v[48:63]
CSQ_68:
    ds_read_b64_tr_b16 v[100:101], v119 offset:25600
    ds_read_b64_tr_b16 v[102:103], v119 offset:25856
    s_waitcnt lgkmcnt(2)
    v_mfma_f32_32x32x16_bf16 v[64:79], v[96:99], v[224:227], v[64:79]
    s_cmp_lg_u32 s44, 0
    s_cbranch_scc1 CSQ_69
    v_mfma_f32_32x32x16_bf16 v[48:63], v[120:123], v[96:99], v[48:63]
CSQ_69:
    ds_read_b64_tr_b16 v[104:105], v119 offset:26624
    ds_read_b64_tr_b16 v[106:107], v119 offset:26880
    s_waitcnt lgkmcnt(2)
    v_mfma_f32_32x32x16_bf16 v[64:79], v[100:103], v[228:231], v[64:79]
    s_cmp_lg_u32 s44, 1
    s_cbranch_scc1 CSQ_70
    v_mfma_f32_32x32x16_bf16 v[48:63], v[120:123], v[100:103], v[48:63]
CSQ_70:
    ds_read_b64_tr_b16 v[108:109], v119 offset:27648
    ds_read_b64_tr_b16 v[110:111], v119 offset:27904
    s_waitcnt lgkmcnt(2)
    v_mfma_f32_32x32x16_bf16 v[64:79], v[104:107], v[232:235], v[64:79]
    s_cmp_lg_u32 s44, 2
    s_cbranch_scc1 CSQ_71
    v_mfma_f32_32x32x16_bf16 v[48:63], v[120:123], v[104:107], v[48:63]
CSQ_71:
    ds_read_b64_tr_b16 v[96:97], v119 offset:28672
    ds_read_b64_tr_b16 v[98:99], v119 offset:28928
    s_waitcnt lgkmcnt(2)
    v_mfma_f32_32x32x16_bf16 v[64:79], v[108:111], v[236:239], v[64:79]
    s_cmp_lg_u32 s44, 3
    s_cbranch_scc1 CSQ_72
    v_mfma_f32_32x32x16_bf16 v[48:63], v[120:123], v[108:111], v[48:63]
CSQ_72:
    ds_read_b64_tr_b16 v[100:101], v119 offset:29696
    ds_read_b64_tr_b16 v[102:103], v119 offset:29952
    s_waitcnt lgkmcnt(2)
    v_mfma_f32_32x32x16_bf16 v[64:79], v[96:99], v[240:243], v[64:79]
    s_cmp_lg_u32 s44, 0
    s_cbranch_scc1 CSQ_73
    v_mfma_f32_32x32x16_bf16 v[48:63], v[120:123], v[96:99], v[48:63]
CSQ_73:
    ds_read_b64_tr_b16 v[104:105], v119 offset:30720
    ds_read_b64_tr_b16 v[106:107], v119 offset:30976
    s_waitcnt lgkmcnt(2)
    v_mfma_f32_32x32x16_bf16 v[64:79], v[100:103], v[244:247], v[64:79]
    s_cmp_lg_u32 s44, 1
    s_cbranch_scc1 CSQ_74
    v_mfma_f32_32x32x16_bf16 v[48:63], v[120:123], v[100:103], v[48:63]
CSQ_74:
    ds_read_b64_tr_b16 v[108:109], v119 offset:31744
    ds_read_b64_tr_b16 v[110:111], v119 offset:32000
    s_waitcnt lgkmcnt(2)
    v_mfma_f32_32x32x16_bf16 v[64:79], v[104:107], v[248:251], v[64:79]
    s_cmp_lg_u32 s44, 2
    s_cbranch_scc1 CSQ_75
    v_mfma_f32_32x32x16_bf16 v[48:63], v[120:123], v[104:107], v[48:63]
CSQ_75:
    s_waitcnt lgkmcnt(0)
    v_mfma_f32_32x32x16_bf16 v[64:79], v[108:111], v[252:255], v[64:79]
    s_cmp_lg_u32 s44, 3
    s_cbranch_scc1 CSQ_76
    v_mfma_f32_32x32x16_bf16 v[48:63], v[120:123], v[108:111], v[48:63]
CSQ_76:
    v_lshlrev_b32 v28, 4, v2
    s_lshl_b32 s74, s44, 2
    v_add_u32 v28, s74, v28
    v_add_u32 v28, 36864, v28
    s_nop 7
    ds_write_b32 v28, v48
    s_waitcnt lgkmcnt(0)
    s_barrier
    v_lshlrev_b32 v28, 4, v2
    v_add_u32 v28, 36864, v28
    ds_read_b128 v[96:99], v28
    s_waitcnt lgkmcnt(0)
    v_add_f32 v96, v96, v97
    v_add_f32 v98, v98, v99
    v_add_f32 v96, v96, v98
    v_cndmask_b32 v96, 0, v96, s[54:55]
    v_cvt_pk_bf16_f32 v108, v96, v96
    v_lshlrev_b32 v26, 16, v108
    v_sub_f32 v26, v96, v26
    v_cvt_pk_bf16_f32 v109, v26, v26
    v_accvgpr_write_b32 a228, v108
    v_accvgpr_write_b32 a229, v109
    v_accvgpr_write_b32 a230, 0
    v_accvgpr_write_b32 a231, 0
    s_nop 1
    v_mfma_f32_32x32x16_bf16 v[64:79], a[228:231], v[124:127], v[64:79]
    s_nop 11
    v_pk_mul_f32 v[64:65], v[64:65], v[20:21] op_sel:[0,1] op_sel_hi:[1,1]
    v_pk_mul_f32 v[66:67], v[66:67], v[20:21] op_sel:[0,1] op_sel_hi:[1,1]
    v_pk_mul_f32 v[68:69], v[68:69], v[20:21] op_sel:[0,1] op_sel_hi:[1,1]
    v_pk_mul_f32 v[70:71], v[70:71], v[20:21] op_sel:[0,1] op_sel_hi:[1,1]
    v_pk_mul_f32 v[72:73], v[72:73], v[20:21] op_sel:[0,1] op_sel_hi:[1,1]
    v_pk_mul_f32 v[74:75], v[74:75], v[20:21] op_sel:[0,1] op_sel_hi:[1,1]
    v_pk_mul_f32 v[76:77], v[76:77], v[20:21] op_sel:[0,1] op_sel_hi:[1,1]
    v_pk_mul_f32 v[78:79], v[78:79], v[20:21] op_sel:[0,1] op_sel_hi:[1,1]
    v_cvt_pk_bf16_f32 v96, v64, v65
    v_cvt_pk_bf16_f32 v97, v66, v67
    v_cvt_pk_bf16_f32 v98, v68, v69
    v_cvt_pk_bf16_f32 v99, v70, v71
    v_cvt_pk_bf16_f32 v100, v72, v73
    v_cvt_pk_bf16_f32 v101, v74, v75
    v_cvt_pk_bf16_f32 v102, v76, v77
    v_cvt_pk_bf16_f32 v103, v78, v79
    v_mfma_f32_32x32x16_bf16 v[80:95], a[248:251], v[96:99], 0
    s_nop 0
    v_mfma_f32_32x32x16_bf16 v[80:95], a[252:255], v[100:103], v[80:95]
    s_nop 11
    v_max3_f32 v24, v80, v81, v82
    v_min3_f32 v26, v80, v81, v82
    v_max3_f32 v24, v24, v83, v84
    v_min3_f32 v26, v26, v83, v84
    v_max3_f32 v24, v24, v85, v86
    v_min3_f32 v26, v26, v85, v86
    v_max_f32 v24, v24, v87
    v_min_f32 v26, v26, v87
    v_mov_b32 v25, v24
    v_mov_b32 v27, v26
    v_nop
    v_permlane32_swap_b32 v24, v25
    v_permlane32_swap_b32 v26, v27
    v_max_f32 v24, v24, v25
    v_min_f32 v26, v26, v27
    v_mul_f32 v24, s50, v24
    v_mul_f32 v26, s50, v26
    v_pk_fma_f32 v[64:65], v[80:81], s[50:51], v[24:25] op_sel_hi:[1,0,0] neg_lo:[0,0,1] neg_hi:[0,0,1]
    v_pk_fma_f32 v[72:73], v[80:81], s[50:51], v[26:27] op_sel_hi:[1,0,0] neg_lo:[1,0,0] neg_hi:[1,0,0]
    v_pk_fma_f32 v[66:67], v[82:83], s[50:51], v[24:25] op_sel_hi:[1,0,0] neg_lo:[0,0,1] neg_hi:[0,0,1]
    v_pk_fma_f32 v[74:75], v[82:83], s[50:51], v[26:27] op_sel_hi:[1,0,0] neg_lo:[1,0,0] neg_hi:[1,0,0]
    v_pk_fma_f32 v[68:69], v[84:85], s[50:51], v[24:25] op_sel_hi:[1,0,0] neg_lo:[0,0,1] neg_hi:[0,0,1]
    v_pk_fma_f32 v[76:77], v[84:85], s[50:51], v[26:27] op_sel_hi:[1,0,0] neg_lo:[1,0,0] neg_hi:[1,0,0]
    v_pk_fma_f32 v[70:71], v[86:87], s[50:51], v[24:25] op_sel_hi:[1,0,0] neg_lo:[0,0,1] neg_hi:[0,0,1]
    v_pk_fma_f32 v[78:79], v[86:87], s[50:51], v[26:27] op_sel_hi:[1,0,0] neg_lo:[1,0,0] neg_hi:[1,0,0]
    v_exp_f32 v64, v64
    v_exp_f32 v72, v72
    v_exp_f32 v65, v65
    v_exp_f32 v73, v73
    v_exp_f32 v66, v66
    v_exp_f32 v74, v74
    v_exp_f32 v67, v67
    v_exp_f32 v75, v75
    v_exp_f32 v68, v68
    v_exp_f32 v76, v76
    v_exp_f32 v69, v69
    v_exp_f32 v77, v77
    v_exp_f32 v70, v70
    v_exp_f32 v78, v78
    v_exp_f32 v71, v71
    v_exp_f32 v79, v79
    v_pk_add_f32 v[24:25], v[64:65], v[66:67]
    v_pk_add_f32 v[26:27], v[72:73], v[74:75]
    v_pk_add_f32 v[24:25], v[24:25], v[68:69]
    v_pk_add_f32 v[26:27], v[26:27], v[76:77]
    v_pk_add_f32 v[24:25], v[24:25], v[70:71]
    v_pk_add_f32 v[26:27], v[26:27], v[78:79]
    v_add_f32 v28, v24, v25
    v_add_f32 v29, v26, v27
    v_mov_b32 v25, v28
    v_mov_b32 v27, v29
    v_nop
    v_permlane32_swap_b32 v28, v25
    v_permlane32_swap_b32 v29, v27
    v_add_f32 v28, v28, v25
    v_add_f32 v29, v29, v27
    v_rcp_f32 v24, v28
    v_rcp_f32 v26, v29
    v_nop
    v_pk_mul_f32 v[64:65], v[64:65], v[24:25] op_sel_hi:[1,0]
    v_pk_mul_f32 v[72:73], v[72:73], v[26:27] op_sel_hi:[1,0]
    v_pk_mul_f32 v[66:67], v[66:67], v[24:25] op_sel_hi:[1,0]
    v_pk_mul_f32 v[74:75], v[74:75], v[26:27] op_sel_hi:[1,0]
    v_pk_mul_f32 v[68:69], v[68:69], v[24:25] op_sel_hi:[1,0]
    v_pk_mul_f32 v[76:77], v[76:77], v[26:27] op_sel_hi:[1,0]
    v_pk_mul_f32 v[70:71], v[70:71], v[24:25] op_sel_hi:[1,0]
    v_pk_mul_f32 v[78:79], v[78:79], v[26:27] op_sel_hi:[1,0]
    v_cvt_pk_bf16_f32 v32, v64, v65
    v_cvt_pk_bf16_f32 v36, v72, v73
    v_cvt_pk_bf16_f32 v33, v66, v67
    v_cvt_pk_bf16_f32 v37, v74, v75
    v_cvt_pk_bf16_f32 v34, v68, v69
    v_cvt_pk_bf16_f32 v38, v76, v77
    v_cvt_pk_bf16_f32 v35, v70, v71
    v_cvt_pk_bf16_f32 v39, v78, v79
    v_max3_f32 v24, v88, v89, v90
    v_min3_f32 v26, v88, v89, v90
    v_max3_f32 v24, v24, v91, v92
    v_min3_f32 v26, v26, v91, v92
    v_max3_f32 v24, v24, v93, v94
    v_min3_f32 v26, v26, v93, v94
    v_max_f32 v24, v24, v95
    v_min_f32 v26, v26, v95
    v_mov_b32 v25, v24
    v_mov_b32 v27, v26
    v_nop
    v_permlane32_swap_b32 v24, v25
    v_permlane32_swap_b32 v26, v27
    v_max_f32 v24, v24, v25
    v_min_f32 v26, v26, v27
    v_mul_f32 v24, s50, v24
    s_lshl_b32 s3, s2, 9
    s_add_u32 s3, s3, 0
    s_buffer_load_dword s4, s[32:35], s3 glc
    v_mul_f32 v26, s50, v26
    v_pk_fma_f32 v[64:65], v[88:89], s[50:51], v[24:25] op_sel_hi:[1,0,0] neg_lo:[0,0,1] neg_hi:[0,0,1]
    v_pk_fma_f32 v[72:73], v[88:89], s[50:51], v[26:27] op_sel_hi:[1,0,0] neg_lo:[1,0,0] neg_hi:[1,0,0]
    v_pk_fma_f32 v[66:67], v[90:91], s[50:51], v[24:25] op_sel_hi:[1,0,0] neg_lo:[0,0,1] neg_hi:[0,0,1]
    v_pk_fma_f32 v[74:75], v[90:91], s[50:51], v[26:27] op_sel_hi:[1,0,0] neg_lo:[1,0,0] neg_hi:[1,0,0]
    v_pk_fma_f32 v[68:69], v[92:93], s[50:51], v[24:25] op_sel_hi:[1,0,0] neg_lo:[0,0,1] neg_hi:[0,0,1]
    v_pk_fma_f32 v[76:77], v[92:93], s[50:51], v[26:27] op_sel_hi:[1,0,0] neg_lo:[1,0,0] neg_hi:[1,0,0]
    v_pk_fma_f32 v[70:71], v[94:95], s[50:51], v[24:25] op_sel_hi:[1,0,0] neg_lo:[0,0,1] neg_hi:[0,0,1]
    v_pk_fma_f32 v[78:79], v[94:95], s[50:51], v[26:27] op_sel_hi:[1,0,0] neg_lo:[1,0,0] neg_hi:[1,0,0]
    v_exp_f32 v64, v64
    v_exp_f32 v72, v72
    v_exp_f32 v65, v65
    v_exp_f32 v73, v73
    v_exp_f32 v66, v66
    v_exp_f32 v74, v74
    v_exp_f32 v67, v67
    v_exp_f32 v75, v75
    v_exp_f32 v68, v68
    v_exp_f32 v76, v76
    v_exp_f32 v69, v69
    v_exp_f32 v77, v77
    v_exp_f32 v70, v70
    v_exp_f32 v78, v78
    v_exp_f32 v71, v71
    v_exp_f32 v79, v79
    v_pk_add_f32 v[24:25], v[64:65], v[66:67]
    v_pk_add_f32 v[26:27], v[72:73], v[74:75]
    v_pk_add_f32 v[24:25], v[24:25], v[68:69]
    v_pk_add_f32 v[26:27], v[26:27], v[76:77]
    v_pk_add_f32 v[24:25], v[24:25], v[70:71]
    v_pk_add_f32 v[26:27], v[26:27], v[78:79]
    v_add_f32 v28, v24, v25
    v_add_f32 v29, v26, v27
    v_mov_b32 v25, v28
    v_mov_b32 v27, v29
    v_nop
    v_permlane32_swap_b32 v28, v25
    v_permlane32_swap_b32 v29, v27
    v_add_f32 v28, v28, v25
    v_add_f32 v29, v29, v27
    v_rcp_f32 v24, v28
    v_rcp_f32 v26, v29
    v_nop
    v_pk_mul_f32 v[64:65], v[64:65], v[24:25] op_sel_hi:[1,0]
    v_pk_mul_f32 v[72:73], v[72:73], v[26:27] op_sel_hi:[1,0]
    v_pk_mul_f32 v[66:67], v[66:67], v[24:25] op_sel_hi:[1,0]
    v_pk_mul_f32 v[74:75], v[74:75], v[26:27] op_sel_hi:[1,0]
    v_pk_mul_f32 v[68:69], v[68:69], v[24:25] op_sel_hi:[1,0]
    v_pk_mul_f32 v[76:77], v[76:77], v[26:27] op_sel_hi:[1,0]
    v_pk_mul_f32 v[70:71], v[70:71], v[24:25] op_sel_hi:[1,0]
    v_pk_mul_f32 v[78:79], v[78:79], v[26:27] op_sel_hi:[1,0]
    v_cvt_pk_bf16_f32 v40, v64, v65
    v_cvt_pk_bf16_f32 v44, v72, v73
    v_cvt_pk_bf16_f32 v41, v66, v67
    v_cvt_pk_bf16_f32 v45, v74, v75
    v_cvt_pk_bf16_f32 v42, v68, v69
    v_cvt_pk_bf16_f32 v46, v76, v77
    v_cvt_pk_bf16_f32 v43, v70, v71
    v_cvt_pk_bf16_f32 v47, v78, v79
    s_branch P1J_42
W23_41:
    v_lshlrev_b32 v119, 8, v3
    v_add_u32 v119, v119, v13
    s_waitcnt vmcnt(0)
    s_barrier
    v_mov_b32 v120, 0x3f803f80
    v_mov_b32 v121, 0x3f803f80
    v_mov_b32 v122, 0x3f803f80
    v_mov_b32 v123, 0x3f803f80
    ds_read_b64_tr_b16 v[96:97], v119 offset:0
    ds_read_b64_tr_b16 v[98:99], v119 offset:256
    ds_read_b64_tr_b16 v[100:101], v119 offset:1024
    ds_read_b64_tr_b16 v[102:103], v119 offset:1280
    s_waitcnt lgkmcnt(2)
    v_mfma_f32_32x32x16_bf16 v[64:79], v[96:99], v[128:131], 0
    s_cmp_lg_u32 s44, 0
    s_cbranch_scc1 CSQ_77
    v_mfma_f32_32x32x16_bf16 v[48:63], v[120:123], v[96:99], 0
CSQ_77:
    ds_read_b64_tr_b16 v[104:105], v119 offset:2048
    ds_read_b64_tr_b16 v[106:107], v119 offset:2304
    s_add_u32 s99, s65, 0
    s_add_u32 m0, s62, 0
    s_nop 0
    buffer_load_dwordx4 v7, s[20:23], s99 offen lds
    s_waitcnt lgkmcnt(2)
    v_mfma_f32_32x32x16_bf16 v[64:79], v[100:103], v[132:135], v[64:79]
    s_cmp_lg_u32 s44, 1
    s_cbranch_scc1 CSQ_78
    s_nop 1
    v_mfma_f32_32x32x16_bf16 v[48:63], v[120:123], v[100:103], 0
CSQ_78:
    ds_read_b64_tr_b16 v[108:109], v119 offset:3072
    ds_read_b64_tr_b16 v[110:111], v119 offset:3328
    s_add_u32 s99, s65, 28672
    s_add_u32 m0, s62, 1024
    s_nop 0
    buffer_load_dwordx4 v7, s[20:23], s99 offen lds
    s_waitcnt lgkmcnt(2)
    v_mfma_f32_32x32x16_bf16 v[64:79], v[104:107], v[136:139], v[64:79]
    s_cmp_lg_u32 s44, 2
    s_cbranch_scc1 CSQ_79
    s_nop 1
    v_mfma_f32_32x32x16_bf16 v[48:63], v[120:123], v[104:107], 0
CSQ_79:
    ds_read_b64_tr_b16 v[96:97], v119 offset:4096
    ds_read_b64_tr_b16 v[98:99], v119 offset:4352
    s_add_u32 s99, s65, 57344
    s_add_u32 m0, s62, 2048
    s_nop 0
    buffer_load_dwordx4 v7, s[20:23], s99 offen lds
    s_waitcnt lgkmcnt(2)
    v_mfma_f32_32x32x16_bf16 v[64:79], v[108:111], v[140:143], v[64:79]
    s_cmp_lg_u32 s44, 3
    s_cbranch_scc1 CSQ_80
    s_nop 1
    v_mfma_f32_32x32x16_bf16 v[48:63], v[120:123], v[108:111], 0
CSQ_80:
    ds_read_b64_tr_b16 v[100:101], v119 offset:5120
    ds_read_b64_tr_b16 v[102:103], v119 offset:5376
    s_add_u32 s99, s65, 86016
    s_add_u32 m0, s62, 3072
    s_nop 0
    buffer_load_dwordx4 v7, s[20:23], s99 offen lds
    s_waitcnt lgkmcnt(2)
    v_mfma_f32_32x32x16_bf16 v[64:79], v[96:99], v[144:147], v[64:79]
    s_cmp_lg_u32 s44, 0
    s_cbranch_scc1 CSQ_81
    v_mfma_f32_32x32x16_bf16 v[48:63], v[120:123], v[96:99], v[48:63]
CSQ_81:
    ds_read_b64_tr_b16 v[104:105], v119 offset:6144
    ds_read_b64_tr_b16 v[106:107], v119 offset:6400
    s_add_u32 s99, s65, 114688
    s_add_u32 m0, s62, 4096
    s_nop 0
    buffer_load_dwordx4 v7, s[20:23], s99 offen lds
    s_waitcnt lgkmcnt(2)
    v_mfma_f32_32x32x16_bf16 v[64:79], v[100:103], v[148:151], v[64:79]
    s_cmp_lg_u32 s44, 1
    s_cbranch_scc1 CSQ_82
    v_mfma_f32_32x32x16_bf16 v[48:63], v[120:123], v[100:103], v[48:63]
CSQ_82:
    ds_read_b64_tr_b16 v[108:109], v119 offset:7168
    ds_read_b64_tr_b16 v[110:111], v119 offset:7424
    s_add_u32 s99, s65, 143360
    s_add_u32 m0, s62, 5120
    s_nop 0
    buffer_load_dwordx4 v7, s[20:23], s99 offen lds
    s_waitcnt lgkmcnt(2)
    v_mfma_f32_32x32x16_bf16 v[64:79], v[104:107], v[152:155], v[64:79]
    s_cmp_lg_u32 s44, 2
    s_cbranch_scc1 CSQ_83
    v_mfma_f32_32x32x16_bf16 v[48:63], v[120:123], v[104:107], v[48:63]
CSQ_83:
    ds_read_b64_tr_b16 v[96:97], v119 offset:8192
    ds_read_b64_tr_b16 v[98:99], v119 offset:8448
    s_add_u32 s99, s65, 172032
    s_add_u32 m0, s62, 6144
    s_nop 0
    buffer_load_dwordx4 v7, s[20:23], s99 offen lds
    s_waitcnt lgkmcnt(2)
    v_mfma_f32_32x32x16_bf16 v[64:79], v[108:111], v[156:159], v[64:79]
    s_cmp_lg_u32 s44, 3
    s_cbranch_scc1 CSQ_84
    v_mfma_f32_32x32x16_bf16 v[48:63], v[120:123], v[108:111], v[48:63]
CSQ_84:
    ds_read_b64_tr_b16 v[100:101], v119 offset:9216
    ds_read_b64_tr_b16 v[102:103], v119 offset:9472
    s_add_u32 s99, s65, 200704
    s_add_u32 m0, s62, 7168
    s_nop 0
    buffer_load_dwordx4 v7, s[20:23], s99 offen lds
    s_waitcnt lgkmcnt(2)
    v_mfma_f32_32x32x16_bf16 v[64:79], v[96:99], v[160:163], v[64:79]
    s_cmp_lg_u32 s44, 0
    s_cbranch_scc1 CSQ_85
    v_mfma_f32_32x32x16_bf16 v[48:63], v[120:123], v[96:99], v[48:63]
CSQ_85:
    ds_read_b64_tr_b16 v[104:105], v119 offset:10240
    ds_read_b64_tr_b16 v[106:107], v119 offset:10496
    s_lshl_b32 s76, s72, 15
    s_lshl_b32 s77, s73, 6
    s_add_u32 s76, s76, s77
    v_lshlrev_b32 v25, 10, v2
    v_lshl_add_u32 v25, v3, 3, v25
    buffer_load_dwordx2 a[240:241], v25, s[8:11], s76 offen offset:0
    buffer_load_dwordx2 a[242:243], v25, s[8:11], s76 offen offset:16
    buffer_load_dwordx2 a[244:245], v25, s[8:11], s76 offen offset:32
    buffer_load_dwordx2 a[246:247], v25, s[8:11], s76 offen offset:48
    s_waitcnt lgkmcnt(2)
    v_mfma_f32_32x32x16_bf16 v[64:79], v[100:103], v[164:167], v[64:79]
    s_cmp_lg_u32 s44, 1
    s_cbranch_scc1 CSQ_86
    v_mfma_f32_32x32x16_bf16 v[48:63], v[120:123], v[100:103], v[48:63]
CSQ_86:
    ds_read_b64_tr_b16 v[108:109], v119 offset:11264
    ds_read_b64_tr_b16 v[110:111], v119 offset:11520
    s_waitcnt lgkmcnt(2)
    v_mfma_f32_32x32x16_bf16 v[64:79], v[104:107], v[168:171], v[64:79]
    s_cmp_lg_u32 s44, 2
    s_cbranch_scc1 CSQ_87
    v_mfma_f32_32x32x16_bf16 v[48:63], v[120:123], v[104:107], v[48:63]
CSQ_87:
    ds_read_b64_tr_b16 v[96:97], v119 offset:12288
    ds_read_b64_tr_b16 v[98:99], v119 offset:12544
    s_sub_u32 s99, s63, 262144
    s_sub_u32 m0, s64, 32768
    s_nop 0
    buffer_load_dwordx4 v6, s[16:19], s99 offen lds
    s_waitcnt lgkmcnt(2)
    v_mfma_f32_32x32x16_bf16 v[64:79], v[108:111], v[172:175], v[64:79]
    s_cmp_lg_u32 s44, 3
    s_cbranch_scc1 CSQ_88
    v_mfma_f32_32x32x16_bf16 v[48:63], v[120:123], v[108:111], v[48:63]
CSQ_88:
    ds_read_b64_tr_b16 v[100:101], v119 offset:13312
    ds_read_b64_tr_b16 v[102:103], v119 offset:13568
    s_waitcnt lgkmcnt(2)
    v_mfma_f32_32x32x16_bf16 v[64:79], v[96:99], v[176:179], v[64:79]
    s_cmp_lg_u32 s44, 0
    s_cbranch_scc1 CSQ_89
    v_mfma_f32_32x32x16_bf16 v[48:63], v[120:123], v[96:99], v[48:63]
CSQ_89:
    ds_read_b64_tr_b16 v[104:105], v119 offset:14336
    ds_read_b64_tr_b16 v[106:107], v119 offset:14592
    s_sub_u32 s99, s63, 253952
    s_sub_u32 m0, s64, 31744
    s_nop 0
    buffer_load_dwordx4 v6, s[16:19], s99 offen lds
    s_waitcnt lgkmcnt(2)
    v_mfma_f32_32x32x16_bf16 v[64:79], v[100:103], v[180:183], v[64:79]
    s_cmp_lg_u32 s44, 1
    s_cbranch_scc1 CSQ_90
    v_mfma_f32_32x32x16_bf16 v[48:63], v[120:123], v[100:103], v[48:63]
CSQ_90:
    ds_read_b64_tr_b16 v[108:109], v119 offset:15360
    ds_read_b64_tr_b16 v[110:111], v119 offset:15616
    s_waitcnt lgkmcnt(2)
    v_mfma_f32_32x32x16_bf16 v[64:79], v[104:107], v[184:187], v[64:79]
    s_cmp_lg_u32 s44, 2
    s_cbranch_scc1 CSQ_91
    v_mfma_f32_32x32x16_bf16 v[48:63], v[120:123], v[104:107], v[48:63]
CSQ_91:
    ds_read_b64_tr_b16 v[96:97], v119 offset:16384
    ds_read_b64_tr_b16 v[98:99], v119 offset:16640
    s_sub_u32 s99, s63, 245760
    s_sub_u32 m0, s64, 30720
    s_nop 0
    buffer_load_dwordx4 v6, s[16:19], s99 offen lds
    s_waitcnt lgkmcnt(2)
    v_mfma_f32_32x32x16_bf16 v[64:79], v[108:111], v[188:191], v[64:79]
    s_cmp_lg_u32 s44, 3
    s_cbranch_scc1 CSQ_92
    v_mfma_f32_32x32x16_bf16 v[48:63], v[120:123], v[108:111], v[48:63]
CSQ_92:
    ds_read_b64_tr_b16 v[100:101], v119 offset:17408
    ds_read_b64_tr_b16 v[102:103], v119 offset:17664
    s_waitcnt lgkmcnt(2)
    v_mfma_f32_32x32x16_bf16 v[64:79], v[96:99], v[192:195], v[64:79]
    s_cmp_lg_u32 s44, 0
    s_cbranch_scc1 CSQ_93
    v_mfma_f32_32x32x16_bf16 v[48:63], v[120:123], v[96:99], v[48:63]
CSQ_93:
    ds_read_b64_tr_b16 v[104:105], v119 offset:18432
    ds_read_b64_tr_b16 v[106:107], v119 offset:18688
    s_sub_u32 s99, s63, 237568
    s_sub_u32 m0, s64, 29696
    s_nop 0
    buffer_load_dwordx4 v6, s[16:19], s99 offen lds
    s_waitcnt lgkmcnt(2)
    v_mfma_f32_32x32x16_bf16 v[64:79], v[100:103], v[196:199], v[64:79]
    s_cmp_lg_u32 s44, 1
    s_cbranch_scc1 CSQ_94
    v_mfma_f32_32x32x16_bf16 v[48:63], v[120:123], v[100:103], v[48:63]
CSQ_94:
    ds_read_b64_tr_b16 v[108:109], v119 offset:19456
    ds_read_b64_tr_b16 v[110:111], v119 offset:19712
    s_waitcnt lgkmcnt(2)
    v_mfma_f32_32x32x16_bf16 v[64:79], v[104:107], v[200:203], v[64:79]
    s_cmp_lg_u32 s44, 2
    s_cbranch_scc1 CSQ_95
    v_mfma_f32_32x32x16_bf16 v[48:63], v[120:123], v[104:107], v[48:63]
CSQ_95:
    ds_read_b64_tr_b16 v[96:97], v119 offset:20480
    ds_read_b64_tr_b16 v[98:99], v119 offset:20736
    s_sub_u32 s99, s63, 229376
    s_sub_u32 m0, s64, 28672
    s_nop 0
    buffer_load_dwordx4 v6, s[16:19], s99 offen lds
    s_waitcnt lgkmcnt(2)
    v_mfma_f32_32x32x16_bf16 v[64:79], v[108:111], v[204:207], v[64:79]
    s_cmp_lg_u32 s44, 3
    s_cbranch_scc1 CSQ_96
    v_mfma_f32_32x32x16_bf16 v[48:63], v[120:123], v[108:111], v[48:63]
CSQ_96:
    ds_read_b64_tr_b16 v[100:101], v119 offset:21504
    ds_read_b64_tr_b16 v[102:103], v119 offset:21760
    s_waitcnt lgkmcnt(2)
    v_mfma_f32_32x32x16_bf16 v[64:79], v[96:99], v[208:211], v[64:79]
    s_cmp_lg_u32 s44, 0
    s_cbranch_scc1 CSQ_97
    v_mfma_f32_32x32x16_bf16 v[48:63], v[120:123], v[96:99], v[48:63]
CSQ_97:
    ds_read_b64_tr_b16 v[104:105], v119 offset:22528
    ds_read_b64_tr_b16 v[106:107], v119 offset:22784
    s_sub_u32 s99, s63, 221184
    s_sub_u32 m0, s64, 27648
    s_nop 0
    buffer_load_dwordx4 v6, s[16:19], s99 offen lds
    v_accvgpr_read_b32 v23, a233
    s_nop 0
    v_readfirstlane_b32 s74, v23
    s_nop 1
    s_cmp_ge_u32 s74, 64
    s_cbranch_scc1 ID_99
    s_mov_b32 s60, 0
IL_98:
    s_sleep 16
    s_buffer_load_dword s4, s[36:39], 0 glc
    s_add_u32 s60, s60, 1
    s_cmp_gt_u32 s60, 0x80000
    s_cbranch_scc1 L_bail
    s_waitcnt lgkmcnt(0)
    s_cmp_lt_u32 s4, 64
    s_cbranch_scc1 IL_98
ID_99:
    s_waitcnt lgkmcnt(2)
    v_mfma_f32_32x32x16_bf16 v[64:79], v[100:103], v[212:215], v[64:79]
    s_cmp_lg_u32 s44, 1
    s_cbranch_scc1 CSQ_100
    v_mfma_f32_32x32x16_bf16 v[48:63], v[120:123], v[100:103], v[48:63]
CSQ_100:
    ds_read_b64_tr_b16 v[108:109], v119 offset:23552
    ds_read_b64_tr_b16 v[110:111], v119 offset:23808
    s_waitcnt lgkmcnt(2)
    v_mfma_f32_32x32x16_bf16 v[64:79], v[104:107], v[216:219], v[64:79]
    s_cmp_lg_u32 s44, 2
    s_cbranch_scc1 CSQ_101
    v_mfma_f32_32x32x16_bf16 v[48:63], v[120:123], v[104:107], v[48:63]
CSQ_101:
    ds_read_b64_tr_b16 v[96:97], v119 offset:24576
    ds_read_b64_tr_b16 v[98:99], v119 offset:24832
    s_sub_u32 s99, s63, 212992
    s_sub_u32 m0, s64, 26624
    s_nop 0
    buffer_load_dwordx4 v6, s[16:19], s99 offen lds
    s_waitcnt lgkmcnt(2)
    v_mfma_f32_32x32x16_bf16 v[64:79], v[108:111], v[220:223], v[64:79]
    s_cmp_lg_u32 s44, 3
    s_cbranch_scc1 CSQ_102
    v_mfma_f32_32x32x16_bf16 v[48:63], v[120:123], v[108:111], v[48:63]
CSQ_102:
    ds_read_b64_tr_b16 v[100:101], v119 offset:25600
    ds_read_b64_tr_b16 v[102:103], v119 offset:25856
    s_waitcnt lgkmcnt(2)
    v_mfma_f32_32x32x16_bf16 v[64:79], v[96:99], v[224:227], v[64:79]
    s_cmp_lg_u32 s44, 0
    s_cbranch_scc1 CSQ_103
    v_mfma_f32_32x32x16_bf16 v[48:63], v[120:123], v[96:99], v[48:63]
CSQ_103:
    ds_read_b64_tr_b16 v[104:105], v119 offset:26624
    ds_read_b64_tr_b16 v[106:107], v119 offset:26880
    s_sub_u32 s99, s63, 204800
    s_sub_u32 m0, s64, 25600
    s_nop 0
    buffer_load_dwordx4 v6, s[16:19], s99 offen lds
    s_waitcnt lgkmcnt(2)
    v_mfma_f32_32x32x16_bf16 v[64:79], v[100:103], v[228:231], v[64:79]
    s_cmp_lg_u32 s44, 1
    s_cbranch_scc1 CSQ_104
    v_mfma_f32_32x32x16_bf16 v[48:63], v[120:123], v[100:103], v[48:63]
CSQ_104:
    ds_read_b64_tr_b16 v[108:109], v119 offset:27648
    ds_read_b64_tr_b16 v[110:111], v119 offset:27904
    s_waitcnt lgkmcnt(2)
    v_mfma_f32_32x32x16_bf16 v[64:79], v[104:107], v[232:235], v[64:79]
    s_cmp_lg_u32 s44, 2
    s_cbranch_scc1 CSQ_105
    v_mfma_f32_32x32x16_bf16 v[48:63], v[120:123], v[104:107], v[48:63]
CSQ_105:
    ds_read_b64_tr_b16 v[96:97], v119 offset:28672
    ds_read_b64_tr_b16 v[98:99], v119 offset:28928
    s_waitcnt lgkmcnt(2)
    v_mfma_f32_32x32x16_bf16 v[64:79], v[108:111], v[236:239], v[64:79]
    s_cmp_lg_u32 s44, 3
    s_cbranch_scc1 CSQ_106
    v_mfma_f32_32x32x16_bf16 v[48:63], v[120:123], v[108:111], v[48:63]
CSQ_106:
    ds_read_b64_tr_b16 v[100:101], v119 offset:29696
    ds_read_b64_tr_b16 v[102:103], v119 offset:29952
    s_waitcnt lgkmcnt(2)
    v_mfma_f32_32x32x16_bf16 v[64:79], v[96:99], v[240:243], v[64:79]
    s_cmp_lg_u32 s44, 0
    s_cbranch_scc1 CSQ_107
    v_mfma_f32_32x32x16_bf16 v[48:63], v[120:123], v[96:99], v[48:63]
CSQ_107:
    ds_read_b64_tr_b16 v[104:105], v119 offset:30720
    ds_read_b64_tr_b16 v[106:107], v119 offset:30976
    s_waitcnt lgkmcnt(2)
    v_mfma_f32_32x32x16_bf16 v[64:79], v[100:103], v[244:247], v[64:79]
    s_cmp_lg_u32 s44, 1
    s_cbranch_scc1 CSQ_108
    v_mfma_f32_32x32x16_bf16 v[48:63], v[120:123], v[100:103], v[48:63]
CSQ_108:
    ds_read_b64_tr_b16 v[108:109], v119 offset:31744
    ds_read_b64_tr_b16 v[110:111], v119 offset:32000
    s_waitcnt lgkmcnt(2)
    v_mfma_f32_32x32x16_bf16 v[64:79], v[104:107], v[248:251], v[64:79]
    s_cmp_lg_u32 s44, 2
    s_cbranch_scc1 CSQ_109
    v_mfma_f32_32x32x16_bf16 v[48:63], v[120:123], v[104:107], v[48:63]
CSQ_109:
    s_waitcnt lgkmcnt(0)
    v_mfma_f32_32x32x16_bf16 v[64:79], v[108:111], v[252:255], v[64:79]
    s_cmp_lg_u32 s44, 3
    s_cbranch_scc1 CSQ_110
    v_mfma_f32_32x32x16_bf16 v[48:63], v[120:123], v[108:111], v[48:63]
CSQ_110:
    v_lshlrev_b32 v28, 4, v2
    s_lshl_b32 s74, s44, 2
    v_add_u32 v28, s74, v28
    v_add_u32 v28, 36864, v28
    s_nop 7
    ds_write_b32 v28, v48
    s_waitcnt lgkmcnt(0)
    s_barrier
    v_lshlrev_b32 v28, 4, v2
    v_add_u32 v28, 36864, v28
    ds_read_b128 v[96:99], v28
    s_waitcnt lgkmcnt(0)
    v_add_f32 v96, v96, v97
    v_add_f32 v98, v98, v99
    v_add_f32 v96, v96, v98
    v_cndmask_b32 v96, 0, v96, s[54:55]
    v_cvt_pk_bf16_f32 v108, v96, v96
    v_lshlrev_b32 v26, 16, v108
    v_sub_f32 v26, v96, v26
    v_cvt_pk_bf16_f32 v109, v26, v26
    v_accvgpr_write_b32 a228, v108
    v_accvgpr_write_b32 a229, v109
    v_accvgpr_write_b32 a230, 0
    v_accvgpr_write_b32 a231, 0
    s_nop 1
    v_mfma_f32_32x32x16_bf16 v[64:79], a[228:231], v[124:127], v[64:79]
    s_nop 11
    v_pk_mul_f32 v[64:65], v[64:65], v[20:21] op_sel:[0,1] op_sel_hi:[1,1]
    v_pk_mul_f32 v[66:67], v[66:67], v[20:21] op_sel:[0,1] op_sel_hi:[1,1]
    v_pk_mul_f32 v[68:69], v[68:69], v[20:21] op_sel:[0,1] op_sel_hi:[1,1]
    v_pk_mul_f32 v[70:71], v[70:71], v[20:21] op_sel:[0,1] op_sel_hi:[1,1]
    v_pk_mul_f32 v[72:73], v[72:73], v[20:21] op_sel:[0,1] op_sel_hi:[1,1]
    v_pk_mul_f32 v[74:75], v[74:75], v[20:21] op_sel:[0,1] op_sel_hi:[1,1]
    v_pk_mul_f32 v[76:77], v[76:77], v[20:21] op_sel:[0,1] op_sel_hi:[1,1]
    v_pk_mul_f32 v[78:79], v[78:79], v[20:21] op_sel:[0,1] op_sel_hi:[1,1]
    v_cvt_pk_bf16_f32 v96, v64, v65
    v_cvt_pk_bf16_f32 v97, v66, v67
    v_cvt_pk_bf16_f32 v98, v68, v69
    v_cvt_pk_bf16_f32 v99, v70, v71
    v_cvt_pk_bf16_f32 v100, v72, v73
    v_cvt_pk_bf16_f32 v101, v74, v75
    v_cvt_pk_bf16_f32 v102, v76, v77
    v_cvt_pk_bf16_f32 v103, v78, v79
    v_mfma_f32_32x32x16_bf16 v[80:95], a[248:251], v[96:99], 0
    s_nop 0
    v_mfma_f32_32x32x16_bf16 v[80:95], a[252:255], v[100:103], v[80:95]
    s_nop 11
    v_max3_f32 v24, v80, v81, v82
    v_min3_f32 v26, v80, v81, v82
    v_max3_f32 v24, v24, v83, v84
    v_min3_f32 v26, v26, v83, v84
    v_max3_f32 v24, v24, v85, v86
    v_min3_f32 v26, v26, v85, v86
    s_sub_u32 s99, s63, 196608
    s_sub_u32 m0, s64, 24576
    s_nop 0
    buffer_load_dwordx4 v6, s[16:19], s99 offen lds
    v_max_f32 v24, v24, v87
    v_min_f32 v26, v26, v87
    v_mov_b32 v25, v24
    v_mov_b32 v27, v26
    v_nop
    v_permlane32_swap_b32 v24, v25
    v_permlane32_swap_b32 v26, v27
    s_sub_u32 s99, s63, 188416
    s_sub_u32 m0, s64, 23552
    s_nop 0
    buffer_load_dwordx4 v6, s[16:19], s99 offen lds
    v_max_f32 v24, v24, v25
    v_min_f32 v26, v26, v27
    v_mul_f32 v24, s50, v24
    v_mul_f32 v26, s50, v26
    v_pk_fma_f32 v[64:65], v[80:81], s[50:51], v[24:25] op_sel_hi:[1,0,0] neg_lo:[0,0,1] neg_hi:[0,0,1]
    v_pk_fma_f32 v[72:73], v[80:81], s[50:51], v[26:27] op_sel_hi:[1,0,0] neg_lo:[1,0,0] neg_hi:[1,0,0]
    v_pk_fma_f32 v[66:67], v[82:83], s[50:51], v[24:25] op_sel_hi:[1,0,0] neg_lo:[0,0,1] neg_hi:[0,0,1]
    s_sub_u32 s99, s63, 180224
    s_sub_u32 m0, s64, 22528
    s_nop 0
    buffer_load_dwordx4 v6, s[16:19], s99 offen lds
    v_pk_fma_f32 v[74:75], v[82:83], s[50:51], v[26:27] op_sel_hi:[1,0,0] neg_lo:[1,0,0] neg_hi:[1,0,0]
    v_pk_fma_f32 v[68:69], v[84:85], s[50:51], v[24:25] op_sel_hi:[1,0,0] neg_lo:[0,0,1] neg_hi:[0,0,1]
    v_pk_fma_f32 v[76:77], v[84:85], s[50:51], v[26:27] op_sel_hi:[1,0,0] neg_lo:[1,0,0] neg_hi:[1,0,0]
    v_pk_fma_f32 v[70:71], v[86:87], s[50:51], v[24:25] op_sel_hi:[1,0,0] neg_lo:[0,0,1] neg_hi:[0,0,1]
    v_pk_fma_f32 v[78:79], v[86:87], s[50:51], v[26:27] op_sel_hi:[1,0,0] neg_lo:[1,0,0] neg_hi:[1,0,0]
    v_exp_f32 v64, v64
    v_exp_f32 v72, v72
    s_sub_u32 s99, s63, 172032
    s_sub_u32 m0, s64, 21504
    s_nop 0
    buffer_load_dwordx4 v6, s[16:19], s99 offen lds
    v_exp_f32 v65, v65
    v_exp_f32 v73, v73
    v_exp_f32 v66, v66
    v_exp_f32 v74, v74
    v_exp_f32 v67, v67
    v_exp_f32 v75, v75
    v_exp_f32 v68, v68
    s_sub_u32 s99, s63, 163840
    s_sub_u32 m0, s64, 20480
    s_nop 0
    buffer_load_dwordx4 v6, s[16:19], s99 offen lds
    v_exp_f32 v76, v76
    v_exp_f32 v69, v69
    v_exp_f32 v77, v77
    v_exp_f32 v70, v70
    v_exp_f32 v78, v78
    v_exp_f32 v71, v71
    v_exp_f32 v79, v79
    s_sub_u32 s99, s63, 155648
    s_sub_u32 m0, s64, 19456
    s_nop 0
    buffer_load_dwordx4 v6, s[16:19], s99 offen lds
    v_pk_add_f32 v[24:25], v[64:65], v[66:67]
    v_pk_add_f32 v[26:27], v[72:73], v[74:75]
    v_pk_add_f32 v[24:25], v[24:25], v[68:69]
    v_pk_add_f32 v[26:27], v[26:27], v[76:77]
    v_pk_add_f32 v[24:25], v[24:25], v[70:71]
    v_pk_add_f32 v[26:27], v[26:27], v[78:79]
    v_add_f32 v28, v24, v25
    s_sub_u32 s99, s63, 147456
    s_sub_u32 m0, s64, 18432
    s_nop 0
    buffer_load_dwordx4 v6, s[16:19], s99 offen lds
    v_add_f32 v29, v26, v27
    v_mov_b32 v25, v28
    v_mov_b32 v27, v29
    v_nop
    v_permlane32_swap_b32 v28, v25
    v_permlane32_swap_b32 v29, v27
    v_add_f32 v28, v28, v25
    s_sub_u32 s99, s63, 139264
    s_sub_u32 m0, s64, 17408
    s_nop 0
    buffer_load_dwordx4 v6, s[16:19], s99 offen lds
    v_add_f32 v29, v29, v27
    v_rcp_f32 v24, v28
    v_rcp_f32 v26, v29
    v_nop
    v_pk_mul_f32 v[64:65], v[64:65], v[24:25] op_sel_hi:[1,0]
    v_pk_mul_f32 v[72:73], v[72:73], v[26:27] op_sel_hi:[1,0]
    v_pk_mul_f32 v[66:67], v[66:67], v[24:25] op_sel_hi:[1,0]
    s_add_u32 s99, s63, 0
    s_add_u32 m0, s64, 0
    s_nop 0
    buffer_load_dwordx4 v6, s[16:19], s99 offen lds
    v_pk_mul_f32 v[74:75], v[74:75], v[26:27] op_sel_hi:[1,0]
    v_pk_mul_f32 v[68:69], v[68:69], v[24:25] op_sel_hi:[1,0]
    v_pk_mul_f32 v[76:77], v[76:77], v[26:27] op_sel_hi:[1,0]
    v_pk_mul_f32 v[70:71], v[70:71], v[24:25] op_sel_hi:[1,0]
    v_pk_mul_f32 v[78:79], v[78:79], v[26:27] op_sel_hi:[1,0]
    v_cvt_pk_bf16_f32 v32, v64, v65
    v_cvt_pk_bf16_f32 v36, v72, v73
    s_add_u32 s99, s63, 8192
    s_add_u32 m0, s64, 1024
    s_nop 0
    buffer_load_dwordx4 v6, s[16:19], s99 offen lds
    v_cvt_pk_bf16_f32 v33, v66, v67
    v_cvt_pk_bf16_f32 v37, v74, v75
    v_cvt_pk_bf16_f32 v34, v68, v69
    v_cvt_pk_bf16_f32 v38, v76, v77
    v_cvt_pk_bf16_f32 v35, v70, v71
    v_cvt_pk_bf16_f32 v39, v78, v79
    v_max3_f32 v24, v88, v89, v90
    s_add_u32 s99, s63, 16384
    s_add_u32 m0, s64, 2048
    s_nop 0
    buffer_load_dwordx4 v6, s[16:19], s99 offen lds
    v_min3_f32 v26, v88, v89, v90
    v_max3_f32 v24, v24, v91, v92
    v_min3_f32 v26, v26, v91, v92
    v_max3_f32 v24, v24, v93, v94
    v_min3_f32 v26, v26, v93, v94
    v_max_f32 v24, v24, v95
    v_min_f32 v26, v26, v95
    s_add_u32 s99, s63, 24576
    s_add_u32 m0, s64, 3072
    s_nop 0
    buffer_load_dwordx4 v6, s[16:19], s99 offen lds
    v_mov_b32 v25, v24
    v_mov_b32 v27, v26
    v_nop
    v_permlane32_swap_b32 v24, v25
    v_permlane32_swap_b32 v26, v27
    v_max_f32 v24, v24, v25
    v_min_f32 v26, v26, v27
    s_add_u32 s99, s63, 32768
    s_add_u32 m0, s64, 4096
    s_nop 0
    buffer_load_dwordx4 v6, s[16:19], s99 offen lds
    v_mul_f32 v24, s50, v24
    s_lshl_b32 s3, s2, 9
    s_add_u32 s3, s3, 0
    s_buffer_load_dword s4, s[32:35], s3 glc
    v_mul_f32 v26, s50, v26
    v_pk_fma_f32 v[64:65], v[88:89], s[50:51], v[24:25] op_sel_hi:[1,0,0] neg_lo:[0,0,1] neg_hi:[0,0,1]
    v_pk_fma_f32 v[72:73], v[88:89], s[50:51], v[26:27] op_sel_hi:[1,0,0] neg_lo:[1,0,0] neg_hi:[1,0,0]
    v_pk_fma_f32 v[66:67], v[90:91], s[50:51], v[24:25] op_sel_hi:[1,0,0] neg_lo:[0,0,1] neg_hi:[0,0,1]
    v_pk_fma_f32 v[74:75], v[90:91], s[50:51], v[26:27] op_sel_hi:[1,0,0] neg_lo:[1,0,0] neg_hi:[1,0,0]
    v_pk_fma_f32 v[68:69], v[92:93], s[50:51], v[24:25] op_sel_hi:[1,0,0] neg_lo:[0,0,1] neg_hi:[0,0,1]
    s_add_u32 s99, s63, 40960
    s_add_u32 m0, s64, 5120
    s_nop 0
    buffer_load_dwordx4 v6, s[16:19], s99 offen lds
    v_pk_fma_f32 v[76:77], v[92:93], s[50:51], v[26:27] op_sel_hi:[1,0,0] neg_lo:[1,0,0] neg_hi:[1,0,0]
    v_pk_fma_f32 v[70:71], v[94:95], s[50:51], v[24:25] op_sel_hi:[1,0,0] neg_lo:[0,0,1] neg_hi:[0,0,1]
    v_pk_fma_f32 v[78:79], v[94:95], s[50:51], v[26:27] op_sel_hi:[1,0,0] neg_lo:[1,0,0] neg_hi:[1,0,0]
    v_exp_f32 v64, v64
    v_exp_f32 v72, v72
    v_exp_f32 v65, v65
    v_exp_f32 v73, v73
    s_add_u32 s99, s63, 49152
    s_add_u32 m0, s64, 6144
    s_nop 0
    buffer_load_dwordx4 v6, s[16:19], s99 offen lds
    v_exp_f32 v66, v66
    v_exp_f32 v74, v74
    v_exp_f32 v67, v67
    v_exp_f32 v75, v75
    v_exp_f32 v68, v68
    v_exp_f32 v76, v76
    v_exp_f32 v69, v69
    s_add_u32 s99, s63, 57344
    s_add_u32 m0, s64, 7168
    s_nop 0
    buffer_load_dwordx4 v6, s[16:19], s99 offen lds
    v_exp_f32 v77, v77
    v_exp_f32 v70, v70
    v_exp_f32 v78, v78
    v_exp_f32 v71, v71
    v_exp_f32 v79, v79
    v_pk_add_f32 v[24:25], v[64:65], v[66:67]
    v_pk_add_f32 v[26:27], v[72:73], v[74:75]
    s_add_u32 s99, s63, 65536
    s_add_u32 m0, s64, 8192
    s_nop 0
    buffer_load_dwordx4 v6, s[16:19], s99 offen lds
    v_pk_add_f32 v[24:25], v[24:25], v[68:69]
    v_pk_add_f32 v[26:27], v[26:27], v[76:77]
    v_pk_add_f32 v[24:25], v[24:25], v[70:71]
    v_pk_add_f32 v[26:27], v[26:27], v[78:79]
    v_add_f32 v28, v24, v25
    v_add_f32 v29, v26, v27
    v_mov_b32 v25, v28
    s_add_u32 s99, s63, 73728
    s_add_u32 m0, s64, 9216
    s_nop 0
    buffer_load_dwordx4 v6, s[16:19], s99 offen lds
    v_mov_b32 v27, v29
    v_nop
    v_permlane32_swap_b32 v28, v25
    v_permlane32_swap_b32 v29, v27
    v_add_f32 v28, v28, v25
    v_add_f32 v29, v29, v27
    v_rcp_f32 v24, v28
    s_add_u32 s99, s63, 81920
    s_add_u32 m0, s64, 10240
    s_nop 0
    buffer_load_dwordx4 v6, s[16:19], s99 offen lds
    v_rcp_f32 v26, v29
    v_nop
    v_pk_mul_f32 v[64:65], v[64:65], v[24:25] op_sel_hi:[1,0]
    v_pk_mul_f32 v[72:73], v[72:73], v[26:27] op_sel_hi:[1,0]
    v_pk_mul_f32 v[66:67], v[66:67], v[24:25] op_sel_hi:[1,0]
    v_pk_mul_f32 v[74:75], v[74:75], v[26:27] op_sel_hi:[1,0]
    v_pk_mul_f32 v[68:69], v[68:69], v[24:25] op_sel_hi:[1,0]
    s_add_u32 s99, s63, 90112
    s_add_u32 m0, s64, 11264
    s_nop 0
    buffer_load_dwordx4 v6, s[16:19], s99 offen lds
    v_pk_mul_f32 v[76:77], v[76:77], v[26:27] op_sel_hi:[1,0]
    v_pk_mul_f32 v[70:71], v[70:71], v[24:25] op_sel_hi:[1,0]
    v_pk_mul_f32 v[78:79], v[78:79], v[26:27] op_sel_hi:[1,0]
    v_cvt_pk_bf16_f32 v40, v64, v65
    v_cvt_pk_bf16_f32 v44, v72, v73
    v_cvt_pk_bf16_f32 v41, v66, v67
    v_cvt_pk_bf16_f32 v45, v74, v75
    s_add_u32 s99, s63, 98304
    s_add_u32 m0, s64, 12288
    s_nop 0
    buffer_load_dwordx4 v6, s[16:19], s99 offen lds
    v_cvt_pk_bf16_f32 v42, v68, v69
    v_cvt_pk_bf16_f32 v46, v76, v77
    v_cvt_pk_bf16_f32 v43, v70, v71
    v_cvt_pk_bf16_f32 v47, v78, v79
    s_add_u32 s99, s63, 106496
    s_add_u32 m0, s64, 13312
    s_nop 0
    buffer_load_dwordx4 v6, s[16:19], s99 offen lds
    s_add_u32 s99, s63, 114688
    s_add_u32 m0, s64, 14336
    s_nop 0
    buffer_load_dwordx4 v6, s[16:19], s99 offen lds
    s_add_u32 s99, s63, 122880
    s_add_u32 m0, s64, 15360
    s_nop 0
    buffer_load_dwordx4 v6, s[16:19], s99 offen lds
P1J_42:
    s_waitcnt lgkmcnt(0)
    s_cmp_ge_u32 s4, 32
    s_cbranch_scc1 PD_112
    s_mov_b32 s60, 0
PL_111:
    s_buffer_load_dword s4, s[32:35], s3 glc
    s_add_u32 s60, s60, 1
    s_cmp_gt_u32 s60, 0x80000
    s_cbranch_scc1 L_bail
    s_waitcnt lgkmcnt(0)
    s_cmp_lt_u32 s4, 32
    s_cbranch_scc1 PL_111
PD_112:
    s_mul_i32 s74, s46, 69632
    s_add_u32 s74, s74, 524288
    v_lshlrev_b32 v26, 4, v0
    s_cmp_lg_u32 s44, 3
    s_cbranch_scc1 NOEX_113
    v_lshrrev_b32 v27, 4, v1
    v_mul_u32_u24 v27, 17408, v27
    v_and_b32 v28, 15, v1
    v_lshl_add_u32 v27, v28, 4, v27
    s_add_u32 s98, s74, 4096
    buffer_load_dwordx4 v[192:195], v27, s[32:35], s98 offen sc1
    s_add_u32 s98, s74, 8448
    buffer_load_dwordx4 v[196:199], v27, s[32:35], s98 offen sc1
    s_add_u32 s98, s74, 12800
    buffer_load_dwordx4 v[200:203], v27, s[32:35], s98 offen sc1
    s_add_u32 s98, s74, 17152
    buffer_load_dwordx4 v[204:207], v27, s[32:35], s98 offen sc1
NOEX_113:
    s_add_u32 s98, s74, 0
    buffer_load_dwordx4 v[128:131], v26, s[32:35], s98 offen sc1
    s_add_u32 s98, s74, 4352
    buffer_load_dwordx4 v[132:135], v26, s[32:35], s98 offen sc1
    s_add_u32 s98, s74, 8704
    buffer_load_dwordx4 v[136:139], v26, s[32:35], s98 offen sc1
    s_add_u32 s98, s74, 13056
    buffer_load_dwordx4 v[140:143], v26, s[32:35], s98 offen sc1
    s_add_u32 s98, s74, 17408
    buffer_load_dwordx4 v[144:147], v26, s[32:35], s98 offen sc1
    s_add_u32 s98, s74, 21760
    buffer_load_dwordx4 v[148:151], v26, s[32:35], s98 offen sc1
    s_add_u32 s98, s74, 26112
    buffer_load_dwordx4 v[152:155], v26, s[32:35], s98 offen sc1
    s_add_u32 s98, s74, 30464
    buffer_load_dwordx4 v[156:159], v26, s[32:35], s98 offen sc1
    s_add_u32 s98, s74, 34816
    buffer_load_dwordx4 v[160:163], v26, s[32:35], s98 offen sc1
    s_add_u32 s98, s74, 39168
    buffer_load_dwordx4 v[164:167], v26, s[32:35], s98 offen sc1
    s_add_u32 s98, s74, 43520
    buffer_load_dwordx4 v[168:171], v26, s[32:35], s98 offen sc1
    s_add_u32 s98, s74, 47872
    buffer_load_dwordx4 v[172:175], v26, s[32:35], s98 offen sc1
    s_add_u32 s98, s74, 52224
    buffer_load_dwordx4 v[176:179], v26, s[32:35], s98 offen sc1
    s_add_u32 s98, s74, 56576
    buffer_load_dwordx4 v[180:183], v26, s[32:35], s98 offen sc1
    s_add_u32 s98, s74, 60928
    buffer_load_dwordx4 v[184:187], v26, s[32:35], s98 offen sc1
    s_add_u32 s98, s74, 65280
    buffer_load_dwordx4 v[188:191], v26, s[32:35], s98 offen sc1
    s_cmp_lg_u32 s44, 3
    s_cbranch_scc1 NOEX2_114
    s_waitcnt vmcnt(18)
    v_add_f32 v192, v192, v196
    v_add_f32 v193, v193, v197
    v_add_f32 v194, v194, v198
    v_add_f32 v195, v195, v199
    s_waitcnt vmcnt(17)
    v_add_f32 v192, v192, v200
    v_add_f32 v193, v193, v201
    v_add_f32 v194, v194, v202
    v_add_f32 v195, v195, v203
    s_waitcnt vmcnt(16)
    v_add_f32 v192, v192, v204
    v_add_f32 v193, v193, v205
    v_add_f32 v194, v194, v206
    v_add_f32 v195, v195, v207
    v_mov_b32 v196, v192
    v_mov_b32 v197, v193
    v_mov_b32 v198, v194
    v_mov_b32 v199, v195
    v_permlane32_swap_b32 v192, v196
    v_permlane32_swap_b32 v193, v197
    v_permlane32_swap_b32 v194, v198
    v_permlane32_swap_b32 v195, v199
    v_add_f32 v192, v192, v196
    v_add_f32 v193, v193, v197
    v_add_f32 v194, v194, v198
    v_add_f32 v195, v195, v199
    v_mov_b32 v196, v192
    v_mov_b32 v197, v193
    v_mov_b32 v198, v194
    v_mov_b32 v199, v195
    v_permlane16_swap_b32 v192, v196
    v_permlane16_swap_b32 v193, v197
    v_permlane16_swap_b32 v194, v198
    v_permlane16_swap_b32 v195, v199
    v_add_f32 v192, v192, v196
    v_add_f32 v193, v193, v197
    v_add_f32 v194, v194, v198
    v_add_f32 v195, v195, v199
    v_cvt_pk_bf16_f32 v196, v192, v193
    v_cvt_pk_bf16_f32 v197, v194, v195
    v_add_u32 v27, 34696, v4
    s_mov_b64 s[58:59], exec
    s_mov_b32 exec_lo, 0xffff
    s_mov_b32 exec_hi, 0
    ds_write_b64 v27, v[196:197]
    s_mov_b64 exec, s[58:59]
NOEX2_114:
    s_waitcnt vmcnt(14)
    v_add_f32 v128, v128, v132
    v_add_f32 v129, v129, v133
    v_add_f32 v130, v130, v134
    v_add_f32 v131, v131, v135
    s_waitcnt vmcnt(13)
    v_add_f32 v128, v128, v136
    v_add_f32 v129, v129, v137
    v_add_f32 v130, v130, v138
    v_add_f32 v131, v131, v139
    s_waitcnt vmcnt(12)
    v_add_f32 v128, v128, v140
    v_add_f32 v129, v129, v141
    v_add_f32 v130, v130, v142
    v_add_f32 v131, v131, v143
    s_waitcnt vmcnt(11)
    v_add_f32 v128, v128, v144
    v_add_f32 v129, v129, v145
    v_add_f32 v130, v130, v146
    v_add_f32 v131, v131, v147
    s_waitcnt vmcnt(10)
    v_add_f32 v128, v128, v148
    v_add_f32 v129, v129, v149
    v_add_f32 v130, v130, v150
    v_add_f32 v131, v131, v151
    s_waitcnt vmcnt(9)
    v_add_f32 v128, v128, v152
    v_add_f32 v129, v129, v153
    v_add_f32 v130, v130, v154
    v_add_f32 v131, v131, v155
    s_waitcnt vmcnt(8)
    v_add_f32 v128, v128, v156
    v_add_f32 v129, v129, v157
    v_add_f32 v130, v130, v158
    v_add_f32 v131, v131, v159
    s_waitcnt vmcnt(7)
    v_add_f32 v128, v128, v160
    v_add_f32 v129, v129, v161
    v_add_f32 v130, v130, v162
    v_add_f32 v131, v131, v163
    s_waitcnt vmcnt(6)
    v_add_f32 v128, v128, v164
    v_add_f32 v129, v129, v165
    v_add_f32 v130, v130, v166
    v_add_f32 v131, v131, v167
    s_waitcnt vmcnt(5)
    v_add_f32 v128, v128, v168
    v_add_f32 v129, v129, v169
    v_add_f32 v130, v130, v170
    v_add_f32 v131, v131, v171
    s_waitcnt vmcnt(4)
    v_add_f32 v128, v128, v172
    v_add_f32 v129, v129, v173
    v_add_f32 v130, v130, v174
    v_add_f32 v131, v131, v175
    s_waitcnt vmcnt(3)
    v_add_f32 v128, v128, v176
    v_add_f32 v129, v129, v177
    v_add_f32 v130, v130, v178
    v_add_f32 v131, v131, v179
    s_waitcnt vmcnt(2)
    v_add_f32 v128, v128, v180
    v_add_f32 v129, v129, v181
    v_add_f32 v130, v130, v182
    v_add_f32 v131, v131, v183
    s_waitcnt vmcnt(1)
    v_add_f32 v128, v128, v184
    v_add_f32 v129, v129, v185
    v_add_f32 v130, v130, v186
    v_add_f32 v131, v131, v187
    s_waitcnt vmcnt(0)
    v_add_f32 v128, v128, v188
    v_add_f32 v129, v129, v189
    v_add_f32 v130, v130, v190
    v_add_f32 v131, v131, v191
    v_cvt_pk_bf16_f32 v132, v128, v129
    v_cvt_pk_bf16_f32 v133, v130, v131
    v_accvgpr_read_b32 v26, a239
    ds_write_b64 v26, v[132:133]
    s_waitcnt lgkmcnt(0)
    s_barrier
    v_accvgpr_read_b32 v26, a237
    ds_read_b128 v[96:99], v26 offset:0
    ds_read_b128 v[100:103], v26 offset:544
    ds_read_b128 v[104:107], v26 offset:1088
    ds_read_b128 v[108:111], v26 offset:1632
    s_waitcnt lgkmcnt(3)
    v_mfma_f32_32x32x16_bf16 v[64:79], v[96:99], v[32:35], 0
    s_waitcnt lgkmcnt(1)
    v_mfma_f32_32x32x16_bf16 v[80:95], v[104:107], v[40:43], 0
    v_mfma_f32_32x32x16_bf16 v[64:79], v[100:103], v[36:39], v[64:79]
    s_waitcnt lgkmcnt(0)
    v_mfma_f32_32x32x16_bf16 v[80:95], v[108:111], v[44:47], v[80:95]
    s_barrier
    s_lshl_b32 s75, s71, 15
    s_lshl_b32 s76, s46, 11
    s_add_u32 s75, s75, s76
    s_add_u32 s75, s75, 4194304
    s_nop 4
    v_add_f32 v26, s53, v72
    v_rcp_f32 v26, v26
    v_add_f32 v27, s53, v88
    v_rcp_f32 v27, v27
    v_mul_f32 v64, v64, v26
    v_mul_f32 v65, v65, v26
    v_mul_f32 v66, v66, v26
    v_mul_f32 v67, v67, v26
    v_mul_f32 v68, v68, v26
    v_mul_f32 v69, v69, v26
    v_mul_f32 v70, v70, v26
    v_mul_f32 v71, v71, v26
    v_cvt_pk_bf16_f32 v128, v64, v65
    v_cvt_pk_bf16_f32 v129, v66, v67
    v_cvt_pk_bf16_f32 v130, v68, v69
    v_cvt_pk_bf16_f32 v131, v70, v71
    buffer_store_dwordx4 v[128:131], v4, s[32:35], s75 offen offset:0 sc1
    v_mul_f32 v80, v80, v27
    v_mul_f32 v81, v81, v27
    v_mul_f32 v82, v82, v27
    v_mul_f32 v83, v83, v27
    v_mul_f32 v84, v84, v27
    v_mul_f32 v85, v85, v27
    v_mul_f32 v86, v86, v27
    v_mul_f32 v87, v87, v27
    v_cvt_pk_bf16_f32 v132, v80, v81
    v_cvt_pk_bf16_f32 v133, v82, v83
    v_cvt_pk_bf16_f32 v134, v84, v85
    v_cvt_pk_bf16_f32 v135, v86, v87
    buffer_store_dwordx4 v[132:135], v4, s[32:35], s75 offen offset:1024 sc1
    s_add_u32 s98, s69, 0
    buffer_load_dwordx4 a[128:131], v6, s[24:27], s98 offen
    s_add_u32 s98, s69, 8192
    buffer_load_dwordx4 a[132:135], v6, s[24:27], s98 offen
    s_add_u32 s98, s69, 16384
    buffer_load_dwordx4 a[136:139], v6, s[24:27], s98 offen
    s_add_u32 s98, s69, 24576
    buffer_load_dwordx4 a[140:143], v6, s[24:27], s98 offen
    s_add_u32 s98, s69, 32768
    buffer_load_dwordx4 a[144:147], v6, s[24:27], s98 offen
    s_add_u32 s98, s69, 40960
    buffer_load_dwordx4 a[148:151], v6, s[24:27], s98 offen
    s_waitcnt vmcnt(6)
    v_accvgpr_read_b32 v25, a235
    s_mov_b64 s[58:59], exec
    s_mov_b32 exec_lo, 255
    s_mov_b32 exec_hi, 0
    v_mov_b32 v24, 1
    buffer_atomic_add v24, v25, s[32:35], 0 offen offset:4 sc1
    s_mov_b64 exec, s[58:59]
    s_add_u32 s98, s69, 49152
    buffer_load_dwordx4 a[152:155], v6, s[24:27], s98 offen
    s_add_u32 s98, s69, 57344
    buffer_load_dwordx4 a[156:159], v6, s[24:27], s98 offen
    s_lshl_b32 s78, s72, 15
    s_and_b32 s75, s44, 1
    s_lshl_b32 s75, s75, 14
    s_add_u32 s78, s78, s75
    s_add_u32 s78, s78, 4194304
    s_lshl_b32 s75, s75, 1
    s_add_u32 s75, s75, 98304
    v_add_u32 v112, s75, v14
    v_add_u32 v113, s75, v15
    s_add_u32 s3, s70, 4
    s_buffer_load_dword s4, s[32:35], s3 glc
    s_waitcnt lgkmcnt(0)
    s_cmp_ge_u32 s4, 8
    s_cbranch_scc1 PD_116
    s_mov_b32 s60, 0
PL_115:
    s_buffer_load_dword s4, s[32:35], s3 glc
    s_add_u32 s60, s60, 1
    s_cmp_gt_u32 s60, 0x80000
    s_cbranch_scc1 L_bail
    s_waitcnt lgkmcnt(0)
    s_cmp_lt_u32 s4, 8
    s_cbranch_scc1 PL_115
PD_116:
    s_add_u32 s98, s78, 0
    buffer_load_dwordx4 a[0:3], v4, s[32:35], s98 offen offset:0 sc1
    s_add_u32 s98, s78, 0
    buffer_load_dwordx4 a[4:7], v4, s[32:35], s98 offen offset:1024 sc1
    s_add_u32 s98, s78, 0
    buffer_load_dwordx4 a[8:11], v4, s[32:35], s98 offen offset:2048 sc1
    s_add_u32 s98, s78, 0
    buffer_load_dwordx4 a[12:15], v4, s[32:35], s98 offen offset:3072 sc1
    s_add_u32 s98, s78, 4096
    buffer_load_dwordx4 a[16:19], v4, s[32:35], s98 offen offset:0 sc1
    s_add_u32 s98, s78, 4096
    buffer_load_dwordx4 a[20:23], v4, s[32:35], s98 offen offset:1024 sc1
    s_add_u32 s98, s78, 4096
    buffer_load_dwordx4 a[24:27], v4, s[32:35], s98 offen offset:2048 sc1
    s_add_u32 s98, s78, 4096
    buffer_load_dwordx4 a[28:31], v4, s[32:35], s98 offen offset:3072 sc1
    s_add_u32 s98, s78, 8192
    buffer_load_dwordx4 a[32:35], v4, s[32:35], s98 offen offset:0 sc1
    s_add_u32 s98, s78, 8192
    buffer_load_dwordx4 a[36:39], v4, s[32:35], s98 offen offset:1024 sc1
    ds_read_b64_tr_b16 v[64:65], v112 offset:0
    ds_read_b64_tr_b16 v[66:67], v112 offset:1024
    ds_read_b64_tr_b16 v[68:69], v113 offset:0
    ds_read_b64_tr_b16 v[70:71], v113 offset:1024
    ds_read_b64_tr_b16 v[72:73], v112 offset:2048
    ds_read_b64_tr_b16 v[74:75], v112 offset:3072
    ds_read_b64_tr_b16 v[76:77], v113 offset:2048
    ds_read_b64_tr_b16 v[78:79], v113 offset:3072
    s_waitcnt vmcnt(9) lgkmcnt(6)
    v_mfma_f32_32x32x16_bf16 v[32:47], v[64:67], a[0:3], 0
    ds_read_b64_tr_b16 v[80:81], v112 offset:4096
    ds_read_b64_tr_b16 v[82:83], v112 offset:5120
    s_add_u32 s98, s78, 8192
    buffer_load_dwordx4 a[40:43], v4, s[32:35], s98 offen offset:2048 sc1
    s_waitcnt lgkmcnt(6)
    v_mfma_f32_32x32x16_bf16 v[48:63], v[68:71], a[0:3], 0
    ds_read_b64_tr_b16 v[84:85], v113 offset:4096
    ds_read_b64_tr_b16 v[86:87], v113 offset:5120
    s_waitcnt vmcnt(9) lgkmcnt(6)
    v_mfma_f32_32x32x16_bf16 v[32:47], v[72:75], a[4:7], v[32:47]
    ds_read_b64_tr_b16 v[64:65], v112 offset:6144
    ds_read_b64_tr_b16 v[66:67], v112 offset:7168
    s_add_u32 s98, s78, 8192
    buffer_load_dwordx4 a[44:47], v4, s[32:35], s98 offen offset:3072 sc1
    s_waitcnt lgkmcnt(6)
    v_mfma_f32_32x32x16_bf16 v[48:63], v[76:79], a[4:7], v[48:63]
    ds_read_b64_tr_b16 v[68:69], v113 offset:6144
    ds_read_b64_tr_b16 v[70:71], v113 offset:7168
    s_waitcnt vmcnt(9) lgkmcnt(6)
    v_mfma_f32_32x32x16_bf16 v[32:47], v[80:83], a[8:11], v[32:47]
    ds_read_b64_tr_b16 v[72:73], v112 offset:8192
    ds_read_b64_tr_b16 v[74:75], v112 offset:9216
    s_add_u32 s98, s78, 12288
    buffer_load_dwordx4 a[48:51], v4, s[32:35], s98 offen offset:0 sc1
    s_waitcnt lgkmcnt(6)
    v_mfma_f32_32x32x16_bf16 v[48:63], v[84:87], a[8:11], v[48:63]
    ds_read_b64_tr_b16 v[76:77], v113 offset:8192
    ds_read_b64_tr_b16 v[78:79], v113 offset:9216
    s_waitcnt vmcnt(9) lgkmcnt(6)
    v_mfma_f32_32x32x16_bf16 v[32:47], v[64:67], a[12:15], v[32:47]
    ds_read_b64_tr_b16 v[80:81], v112 offset:10240
    ds_read_b64_tr_b16 v[82:83], v112 offset:11264
    s_add_u32 s98, s78, 12288
    buffer_load_dwordx4 a[52:55], v4, s[32:35], s98 offen offset:1024 sc1
    s_waitcnt lgkmcnt(6)
    v_mfma_f32_32x32x16_bf16 v[48:63], v[68:71], a[12:15], v[48:63]
    ds_read_b64_tr_b16 v[84:85], v113 offset:10240
    ds_read_b64_tr_b16 v[86:87], v113 offset:11264
    s_waitcnt vmcnt(9) lgkmcnt(6)
    v_mfma_f32_32x32x16_bf16 v[32:47], v[72:75], a[16:19], v[32:47]
    ds_read_b64_tr_b16 v[64:65], v112 offset:12288
    ds_read_b64_tr_b16 v[66:67], v112 offset:13312
    s_add_u32 s98, s78, 12288
    buffer_load_dwordx4 a[56:59], v4, s[32:35], s98 offen offset:2048 sc1
    s_waitcnt lgkmcnt(6)
    v_mfma_f32_32x32x16_bf16 v[48:63], v[76:79], a[16:19], v[48:63]
    ds_read_b64_tr_b16 v[68:69], v113 offset:12288
    ds_read_b64_tr_b16 v[70:71], v113 offset:13312
    v_accvgpr_read_b32 v193, a240
    v_lshlrev_b32 v192, 16, v193
    s_waitcnt vmcnt(9) lgkmcnt(6)
    v_mfma_f32_32x32x16_bf16 v[32:47], v[80:83], a[20:23], v[32:47]
    ds_read_b64_tr_b16 v[72:73], v112 offset:14336
    ds_read_b64_tr_b16 v[74:75], v112 offset:15360
    s_add_u32 s98, s78, 12288
    buffer_load_dwordx4 a[60:63], v4, s[32:35], s98 offen offset:3072 sc1
    s_waitcnt lgkmcnt(6)
    v_mfma_f32_32x32x16_bf16 v[48:63], v[84:87], a[20:23], v[48:63]
    ds_read_b64_tr_b16 v[76:77], v113 offset:14336
    ds_read_b64_tr_b16 v[78:79], v113 offset:15360
    v_and_b32 v193, 0xffff0000, v193
    v_accvgpr_read_b32 v195, a241
    s_waitcnt vmcnt(9) lgkmcnt(6)
    v_mfma_f32_32x32x16_bf16 v[32:47], v[64:67], a[24:27], v[32:47]
    ds_read_b64_tr_b16 v[80:81], v112 offset:16384
    ds_read_b64_tr_b16 v[82:83], v112 offset:17408
    s_waitcnt lgkmcnt(6)
    v_mfma_f32_32x32x16_bf16 v[48:63], v[68:71], a[24:27], v[48:63]
    ds_read_b64_tr_b16 v[84:85], v113 offset:16384
    ds_read_b64_tr_b16 v[86:87], v113 offset:17408
    v_lshlrev_b32 v194, 16, v195
    v_and_b32 v195, 0xffff0000, v195
    s_add_u32 s99, s65, 917504
    s_add_u32 m0, s62, 65536
    s_nop 0
    buffer_load_dwordx4 v7, s[20:23], s99 offen lds
    s_waitcnt vmcnt(9) lgkmcnt(6)
    v_mfma_f32_32x32x16_bf16 v[32:47], v[72:75], a[28:31], v[32:47]
    ds_read_b64_tr_b16 v[64:65], v112 offset:18432
    ds_read_b64_tr_b16 v[66:67], v112 offset:19456
    s_waitcnt lgkmcnt(6)
    v_mfma_f32_32x32x16_bf16 v[48:63], v[76:79], a[28:31], v[48:63]
    ds_read_b64_tr_b16 v[68:69], v113 offset:18432
    ds_read_b64_tr_b16 v[70:71], v113 offset:19456
    v_accvgpr_read_b32 v197, a242
    v_lshlrev_b32 v196, 16, v197
    s_add_u32 s99, s65, 946176
    s_add_u32 m0, s62, 66560
    s_nop 0
    buffer_load_dwordx4 v7, s[20:23], s99 offen lds
    s_waitcnt vmcnt(9) lgkmcnt(6)
    v_mfma_f32_32x32x16_bf16 v[32:47], v[80:83], a[32:35], v[32:47]
    ds_read_b64_tr_b16 v[72:73], v112 offset:20480
    ds_read_b64_tr_b16 v[74:75], v112 offset:21504
    s_waitcnt lgkmcnt(6)
    v_mfma_f32_32x32x16_bf16 v[48:63], v[84:87], a[32:35], v[48:63]
    ds_read_b64_tr_b16 v[76:77], v113 offset:20480
    ds_read_b64_tr_b16 v[78:79], v113 offset:21504
    v_and_b32 v197, 0xffff0000, v197
    v_accvgpr_read_b32 v199, a243
    s_add_u32 s99, s65, 974848
    s_add_u32 m0, s62, 67584
    s_nop 0
    buffer_load_dwordx4 v7, s[20:23], s99 offen lds
    s_waitcnt vmcnt(9) lgkmcnt(6)
    v_mfma_f32_32x32x16_bf16 v[32:47], v[64:67], a[36:39], v[32:47]
    ds_read_b64_tr_b16 v[80:81], v112 offset:22528
    ds_read_b64_tr_b16 v[82:83], v112 offset:23552
    s_waitcnt lgkmcnt(6)
    v_mfma_f32_32x32x16_bf16 v[48:63], v[68:71], a[36:39], v[48:63]
    ds_read_b64_tr_b16 v[84:85], v113 offset:22528
    ds_read_b64_tr_b16 v[86:87], v113 offset:23552
    v_lshlrev_b32 v198, 16, v199
    v_and_b32 v199, 0xffff0000, v199
    s_add_u32 s99, s65, 1003520
    s_add_u32 m0, s62, 68608
    s_nop 0
    buffer_load_dwordx4 v7, s[20:23], s99 offen lds
    s_waitcnt vmcnt(9) lgkmcnt(6)
    v_mfma_f32_32x32x16_bf16 v[32:47], v[72:75], a[40:43], v[32:47]
    ds_read_b64_tr_b16 v[64:65], v112 offset:24576
    ds_read_b64_tr_b16 v[66:67], v112 offset:25600
    s_waitcnt lgkmcnt(6)
    v_mfma_f32_32x32x16_bf16 v[48:63], v[76:79], a[40:43], v[48:63]
    ds_read_b64_tr_b16 v[68:69], v113 offset:24576
    ds_read_b64_tr_b16 v[70:71], v113 offset:25600
    v_accvgpr_read_b32 v201, a244
    v_lshlrev_b32 v200, 16, v201
    s_add_u32 s99, s65, 1032192
    s_add_u32 m0, s62, 69632
    s_nop 0
    buffer_load_dwordx4 v7, s[20:23], s99 offen lds
    s_waitcnt vmcnt(9) lgkmcnt(6)
    v_mfma_f32_32x32x16_bf16 v[32:47], v[80:83], a[44:47], v[32:47]
    ds_read_b64_tr_b16 v[72:73], v112 offset:26624
    ds_read_b64_tr_b16 v[74:75], v112 offset:27648
    s_waitcnt lgkmcnt(6)
    v_mfma_f32_32x32x16_bf16 v[48:63], v[84:87], a[44:47], v[48:63]
    ds_read_b64_tr_b16 v[76:77], v113 offset:26624
    ds_read_b64_tr_b16 v[78:79], v113 offset:27648
    v_and_b32 v201, 0xffff0000, v201
    v_accvgpr_read_b32 v203, a245
    s_add_u32 s99, s65, 1060864
    s_add_u32 m0, s62, 70656
    s_nop 0
    buffer_load_dwordx4 v7, s[20:23], s99 offen lds
    s_waitcnt vmcnt(9) lgkmcnt(6)
    v_mfma_f32_32x32x16_bf16 v[32:47], v[64:67], a[48:51], v[32:47]
    ds_read_b64_tr_b16 v[80:81], v112 offset:28672
    ds_read_b64_tr_b16 v[82:83], v112 offset:29696
    s_waitcnt lgkmcnt(6)
    v_mfma_f32_32x32x16_bf16 v[48:63], v[68:71], a[48:51], v[48:63]
    ds_read_b64_tr_b16 v[84:85], v113 offset:28672
    ds_read_b64_tr_b16 v[86:87], v113 offset:29696
    v_lshlrev_b32 v202, 16, v203
    v_and_b32 v203, 0xffff0000, v203
    s_add_u32 s99, s65, 1089536
    s_add_u32 m0, s62, 71680
    s_nop 0
    buffer_load_dwordx4 v7, s[20:23], s99 offen lds
    s_waitcnt vmcnt(9) lgkmcnt(6)
    v_mfma_f32_32x32x16_bf16 v[32:47], v[72:75], a[52:55], v[32:47]
    ds_read_b64_tr_b16 v[64:65], v112 offset:30720
    ds_read_b64_tr_b16 v[66:67], v112 offset:31744
    s_waitcnt lgkmcnt(6)
    v_mfma_f32_32x32x16_bf16 v[48:63], v[76:79], a[52:55], v[48:63]
    ds_read_b64_tr_b16 v[68:69], v113 offset:30720
    ds_read_b64_tr_b16 v[70:71], v113 offset:31744
    v_accvgpr_read_b32 v205, a246
    v_lshlrev_b32 v204, 16, v205
    s_add_u32 s99, s65, 1118208
    s_add_u32 m0, s62, 72704
    s_nop 0
    buffer_load_dwordx4 v7, s[20:23], s99 offen lds
    s_waitcnt vmcnt(9) lgkmcnt(6)
    v_mfma_f32_32x32x16_bf16 v[32:47], v[80:83], a[56:59], v[32:47]
    s_waitcnt lgkmcnt(4)
    v_mfma_f32_32x32x16_bf16 v[48:63], v[84:87], a[56:59], v[48:63]
    v_and_b32 v205, 0xffff0000, v205
    v_accvgpr_read_b32 v207, a247
    s_waitcnt vmcnt(8) lgkmcnt(2)
    v_mfma_f32_32x32x16_bf16 v[32:47], v[64:67], a[60:63], v[32:47]
    s_waitcnt lgkmcnt(0)
    v_mfma_f32_32x32x16_bf16 v[48:63], v[68:71], a[60:63], v[48:63]
    v_lshlrev_b32 v206, 16, v207
    v_and_b32 v207, 0xffff0000, v207
    s_lshl_b32 s84, s44, 12
    s_xor_b32 s85, s84, 4096
    v_add_u32 v26, s84, v4
    v_add_u32 v27, s85, v4
    s_nop 5
    ds_write_b128 v26, v[48:51] offset:32768
    ds_write_b128 v26, v[52:55] offset:33792
    ds_write_b128 v26, v[56:59] offset:34816
    ds_write_b128 v26, v[60:63] offset:35840
    s_waitcnt lgkmcnt(0)
    s_barrier
    ds_read_b128 v[128:131], v27 offset:32768
    ds_read_b128 v[132:135], v27 offset:33792
    ds_read_b128 v[136:139], v27 offset:34816
    ds_read_b128 v[140:143], v27 offset:35840
    s_waitcnt lgkmcnt(3)
    v_pk_add_f32 v[32:33], v[32:33], v[128:129]
    v_pk_add_f32 v[34:35], v[34:35], v[130:131]
    s_waitcnt lgkmcnt(2)
    v_pk_add_f32 v[36:37], v[36:37], v[132:133]
    v_pk_add_f32 v[38:39], v[38:39], v[134:135]
    s_waitcnt lgkmcnt(1)
    v_pk_add_f32 v[40:41], v[40:41], v[136:137]
    v_pk_add_f32 v[42:43], v[42:43], v[138:139]
    s_waitcnt lgkmcnt(0)
    v_pk_add_f32 v[44:45], v[44:45], v[140:141]
    v_pk_add_f32 v[46:47], v[46:47], v[142:143]
    v_pk_add_f32 v[32:33], v[32:33], v[192:193]
    v_pk_add_f32 v[34:35], v[34:35], v[194:195]
    v_pk_add_f32 v[36:37], v[36:37], v[196:197]
    v_pk_add_f32 v[38:39], v[38:39], v[198:199]
    v_pk_add_f32 v[40:41], v[40:41], v[200:201]
    v_pk_add_f32 v[42:43], v[42:43], v[202:203]
    v_pk_add_f32 v[44:45], v[44:45], v[204:205]
    v_pk_add_f32 v[46:47], v[46:47], v[206:207]
    v_cvt_pk_bf16_f32 v160, v32, v33
    v_cvt_pk_bf16_f32 v161, v34, v35
    v_cvt_pk_bf16_f32 v162, v36, v37
    v_cvt_pk_bf16_f32 v163, v38, v39
    v_cvt_pk_bf16_f32 v164, v40, v41
    v_cvt_pk_bf16_f32 v165, v42, v43
    v_cvt_pk_bf16_f32 v166, v44, v45
    v_cvt_pk_bf16_f32 v167, v46, v47
    s_lshl_b32 s76, s72, 15
    s_lshl_b32 s77, s73, 11
    s_add_u32 s76, s76, s77
    s_add_u32 s76, s76, 8388608
    buffer_store_dwordx4 v[160:163], v4, s[32:35], s76 offen sc1
    buffer_store_dwordx4 v[164:167], v4, s[32:35], s76 offen offset:1024 sc1
    v_mov_b32 v168, 0
    v_mov_b32 v169, 0
    v_mov_b32 v172, 0
    v_mov_b32 v173, 0
    v_mov_b32 v170, 0x3f803f80
    v_dot2c_f32_bf16 v168, v160, v170
    v_dot2c_f32_bf16 v169, v160, v160
    v_dot2c_f32_bf16 v172, v161, v170
    v_dot2c_f32_bf16 v173, v161, v161
    v_dot2c_f32_bf16 v168, v162, v170
    v_dot2c_f32_bf16 v169, v162, v162
    v_dot2c_f32_bf16 v172, v163, v170
    v_dot2c_f32_bf16 v173, v163, v163
    v_dot2c_f32_bf16 v168, v164, v170
    v_dot2c_f32_bf16 v169, v164, v164
    v_dot2c_f32_bf16 v172, v165, v170
    v_dot2c_f32_bf16 v173, v165, v165
    v_dot2c_f32_bf16 v168, v166, v170
    v_dot2c_f32_bf16 v169, v166, v166
    v_dot2c_f32_bf16 v172, v167, v170
    v_dot2c_f32_bf16 v173, v167, v167
    s_nop 1
    v_add_f32 v168, v168, v172
    v_add_f32 v169, v169, v173
    v_mov_b32 v171, v168
    v_mov_b32 v172, v169
    v_nop
    v_permlane32_swap_b32 v168, v171
    v_permlane32_swap_b32 v169, v172
    v_add_f32 v168, v168, v171
    v_add_f32 v169, v169, v172
    s_lshl_b32 s76, s72, 12
    s_lshl_b32 s77, s73, 8
    s_add_u32 s76, s76, s77
    s_add_u32 s76, s76, 2883584
    v_lshlrev_b32 v171, 3, v2
    s_mov_b64 s[58:59], exec
    s_mov_b32 exec_hi, 0
    buffer_store_dwordx2 v[168:169], v171, s[32:35], s76 offen sc1
    s_mov_b64 exec, s[58:59]
    v_accvgpr_write_b32 a240, v160
    v_accvgpr_write_b32 a241, v161
    v_accvgpr_write_b32 a242, v162
    v_accvgpr_write_b32 a243, v163
    v_accvgpr_write_b32 a244, v164
    v_accvgpr_write_b32 a245, v165
    v_accvgpr_write_b32 a246, v166
    v_accvgpr_write_b32 a247, v167
    s_waitcnt lgkmcnt(0)
    s_barrier
    s_add_u32 s99, s65, 458752
    s_add_u32 m0, s62, 32768
    s_nop 0
    buffer_load_dwordx4 v7, s[20:23], s99 offen lds
    s_add_u32 s99, s65, 487424
    s_add_u32 m0, s62, 33792
    s_nop 0
    buffer_load_dwordx4 v7, s[20:23], s99 offen lds
    s_add_u32 s99, s65, 516096
    s_add_u32 m0, s62, 34816
    s_nop 0
    buffer_load_dwordx4 v7, s[20:23], s99 offen lds
    s_add_u32 s99, s65, 544768
    s_add_u32 m0, s62, 35840
    s_nop 0
    buffer_load_dwordx4 v7, s[20:23], s99 offen lds
    s_add_u32 s99, s65, 573440
    s_add_u32 m0, s62, 36864
    s_nop 0
    buffer_load_dwordx4 v7, s[20:23], s99 offen lds
    s_add_u32 s99, s65, 602112
    s_add_u32 m0, s62, 37888
    s_nop 0
    buffer_load_dwordx4 v7, s[20:23], s99 offen lds
    s_add_u32 s99, s65, 630784
    s_add_u32 m0, s62, 38912
    s_nop 0
    buffer_load_dwordx4 v7, s[20:23], s99 offen lds
    s_add_u32 s99, s65, 659456
    s_add_u32 m0, s62, 39936
    s_nop 0
    buffer_load_dwordx4 v7, s[20:23], s99 offen lds
    s_waitcnt vmcnt(8)
    v_accvgpr_read_b32 v25, a234
    s_mov_b64 s[58:59], exec
    s_mov_b32 exec_lo, 65535
    s_mov_b32 exec_hi, 0
    v_mov_b32 v24, 1
    buffer_atomic_add v24, v25, s[32:35], 0 offen offset:8 sc1
    s_mov_b64 exec, s[58:59]
    s_add_u32 s99, s65, 1376256
    s_add_u32 m0, s62, 98304
    s_nop 0
    buffer_load_dwordx4 v7, s[20:23], s99 offen lds
    s_add_u32 s99, s65, 1404928
    s_add_u32 m0, s62, 99328
    s_nop 0
    buffer_load_dwordx4 v7, s[20:23], s99 offen lds
    s_add_u32 s99, s65, 1433600
    s_add_u32 m0, s62, 100352
    s_nop 0
    buffer_load_dwordx4 v7, s[20:23], s99 offen lds
    s_add_u32 s99, s65, 1462272
    s_add_u32 m0, s62, 101376
    s_nop 0
    buffer_load_dwordx4 v7, s[20:23], s99 offen lds
    s_add_u32 s99, s65, 1490944
    s_add_u32 m0, s62, 102400
    s_nop 0
    buffer_load_dwordx4 v7, s[20:23], s99 offen lds
    s_add_u32 s99, s65, 1519616
    s_add_u32 m0, s62, 103424
    s_nop 0
    buffer_load_dwordx4 v7, s[20:23], s99 offen lds
    s_add_u32 s99, s65, 1548288
    s_add_u32 m0, s62, 104448
    s_nop 0
    buffer_load_dwordx4 v7, s[20:23], s99 offen lds
    s_add_u32 s99, s65, 1576960
    s_add_u32 m0, s62, 105472
    s_nop 0
    buffer_load_dwordx4 v7, s[20:23], s99 offen lds
    s_add_u32 s99, s66, 0
    s_add_u32 m0, s67, 131072
    s_nop 0
    buffer_load_dwordx4 v4, s[32:35], s99 offen offset:0 lds
    buffer_load_dwordx4 v4, s[32:35], s99 offen offset:1024 lds
    buffer_load_dwordx4 v4, s[32:35], s99 offen offset:2048 lds
    buffer_load_dwordx4 v4, s[32:35], s99 offen offset:3072 lds
    s_add_u32 s99, s66, 4096
    s_add_u32 m0, s67, 135168
    s_nop 0
    buffer_load_dwordx4 v4, s[32:35], s99 offen offset:0 lds
    buffer_load_dwordx4 v4, s[32:35], s99 offen offset:1024 lds
    s_add_u32 s98, s69, 65536
    buffer_load_dwordx4 a[160:163], v6, s[24:27], s98 offen
    s_add_u32 s98, s69, 73728
    buffer_load_dwordx4 a[164:167], v6, s[24:27], s98 offen
    s_add_u32 s98, s69, 81920
    buffer_load_dwordx4 a[168:171], v6, s[24:27], s98 offen
    s_add_u32 s98, s69, 90112
    buffer_load_dwordx4 a[172:175], v6, s[24:27], s98 offen
    s_add_u32 s98, s69, 98304
    buffer_load_dwordx4 a[176:179], v6, s[24:27], s98 offen
    s_add_u32 s98, s69, 106496
    buffer_load_dwordx4 a[180:183], v6, s[24:27], s98 offen
    s_add_u32 s98, s69, 114688
    buffer_load_dwordx4 a[184:187], v6, s[24:27], s98 offen
    s_add_u32 s98, s69, 122880
    buffer_load_dwordx4 a[188:191], v6, s[24:27], s98 offen
    s_add_u32 s3, s70, 8
    s_buffer_load_dword s4, s[32:35], s3 glc
    s_waitcnt lgkmcnt(0)
    s_cmp_ge_u32 s4, 16
    s_cbranch_scc1 PD_118
    s_mov_b32 s60, 0
PL_117:
    s_buffer_load_dword s4, s[32:35], s3 glc
    s_add_u32 s60, s60, 1
    s_cmp_gt_u32 s60, 0x80000
    s_cbranch_scc1 L_bail
    s_waitcnt lgkmcnt(0)
    s_cmp_lt_u32 s4, 16
    s_cbranch_scc1 PL_117
PD_118:
    s_lshl_b32 s74, s71, 15
    s_add_u32 s74, s74, 8388608
    s_mov_b32 s76, s74
    s_add_u32 s98, s76, 0
    buffer_load_dwordx4 a[0:3], v4, s[32:35], s98 offen offset:0 sc1
    s_add_u32 s98, s76, 0
    buffer_load_dwordx4 a[4:7], v4, s[32:35], s98 offen offset:1024 sc1
    s_add_u32 s98, s76, 0
    buffer_load_dwordx4 a[8:11], v4, s[32:35], s98 offen offset:2048 sc1
    s_add_u32 s98, s76, 0
    buffer_load_dwordx4 a[12:15], v4, s[32:35], s98 offen offset:3072 sc1
    s_add_u32 s98, s76, 4096
    buffer_load_dwordx4 a[16:19], v4, s[32:35], s98 offen offset:0 sc1
    s_add_u32 s98, s76, 4096
    buffer_load_dwordx4 a[20:23], v4, s[32:35], s98 offen offset:1024 sc1
    s_add_u32 s98, s76, 4096
    buffer_load_dwordx4 a[24:27], v4, s[32:35], s98 offen offset:2048 sc1
    s_add_u32 s98, s76, 4096
    buffer_load_dwordx4 a[28:31], v4, s[32:35], s98 offen offset:3072 sc1
    s_mul_i32 s88, s71, 114688
    s_add_u32 s88, s88, 16777216
    s_mul_i32 s89, s46, 3072
    s_add_u32 s89, s89, s88
    s_add_u32 s89, s89, 65536
    s_lshl_b32 s75, s46, 12
    s_add_u32 s88, s88, s75
    s_waitcnt vmcnt(16)
    s_barrier
    v_add_u32 v212, 0, v16
    v_add_u32 v213, 0, v17
    v_add_u32 v214, 0, v18
    v_add_u32 v215, 0, v19
    ds_read_b64_tr_b16 v[144:145], v212 offset:0
    ds_read_b64_tr_b16 v[146:147], v212 offset:1024
    ds_read_b64_tr_b16 v[148:149], v213 offset:0
    ds_read_b64_tr_b16 v[150:151], v213 offset:1024
    ds_read_b64_tr_b16 v[152:153], v214 offset:0
    ds_read_b64_tr_b16 v[154:155], v214 offset:1024
    ds_read_b64_tr_b16 v[156:157], v215 offset:0
    ds_read_b64_tr_b16 v[158:159], v215 offset:1024
    ds_read_b64_tr_b16 v[160:161], v212 offset:2048
    ds_read_b64_tr_b16 v[162:163], v212 offset:3072
    ds_read_b64_tr_b16 v[164:165], v213 offset:2048
    ds_read_b64_tr_b16 v[166:167], v213 offset:3072
    ds_read_b64_tr_b16 v[168:169], v214 offset:2048
    ds_read_b64_tr_b16 v[170:171], v214 offset:3072
    ds_read_b64_tr_b16 v[172:173], v215 offset:2048
    ds_read_b64_tr_b16 v[174:175], v215 offset:3072
    s_waitcnt lgkmcnt(8)
    s_waitcnt vmcnt(7)
    v_mfma_f32_32x32x16_bf16 v[32:47], v[144:147], a[0:3], 0
    ds_read_b64_tr_b16 v[176:177], v212 offset:4096
    ds_read_b64_tr_b16 v[178:179], v212 offset:5120
    s_add_u32 s98, s76, 8192
    buffer_load_dwordx4 a[32:35], v4, s[32:35], s98 offen offset:0 sc1
    v_mfma_f32_32x32x16_bf16 v[48:63], v[148:151], a[0:3], 0
    ds_read_b64_tr_b16 v[180:181], v213 offset:4096
    ds_read_b64_tr_b16 v[182:183], v213 offset:5120
    v_mfma_f32_32x32x16_bf16 v[64:79], v[152:155], a[0:3], 0
    ds_read_b64_tr_b16 v[184:185], v214 offset:4096
    ds_read_b64_tr_b16 v[186:187], v214 offset:5120
    s_add_u32 s98, s76, 8192
    buffer_load_dwordx4 a[36:39], v4, s[32:35], s98 offen offset:1024 sc1
    v_mfma_f32_32x32x16_bf16 v[80:95], v[156:159], a[0:3], 0
    ds_read_b64_tr_b16 v[188:189], v215 offset:4096
    ds_read_b64_tr_b16 v[190:191], v215 offset:5120
    s_waitcnt lgkmcnt(8)
    s_waitcnt vmcnt(8)
    v_mfma_f32_32x32x16_bf16 v[32:47], v[160:163], a[4:7], v[32:47]
    ds_read_b64_tr_b16 v[144:145], v212 offset:6144
    ds_read_b64_tr_b16 v[146:147], v212 offset:7168
    s_add_u32 s98, s76, 8192
    buffer_load_dwordx4 a[40:43], v4, s[32:35], s98 offen offset:2048 sc1
    v_mfma_f32_32x32x16_bf16 v[48:63], v[164:167], a[4:7], v[48:63]
    ds_read_b64_tr_b16 v[148:149], v213 offset:6144
    ds_read_b64_tr_b16 v[150:151], v213 offset:7168
    v_mfma_f32_32x32x16_bf16 v[64:79], v[168:171], a[4:7], v[64:79]
    ds_read_b64_tr_b16 v[152:153], v214 offset:6144
    ds_read_b64_tr_b16 v[154:155], v214 offset:7168
    s_add_u32 s98, s76, 8192
    buffer_load_dwordx4 a[44:47], v4, s[32:35], s98 offen offset:3072 sc1
    v_mfma_f32_32x32x16_bf16 v[80:95], v[172:175], a[4:7], v[80:95]
    ds_read_b64_tr_b16 v[156:157], v215 offset:6144
    ds_read_b64_tr_b16 v[158:159], v215 offset:7168
    s_waitcnt lgkmcnt(8)
    s_waitcnt vmcnt(9)
    v_mfma_f32_32x32x16_bf16 v[32:47], v[176:179], a[8:11], v[32:47]
    ds_read_b64_tr_b16 v[160:161], v212 offset:8192
    ds_read_b64_tr_b16 v[162:163], v212 offset:9216
    s_add_u32 s98, s76, 12288
    buffer_load_dwordx4 a[48:51], v4, s[32:35], s98 offen offset:0 sc1
    v_mfma_f32_32x32x16_bf16 v[48:63], v[180:183], a[8:11], v[48:63]
    ds_read_b64_tr_b16 v[164:165], v213 offset:8192
    ds_read_b64_tr_b16 v[166:167], v213 offset:9216
    v_mfma_f32_32x32x16_bf16 v[64:79], v[184:187], a[8:11], v[64:79]
    ds_read_b64_tr_b16 v[168:169], v214 offset:8192
    ds_read_b64_tr_b16 v[170:171], v214 offset:9216
    s_add_u32 s98, s76, 12288
    buffer_load_dwordx4 a[52:55], v4, s[32:35], s98 offen offset:1024 sc1
    v_mfma_f32_32x32x16_bf16 v[80:95], v[188:191], a[8:11], v[80:95]
    ds_read_b64_tr_b16 v[172:173], v215 offset:8192
    ds_read_b64_tr_b16 v[174:175], v215 offset:9216
    s_waitcnt lgkmcnt(8)
    s_waitcnt vmcnt(10)
    v_mfma_f32_32x32x16_bf16 v[32:47], v[144:147], a[12:15], v[32:47]
    ds_read_b64_tr_b16 v[176:177], v212 offset:10240
    ds_read_b64_tr_b16 v[178:179], v212 offset:11264
    s_add_u32 s98, s76, 12288
    buffer_load_dwordx4 a[56:59], v4, s[32:35], s98 offen offset:2048 sc1
    v_mfma_f32_32x32x16_bf16 v[48:63], v[148:151], a[12:15], v[48:63]
    ds_read_b64_tr_b16 v[180:181], v213 offset:10240
    ds_read_b64_tr_b16 v[182:183], v213 offset:11264
    v_mfma_f32_32x32x16_bf16 v[64:79], v[152:155], a[12:15], v[64:79]
    ds_read_b64_tr_b16 v[184:185], v214 offset:10240
    ds_read_b64_tr_b16 v[186:187], v214 offset:11264
    s_add_u32 s98, s76, 12288
    buffer_load_dwordx4 a[60:63], v4, s[32:35], s98 offen offset:3072 sc1
    v_mfma_f32_32x32x16_bf16 v[80:95], v[156:159], a[12:15], v[80:95]
    ds_read_b64_tr_b16 v[188:189], v215 offset:10240
    ds_read_b64_tr_b16 v[190:191], v215 offset:11264
    s_waitcnt lgkmcnt(8)
    s_waitcnt vmcnt(11)
    v_mfma_f32_32x32x16_bf16 v[32:47], v[160:163], a[16:19], v[32:47]
    ds_read_b64_tr_b16 v[144:145], v212 offset:12288
    ds_read_b64_tr_b16 v[146:147], v212 offset:13312
    s_add_u32 s98, s76, 16384
    buffer_load_dwordx4 a[64:67], v4, s[32:35], s98 offen offset:0 sc1
    v_mfma_f32_32x32x16_bf16 v[48:63], v[164:167], a[16:19], v[48:63]
    ds_read_b64_tr_b16 v[148:149], v213 offset:12288
    ds_read_b64_tr_b16 v[150:151], v213 offset:13312
    v_mfma_f32_32x32x16_bf16 v[64:79], v[168:171], a[16:19], v[64:79]
    ds_read_b64_tr_b16 v[152:153], v214 offset:12288
    ds_read_b64_tr_b16 v[154:155], v214 offset:13312
    s_add_u32 s98, s76, 16384
    buffer_load_dwordx4 a[68:71], v4, s[32:35], s98 offen offset:1024 sc1
    v_mfma_f32_32x32x16_bf16 v[80:95], v[172:175], a[16:19], v[80:95]
    ds_read_b64_tr_b16 v[156:157], v215 offset:12288
    ds_read_b64_tr_b16 v[158:159], v215 offset:13312
    s_waitcnt lgkmcnt(8)
    s_waitcnt vmcnt(12)
    v_mfma_f32_32x32x16_bf16 v[32:47], v[176:179], a[20:23], v[32:47]
    ds_read_b64_tr_b16 v[160:161], v212 offset:14336
    ds_read_b64_tr_b16 v[162:163], v212 offset:15360
    s_add_u32 s98, s76, 16384
    buffer_load_dwordx4 a[72:75], v4, s[32:35], s98 offen offset:2048 sc1
    v_mfma_f32_32x32x16_bf16 v[48:63], v[180:183], a[20:23], v[48:63]
    ds_read_b64_tr_b16 v[164:165], v213 offset:14336
    ds_read_b64_tr_b16 v[166:167], v213 offset:15360
    v_mfma_f32_32x32x16_bf16 v[64:79], v[184:187], a[20:23], v[64:79]
    ds_read_b64_tr_b16 v[168:169], v214 offset:14336
    ds_read_b64_tr_b16 v[170:171], v214 offset:15360
    s_add_u32 s98, s76, 16384
    buffer_load_dwordx4 a[76:79], v4, s[32:35], s98 offen offset:3072 sc1
    v_mfma_f32_32x32x16_bf16 v[80:95], v[188:191], a[20:23], v[80:95]
    ds_read_b64_tr_b16 v[172:173], v215 offset:14336
    ds_read_b64_tr_b16 v[174:175], v215 offset:15360
    v_add_u32 v216, 32768, v16
    v_add_u32 v217, 32768, v17
    v_add_u32 v218, 32768, v18
    v_add_u32 v219, 32768, v19
    s_waitcnt lgkmcnt(8)
    s_waitcnt vmcnt(13)
    v_mfma_f32_32x32x16_bf16 v[32:47], v[144:147], a[24:27], v[32:47]
    ds_read_b64_tr_b16 v[176:177], v216 offset:0
    ds_read_b64_tr_b16 v[178:179], v216 offset:1024
    s_add_u32 s98, s76, 20480
    buffer_load_dwordx4 a[80:83], v4, s[32:35], s98 offen offset:0 sc1
    v_mfma_f32_32x32x16_bf16 v[48:63], v[148:151], a[24:27], v[48:63]
    ds_read_b64_tr_b16 v[180:181], v217 offset:0
    ds_read_b64_tr_b16 v[182:183], v217 offset:1024
    v_mfma_f32_32x32x16_bf16 v[64:79], v[152:155], a[24:27], v[64:79]
    ds_read_b64_tr_b16 v[184:185], v218 offset:0
    ds_read_b64_tr_b16 v[186:187], v218 offset:1024
    s_add_u32 s98, s76, 20480
    buffer_load_dwordx4 a[84:87], v4, s[32:35], s98 offen offset:1024 sc1
    v_mfma_f32_32x32x16_bf16 v[80:95], v[156:159], a[24:27], v[80:95]
    ds_read_b64_tr_b16 v[188:189], v219 offset:0
    ds_read_b64_tr_b16 v[190:191], v219 offset:1024
    s_waitcnt lgkmcnt(8)
    s_waitcnt vmcnt(14)
    v_mfma_f32_32x32x16_bf16 v[32:47], v[160:163], a[28:31], v[32:47]
    ds_read_b64_tr_b16 v[144:145], v216 offset:2048
    ds_read_b64_tr_b16 v[146:147], v216 offset:3072
    s_add_u32 s98, s76, 20480
    buffer_load_dwordx4 a[88:91], v4, s[32:35], s98 offen offset:2048 sc1
    v_mfma_f32_32x32x16_bf16 v[48:63], v[164:167], a[28:31], v[48:63]
    ds_read_b64_tr_b16 v[148:149], v217 offset:2048
    ds_read_b64_tr_b16 v[150:151], v217 offset:3072
    v_mfma_f32_32x32x16_bf16 v[64:79], v[168:171], a[28:31], v[64:79]
    ds_read_b64_tr_b16 v[152:153], v218 offset:2048
    ds_read_b64_tr_b16 v[154:155], v218 offset:3072
    s_add_u32 s98, s76, 20480
    buffer_load_dwordx4 a[92:95], v4, s[32:35], s98 offen offset:3072 sc1
    v_mfma_f32_32x32x16_bf16 v[80:95], v[172:175], a[28:31], v[80:95]
    ds_read_b64_tr_b16 v[156:157], v219 offset:2048
    ds_read_b64_tr_b16 v[158:159], v219 offset:3072
    s_waitcnt lgkmcnt(8)
    s_waitcnt vmcnt(15)
    v_mfma_f32_32x32x16_bf16 v[32:47], v[176:179], a[32:35], v[32:47]
    ds_read_b64_tr_b16 v[160:161], v216 offset:4096
    ds_read_b64_tr_b16 v[162:163], v216 offset:5120
    s_add_u32 s98, s76, 24576
    buffer_load_dwordx4 a[96:99], v4, s[32:35], s98 offen offset:0 sc1
    v_mfma_f32_32x32x16_bf16 v[48:63], v[180:183], a[32:35], v[48:63]
    ds_read_b64_tr_b16 v[164:165], v217 offset:4096
    ds_read_b64_tr_b16 v[166:167], v217 offset:5120
    v_mfma_f32_32x32x16_bf16 v[64:79], v[184:187], a[32:35], v[64:79]
    ds_read_b64_tr_b16 v[168:169], v218 offset:4096
    ds_read_b64_tr_b16 v[170:171], v218 offset:5120
    s_add_u32 s98, s76, 24576
    buffer_load_dwordx4 a[100:103], v4, s[32:35], s98 offen offset:1024 sc1
    v_mfma_f32_32x32x16_bf16 v[80:95], v[188:191], a[32:35], v[80:95]
    ds_read_b64_tr_b16 v[172:173], v219 offset:4096
    ds_read_b64_tr_b16 v[174:175], v219 offset:5120
    s_waitcnt lgkmcnt(8)
    s_waitcnt vmcnt(16)
    v_mfma_f32_32x32x16_bf16 v[32:47], v[144:147], a[36:39], v[32:47]
    ds_read_b64_tr_b16 v[176:177], v216 offset:6144
    ds_read_b64_tr_b16 v[178:179], v216 offset:7168
    s_add_u32 s98, s76, 24576
    buffer_load_dwordx4 a[104:107], v4, s[32:35], s98 offen offset:2048 sc1
    v_mfma_f32_32x32x16_bf16 v[48:63], v[148:151], a[36:39], v[48:63]
    ds_read_b64_tr_b16 v[180:181], v217 offset:6144
    ds_read_b64_tr_b16 v[182:183], v217 offset:7168
    v_mfma_f32_32x32x16_bf16 v[64:79], v[152:155], a[36:39], v[64:79]
    ds_read_b64_tr_b16 v[184:185], v218 offset:6144
    ds_read_b64_tr_b16 v[186:187], v218 offset:7168
    s_add_u32 s98, s76, 24576
    buffer_load_dwordx4 a[108:111], v4, s[32:35], s98 offen offset:3072 sc1
    v_mfma_f32_32x32x16_bf16 v[80:95], v[156:159], a[36:39], v[80:95]
    ds_read_b64_tr_b16 v[188:189], v219 offset:6144
    ds_read_b64_tr_b16 v[190:191], v219 offset:7168
    s_waitcnt lgkmcnt(8)
    s_waitcnt vmcnt(17)
    v_mfma_f32_32x32x16_bf16 v[32:47], v[160:163], a[40:43], v[32:47]
    ds_read_b64_tr_b16 v[144:145], v216 offset:8192
    ds_read_b64_tr_b16 v[146:147], v216 offset:9216
    s_add_u32 s98, s76, 28672
    buffer_load_dwordx4 a[112:115], v4, s[32:35], s98 offen offset:0 sc1
    v_mfma_f32_32x32x16_bf16 v[48:63], v[164:167], a[40:43], v[48:63]
    ds_read_b64_tr_b16 v[148:149], v217 offset:8192
    ds_read_b64_tr_b16 v[150:151], v217 offset:9216
    v_mfma_f32_32x32x16_bf16 v[64:79], v[168:171], a[40:43], v[64:79]
    ds_read_b64_tr_b16 v[152:153], v218 offset:8192
    ds_read_b64_tr_b16 v[154:155], v218 offset:9216
    s_add_u32 s98, s76, 28672
    buffer_load_dwordx4 a[116:119], v4, s[32:35], s98 offen offset:1024 sc1
    v_mfma_f32_32x32x16_bf16 v[80:95], v[172:175], a[40:43], v[80:95]
    ds_read_b64_tr_b16 v[156:157], v219 offset:8192
    ds_read_b64_tr_b16 v[158:159], v219 offset:9216
    s_waitcnt lgkmcnt(8)
    s_waitcnt vmcnt(18)
    v_mfma_f32_32x32x16_bf16 v[32:47], v[176:179], a[44:47], v[32:47]
    ds_read_b64_tr_b16 v[160:161], v216 offset:10240
    ds_read_b64_tr_b16 v[162:163], v216 offset:11264
    s_add_u32 s98, s76, 28672
    buffer_load_dwordx4 a[120:123], v4, s[32:35], s98 offen offset:2048 sc1
    v_mfma_f32_32x32x16_bf16 v[48:63], v[180:183], a[44:47], v[48:63]
    ds_read_b64_tr_b16 v[164:165], v217 offset:10240
    ds_read_b64_tr_b16 v[166:167], v217 offset:11264
    v_mfma_f32_32x32x16_bf16 v[64:79], v[184:187], a[44:47], v[64:79]
    ds_read_b64_tr_b16 v[168:169], v218 offset:10240
    ds_read_b64_tr_b16 v[170:171], v218 offset:11264
    s_add_u32 s98, s76, 28672
    buffer_load_dwordx4 a[124:127], v4, s[32:35], s98 offen offset:3072 sc1
    v_mfma_f32_32x32x16_bf16 v[80:95], v[188:191], a[44:47], v[80:95]
    ds_read_b64_tr_b16 v[172:173], v219 offset:10240
    ds_read_b64_tr_b16 v[174:175], v219 offset:11264
    s_waitcnt lgkmcnt(8)
    s_waitcnt vmcnt(19)
    v_mfma_f32_32x32x16_bf16 v[32:47], v[144:147], a[48:51], v[32:47]
    ds_read_b64_tr_b16 v[176:177], v216 offset:12288
    ds_read_b64_tr_b16 v[178:179], v216 offset:13312
    s_lshl_b32 s75, s71, 12
    s_add_u32 s75, s75, 2883584
    v_lshlrev_b32 v26, 3, v2
    v_lshl_add_u32 v26, v3, 11, v26
    buffer_load_dwordx2 v[112:113], v26, s[32:35], s75 offen offset:0 sc1
    buffer_load_dwordx2 v[114:115], v26, s[32:35], s75 offen offset:256 sc1
    buffer_load_dwordx2 v[116:117], v26, s[32:35], s75 offen offset:512 sc1
    buffer_load_dwordx2 v[118:119], v26, s[32:35], s75 offen offset:768 sc1
    buffer_load_dwordx2 v[120:121], v26, s[32:35], s75 offen offset:1024 sc1
    buffer_load_dwordx2 v[122:123], v26, s[32:35], s75 offen offset:1280 sc1
    buffer_load_dwordx2 v[124:125], v26, s[32:35], s75 offen offset:1536 sc1
    buffer_load_dwordx2 v[126:127], v26, s[32:35], s75 offen offset:1792 sc1
    v_mfma_f32_32x32x16_bf16 v[48:63], v[148:151], a[48:51], v[48:63]
    ds_read_b64_tr_b16 v[180:181], v217 offset:12288
    ds_read_b64_tr_b16 v[182:183], v217 offset:13312
    v_mfma_f32_32x32x16_bf16 v[64:79], v[152:155], a[48:51], v[64:79]
    ds_read_b64_tr_b16 v[184:185], v218 offset:12288
    ds_read_b64_tr_b16 v[186:187], v218 offset:13312
    v_lshrrev_b32 v210, 4, v2
    v_mul_u32_u24 v210, 1792, v210
    v_and_b32 v211, 15, v2
    v_add_u32 v210, v210, v211
    v_lshlrev_b32 v210, 5, v210
    s_lshl_b32 s79, s46, 11
    s_add_u32 s79, s79, 262144
    s_mul_i32 s80, s46, 1536
    s_add_u32 s80, s80, 294912
    v_mfma_f32_32x32x16_bf16 v[80:95], v[156:159], a[48:51], v[80:95]
    ds_read_b64_tr_b16 v[188:189], v219 offset:12288
    ds_read_b64_tr_b16 v[190:191], v219 offset:13312
    s_waitcnt lgkmcnt(8)
    s_waitcnt vmcnt(26)
    v_mfma_f32_32x32x16_bf16 v[32:47], v[160:163], a[52:55], v[32:47]
    ds_read_b64_tr_b16 v[144:145], v216 offset:14336
    ds_read_b64_tr_b16 v[146:147], v216 offset:15360
    buffer_load_dwordx4 v[96:99], v210, s[32:35], s79 offen offset:0 sc1
    v_mfma_f32_32x32x16_bf16 v[48:63], v[164:167], a[52:55], v[48:63]
    ds_read_b64_tr_b16 v[148:149], v217 offset:14336
    ds_read_b64_tr_b16 v[150:151], v217 offset:15360
    v_mfma_f32_32x32x16_bf16 v[64:79], v[168:171], a[52:55], v[64:79]
    ds_read_b64_tr_b16 v[152:153], v218 offset:14336
    ds_read_b64_tr_b16 v[154:155], v218 offset:15360
    buffer_load_dwordx4 v[100:103], v210, s[32:35], s79 offen offset:16 sc1
    v_mfma_f32_32x32x16_bf16 v[80:95], v[172:175], a[52:55], v[80:95]
    ds_read_b64_tr_b16 v[156:157], v219 offset:14336
    ds_read_b64_tr_b16 v[158:159], v219 offset:15360
    v_add_u32 v212, 65536, v16
    v_add_u32 v213, 65536, v17
    v_add_u32 v214, 65536, v18
    v_add_u32 v215, 65536, v19
    s_waitcnt lgkmcnt(8)
    s_waitcnt vmcnt(27)
    v_mfma_f32_32x32x16_bf16 v[32:47], v[176:179], a[56:59], v[32:47]
    ds_read_b64_tr_b16 v[160:161], v212 offset:0
    ds_read_b64_tr_b16 v[162:163], v212 offset:1024
    buffer_load_dwordx4 v[104:107], v210, s[32:35], s79 offen offset:512 sc1
    v_mfma_f32_32x32x16_bf16 v[48:63], v[180:183], a[56:59], v[48:63]
    ds_read_b64_tr_b16 v[164:165], v213 offset:0
    ds_read_b64_tr_b16 v[166:167], v213 offset:1024
    v_mfma_f32_32x32x16_bf16 v[64:79], v[184:187], a[56:59], v[64:79]
    ds_read_b64_tr_b16 v[168:169], v214 offset:0
    ds_read_b64_tr_b16 v[170:171], v214 offset:1024
    buffer_load_dwordx4 v[108:111], v210, s[32:35], s79 offen offset:528 sc1
    v_mfma_f32_32x32x16_bf16 v[80:95], v[188:191], a[56:59], v[80:95]
    ds_read_b64_tr_b16 v[172:173], v215 offset:0
    ds_read_b64_tr_b16 v[174:175], v215 offset:1024
    s_waitcnt lgkmcnt(8)
    s_waitcnt vmcnt(28)
    v_mfma_f32_32x32x16_bf16 v[32:47], v[144:147], a[60:63], v[32:47]
    ds_read_b64_tr_b16 v[176:177], v212 offset:2048
    ds_read_b64_tr_b16 v[178:179], v212 offset:3072
    buffer_load_dwordx4 v[128:131], v210, s[32:35], s79 offen offset:1024 sc1
    v_mfma_f32_32x32x16_bf16 v[48:63], v[148:151], a[60:63], v[48:63]
    ds_read_b64_tr_b16 v[180:181], v213 offset:2048
    ds_read_b64_tr_b16 v[182:183], v213 offset:3072
    v_mfma_f32_32x32x16_bf16 v[64:79], v[152:155], a[60:63], v[64:79]
    ds_read_b64_tr_b16 v[184:185], v214 offset:2048
    ds_read_b64_tr_b16 v[186:187], v214 offset:3072
    buffer_load_dwordx4 v[132:135], v210, s[32:35], s79 offen offset:1040 sc1
    v_mfma_f32_32x32x16_bf16 v[80:95], v[156:159], a[60:63], v[80:95]
    ds_read_b64_tr_b16 v[188:189], v215 offset:2048
    ds_read_b64_tr_b16 v[190:191], v215 offset:3072
    s_waitcnt lgkmcnt(8)
    s_waitcnt vmcnt(29)
    v_mfma_f32_32x32x16_bf16 v[32:47], v[160:163], a[64:67], v[32:47]
    ds_read_b64_tr_b16 v[144:145], v212 offset:4096
    ds_read_b64_tr_b16 v[146:147], v212 offset:5120
    buffer_load_dwordx4 v[136:139], v210, s[32:35], s79 offen offset:1536 sc1
    v_mfma_f32_32x32x16_bf16 v[48:63], v[164:167], a[64:67], v[48:63]
    ds_read_b64_tr_b16 v[148:149], v213 offset:4096
    ds_read_b64_tr_b16 v[150:151], v213 offset:5120
    v_mfma_f32_32x32x16_bf16 v[64:79], v[168:171], a[64:67], v[64:79]
    ds_read_b64_tr_b16 v[152:153], v214 offset:4096
    ds_read_b64_tr_b16 v[154:155], v214 offset:5120
    buffer_load_dwordx4 v[140:143], v210, s[32:35], s79 offen offset:1552 sc1
    v_mfma_f32_32x32x16_bf16 v[80:95], v[172:175], a[64:67], v[80:95]
    ds_read_b64_tr_b16 v[156:157], v215 offset:4096
    ds_read_b64_tr_b16 v[158:159], v215 offset:5120
    s_waitcnt lgkmcnt(8)
    s_waitcnt vmcnt(30)
    v_mfma_f32_32x32x16_bf16 v[32:47], v[176:179], a[68:71], v[32:47]
    ds_read_b64_tr_b16 v[160:161], v212 offset:6144
    ds_read_b64_tr_b16 v[162:163], v212 offset:7168
    buffer_load_dwordx4 v[192:195], v210, s[32:35], s80 offen offset:0 sc1
    v_mfma_f32_32x32x16_bf16 v[48:63], v[180:183], a[68:71], v[48:63]
    ds_read_b64_tr_b16 v[164:165], v213 offset:6144
    ds_read_b64_tr_b16 v[166:167], v213 offset:7168
    v_mfma_f32_32x32x16_bf16 v[64:79], v[184:187], a[68:71], v[64:79]
    ds_read_b64_tr_b16 v[168:169], v214 offset:6144
    ds_read_b64_tr_b16 v[170:171], v214 offset:7168
    buffer_load_dwordx4 v[196:199], v210, s[32:35], s80 offen offset:16 sc1
    v_mfma_f32_32x32x16_bf16 v[80:95], v[188:191], a[68:71], v[80:95]
    ds_read_b64_tr_b16 v[172:173], v215 offset:6144
    ds_read_b64_tr_b16 v[174:175], v215 offset:7168
    s_waitcnt lgkmcnt(8)
    s_waitcnt vmcnt(31)
    v_mfma_f32_32x32x16_bf16 v[32:47], v[144:147], a[72:75], v[32:47]
    ds_read_b64_tr_b16 v[176:177], v212 offset:8192
    ds_read_b64_tr_b16 v[178:179], v212 offset:9216
    buffer_load_dwordx4 v[240:243], v210, s[32:35], s80 offen offset:512 sc1
    v_mfma_f32_32x32x16_bf16 v[48:63], v[148:151], a[72:75], v[48:63]
    ds_read_b64_tr_b16 v[180:181], v213 offset:8192
    ds_read_b64_tr_b16 v[182:183], v213 offset:9216
    v_mfma_f32_32x32x16_bf16 v[64:79], v[152:155], a[72:75], v[64:79]
    ds_read_b64_tr_b16 v[184:185], v214 offset:8192
    ds_read_b64_tr_b16 v[186:187], v214 offset:9216
    buffer_load_dwordx4 v[244:247], v210, s[32:35], s80 offen offset:528 sc1
    v_mfma_f32_32x32x16_bf16 v[80:95], v[156:159], a[72:75], v[80:95]
    ds_read_b64_tr_b16 v[188:189], v215 offset:8192
    ds_read_b64_tr_b16 v[190:191], v215 offset:9216
    s_waitcnt lgkmcnt(8)
    s_waitcnt vmcnt(32)
    v_mfma_f32_32x32x16_bf16 v[32:47], v[160:163], a[76:79], v[32:47]
    ds_read_b64_tr_b16 v[144:145], v212 offset:10240
    ds_read_b64_tr_b16 v[146:147], v212 offset:11264
    buffer_load_dwordx4 v[248:251], v210, s[32:35], s80 offen offset:1024 sc1
    v_mfma_f32_32x32x16_bf16 v[48:63], v[164:167], a[76:79], v[48:63]
    ds_read_b64_tr_b16 v[148:149], v213 offset:10240
    ds_read_b64_tr_b16 v[150:151], v213 offset:11264
    v_mfma_f32_32x32x16_bf16 v[64:79], v[168:171], a[76:79], v[64:79]
    ds_read_b64_tr_b16 v[152:153], v214 offset:10240
    ds_read_b64_tr_b16 v[154:155], v214 offset:11264
    buffer_load_dwordx4 v[252:255], v210, s[32:35], s80 offen offset:1040 sc1
    v_mfma_f32_32x32x16_bf16 v[80:95], v[172:175], a[76:79], v[80:95]
    ds_read_b64_tr_b16 v[156:157], v215 offset:10240
    ds_read_b64_tr_b16 v[158:159], v215 offset:11264
    s_waitcnt lgkmcnt(8)
    s_waitcnt vmcnt(33)
    v_mfma_f32_32x32x16_bf16 v[32:47], v[176:179], a[80:83], v[32:47]
    ds_read_b64_tr_b16 v[160:161], v212 offset:12288
    ds_read_b64_tr_b16 v[162:163], v212 offset:13312
    s_waitcnt vmcnt(20)
    v_add_f32 v112, v112, v114
    v_add_f32 v113, v113, v115
    s_waitcnt vmcnt(19)
    v_add_f32 v112, v112, v116
    v_mfma_f32_32x32x16_bf16 v[48:63], v[180:183], a[80:83], v[48:63]
    ds_read_b64_tr_b16 v[164:165], v213 offset:12288
    ds_read_b64_tr_b16 v[166:167], v213 offset:13312
    v_add_f32 v113, v113, v117
    s_waitcnt vmcnt(18)
    v_add_f32 v112, v112, v118
    v_add_f32 v113, v113, v119
    v_mfma_f32_32x32x16_bf16 v[64:79], v[184:187], a[80:83], v[64:79]
    ds_read_b64_tr_b16 v[168:169], v214 offset:12288
    ds_read_b64_tr_b16 v[170:171], v214 offset:13312
    s_waitcnt vmcnt(17)
    v_add_f32 v112, v112, v120
    v_add_f32 v113, v113, v121
    s_waitcnt vmcnt(16)
    v_add_f32 v112, v112, v122
    v_mfma_f32_32x32x16_bf16 v[80:95], v[188:191], a[80:83], v[80:95]
    ds_read_b64_tr_b16 v[172:173], v215 offset:12288
    ds_read_b64_tr_b16 v[174:175], v215 offset:13312
    v_add_f32 v113, v113, v123
    s_waitcnt vmcnt(15)
    v_add_f32 v112, v112, v124
    v_add_f32 v113, v113, v125
    s_waitcnt vmcnt(14)
    v_add_f32 v112, v112, v126
    v_add_f32 v113, v113, v127
    s_waitcnt lgkmcnt(8)
    v_mfma_f32_32x32x16_bf16 v[32:47], v[144:147], a[84:87], v[32:47]
    ds_read_b64_tr_b16 v[176:177], v212 offset:14336
    ds_read_b64_tr_b16 v[178:179], v212 offset:15360
    v_mov_b32 v26, v112
    v_mov_b32 v27, v113
    v_nop
    v_mfma_f32_32x32x16_bf16 v[48:63], v[148:151], a[84:87], v[48:63]
    ds_read_b64_tr_b16 v[180:181], v213 offset:14336
    ds_read_b64_tr_b16 v[182:183], v213 offset:15360
    v_permlane32_swap_b32 v112, v26
    v_permlane32_swap_b32 v113, v27
    v_add_f32 v112, v112, v26
    v_mfma_f32_32x32x16_bf16 v[64:79], v[152:155], a[84:87], v[64:79]
    ds_read_b64_tr_b16 v[184:185], v214 offset:14336
    ds_read_b64_tr_b16 v[186:187], v214 offset:15360
    v_add_f32 v113, v113, v27
    v_mul_f32 v22, s51, v112
    v_mul_f32 v113, s51, v113
    v_mfma_f32_32x32x16_bf16 v[80:95], v[156:159], a[84:87], v[80:95]
    ds_read_b64_tr_b16 v[188:189], v215 offset:14336
    ds_read_b64_tr_b16 v[190:191], v215 offset:15360
    v_fma_f32 v113, -v22, v22, v113
    v_max_f32 v113, 0, v113
    v_add_f32 v113, s52, v113
    v_rsq_f32 v21, v113
    v_sub_f32 v28, 0, v22
    s_barrier
    v_add_u32 v216, 98304, v16
    v_add_u32 v217, 98304, v17
    v_add_u32 v218, 98304, v18
    v_add_u32 v219, 98304, v19
    s_waitcnt lgkmcnt(8)
    v_mfma_f32_32x32x16_bf16 v[32:47], v[160:163], a[88:91], v[32:47]
    ds_read_b64_tr_b16 v[144:145], v216 offset:0
    ds_read_b64_tr_b16 v[146:147], v216 offset:1024
    v_cndmask_b32 v28, 0, v28, s[54:55]
    v_cvt_pk_bf16_f32 v204, v28, v28
    v_lshlrev_b32 v26, 16, v204
    v_mfma_f32_32x32x16_bf16 v[48:63], v[164:167], a[88:91], v[48:63]
    ds_read_b64_tr_b16 v[148:149], v217 offset:0
    ds_read_b64_tr_b16 v[150:151], v217 offset:1024
    s_add_u32 s99, s66, 12288
    s_add_u32 m0, s67, 0
    s_nop 0
    buffer_load_dwordx4 v4, s[32:35], s99 offen offset:0 lds
    v_sub_f32 v26, v28, v26
    v_cvt_pk_bf16_f32 v204, v28, v26
    v_mov_b32 v205, v204
    v_mfma_f32_32x32x16_bf16 v[64:79], v[168:171], a[88:91], v[64:79]
    ds_read_b64_tr_b16 v[152:153], v218 offset:0
    ds_read_b64_tr_b16 v[154:155], v218 offset:1024
    v_mov_b32 v206, 0
    v_mov_b32 v207, 0
    v_mul_f32 v208, s50, v21
    v_mfma_f32_32x32x16_bf16 v[80:95], v[172:175], a[88:91], v[80:95]
    ds_read_b64_tr_b16 v[156:157], v219 offset:0
    ds_read_b64_tr_b16 v[158:159], v219 offset:1024
    buffer_load_dwordx4 v4, s[32:35], s99 offen offset:1024 lds
    v_sub_f32 v208, 0, v208
    v_mul_f32 v209, v21, v21
    v_rcp_f32 v209, v209
    v_add_u32 v236, 0, v6
    v_add_u32 v237, 7168, v6
    s_waitcnt lgkmcnt(8)
    v_mfma_f32_32x32x16_bf16 v[32:47], v[176:179], a[92:95], v[32:47]
    ds_read_b64_tr_b16 v[160:161], v216 offset:2048
    ds_read_b64_tr_b16 v[162:163], v216 offset:3072
    v_add_u32 v238, 14336, v6
    v_add_u32 v239, 21504, v6
    s_waitcnt vmcnt(15)
    v_add_f32 v96, v96, v97
    v_mfma_f32_32x32x16_bf16 v[48:63], v[180:183], a[92:95], v[48:63]
    ds_read_b64_tr_b16 v[164:165], v217 offset:2048
    ds_read_b64_tr_b16 v[166:167], v217 offset:3072
    buffer_load_dwordx4 v4, s[32:35], s99 offen offset:2048 lds
    v_add_f32 v96, v96, v98
    v_add_f32 v96, v96, v99
    s_waitcnt vmcnt(15)
    v_add_f32 v96, v96, v100
    v_mfma_f32_32x32x16_bf16 v[64:79], v[184:187], a[92:95], v[64:79]
    ds_read_b64_tr_b16 v[168:169], v218 offset:2048
    ds_read_b64_tr_b16 v[170:171], v218 offset:3072
    v_add_f32 v96, v96, v101
    v_add_f32 v96, v96, v102
    v_add_f32 v96, v96, v103
    v_mfma_f32_32x32x16_bf16 v[80:95], v[188:191], a[92:95], v[80:95]
    ds_read_b64_tr_b16 v[172:173], v219 offset:2048
    ds_read_b64_tr_b16 v[174:175], v219 offset:3072
    buffer_load_dwordx4 v4, s[32:35], s99 offen offset:3072 lds
    v_cndmask_b32 v96, 0, v96, s[54:55]
    v_cvt_pk_bf16_f32 v97, v96, v96
    v_lshlrev_b32 v98, 16, v97
    v_sub_f32 v98, v96, v98
    v_cvt_pk_bf16_f32 v99, v98, v98
    s_waitcnt lgkmcnt(8)
    v_mfma_f32_32x32x16_bf16 v[32:47], v[144:147], a[96:99], v[32:47]
    ds_read_b64_tr_b16 v[176:177], v216 offset:4096
    ds_read_b64_tr_b16 v[178:179], v216 offset:5120
    v_accvgpr_write_b32 a192, v97
    v_accvgpr_write_b32 a193, v99
    v_accvgpr_write_b32 a194, 0
    v_mfma_f32_32x32x16_bf16 v[48:63], v[148:151], a[96:99], v[48:63]
    ds_read_b64_tr_b16 v[180:181], v217 offset:4096
    ds_read_b64_tr_b16 v[182:183], v217 offset:5120
    s_add_u32 s99, s66, 16384
    s_add_u32 m0, s67, 4096
    s_nop 0
    buffer_load_dwordx4 v4, s[32:35], s99 offen offset:0 lds
    v_accvgpr_write_b32 a195, 0
    s_waitcnt vmcnt(16)
    v_add_f32 v104, v104, v105
    v_add_f32 v104, v104, v106
    v_mfma_f32_32x32x16_bf16 v[64:79], v[152:155], a[96:99], v[64:79]
    ds_read_b64_tr_b16 v[184:185], v218 offset:4096
    ds_read_b64_tr_b16 v[186:187], v218 offset:5120
    v_add_f32 v104, v104, v107
    s_waitcnt vmcnt(15)
    v_add_f32 v104, v104, v108
    v_add_f32 v104, v104, v109
    v_mfma_f32_32x32x16_bf16 v[80:95], v[156:159], a[96:99], v[80:95]
    ds_read_b64_tr_b16 v[188:189], v219 offset:4096
    ds_read_b64_tr_b16 v[190:191], v219 offset:5120
    buffer_load_dwordx4 v4, s[32:35], s99 offen offset:1024 lds
    v_add_f32 v104, v104, v110
    v_add_f32 v104, v104, v111
    v_cndmask_b32 v104, 0, v104, s[54:55]
    v_cvt_pk_bf16_f32 v105, v104, v104
    v_lshlrev_b32 v106, 16, v105
    s_waitcnt lgkmcnt(8)
    v_mfma_f32_32x32x16_bf16 v[32:47], v[160:163], a[100:103], v[32:47]
    ds_read_b64_tr_b16 v[144:145], v216 offset:6144
    ds_read_b64_tr_b16 v[146:147], v216 offset:7168
    v_sub_f32 v106, v104, v106
    v_cvt_pk_bf16_f32 v107, v106, v106
    v_accvgpr_write_b32 a196, v105
    v_mfma_f32_32x32x16_bf16 v[48:63], v[164:167], a[100:103], v[48:63]
    ds_read_b64_tr_b16 v[148:149], v217 offset:6144
    ds_read_b64_tr_b16 v[150:151], v217 offset:7168
    s_add_u32 s99, s66, 24576
    s_add_u32 m0, s67, 32768
    s_nop 0
    buffer_load_dwordx4 v4, s[32:35], s99 offen offset:0 lds
    v_accvgpr_write_b32 a197, v107
    v_accvgpr_write_b32 a198, 0
    v_accvgpr_write_b32 a199, 0
    v_mfma_f32_32x32x16_bf16 v[64:79], v[168:171], a[100:103], v[64:79]
    ds_read_b64_tr_b16 v[152:153], v218 offset:6144
    ds_read_b64_tr_b16 v[154:155], v218 offset:7168
    s_waitcnt vmcnt(16)
    v_add_f32 v128, v128, v129
    v_add_f32 v128, v128, v130
    v_add_f32 v128, v128, v131
    v_mfma_f32_32x32x16_bf16 v[80:95], v[172:175], a[100:103], v[80:95]
    ds_read_b64_tr_b16 v[156:157], v219 offset:6144
    ds_read_b64_tr_b16 v[158:159], v219 offset:7168
    buffer_load_dwordx4 v4, s[32:35], s99 offen offset:1024 lds
    s_waitcnt vmcnt(16)
    v_add_f32 v128, v128, v132
    v_add_f32 v128, v128, v133
    v_add_f32 v128, v128, v134
    v_add_f32 v128, v128, v135
    v_cndmask_b32 v128, 0, v128, s[54:55]
    s_waitcnt lgkmcnt(8)
    v_mfma_f32_32x32x16_bf16 v[32:47], v[176:179], a[104:107], v[32:47]
    ds_read_b64_tr_b16 v[160:161], v216 offset:8192
    ds_read_b64_tr_b16 v[162:163], v216 offset:9216
    v_cvt_pk_bf16_f32 v129, v128, v128
    v_lshlrev_b32 v130, 16, v129
    v_sub_f32 v130, v128, v130
    v_mfma_f32_32x32x16_bf16 v[48:63], v[180:183], a[104:107], v[48:63]
    ds_read_b64_tr_b16 v[164:165], v217 offset:8192
    ds_read_b64_tr_b16 v[166:167], v217 offset:9216
    buffer_load_dwordx4 v4, s[32:35], s99 offen offset:2048 lds
    v_cvt_pk_bf16_f32 v131, v130, v130
    v_accvgpr_write_b32 a200, v129
    v_accvgpr_write_b32 a201, v131
    v_mfma_f32_32x32x16_bf16 v[64:79], v[184:187], a[104:107], v[64:79]
    ds_read_b64_tr_b16 v[168:169], v218 offset:8192
    ds_read_b64_tr_b16 v[170:171], v218 offset:9216
    v_accvgpr_write_b32 a202, 0
    v_accvgpr_write_b32 a203, 0
    s_waitcnt vmcnt(16)
    v_add_f32 v136, v136, v137
    v_mfma_f32_32x32x16_bf16 v[80:95], v[188:191], a[104:107], v[80:95]
    ds_read_b64_tr_b16 v[172:173], v219 offset:8192
    ds_read_b64_tr_b16 v[174:175], v219 offset:9216
    buffer_load_dwordx4 v4, s[32:35], s99 offen offset:3072 lds
    v_add_f32 v136, v136, v138
    v_add_f32 v136, v136, v139
    s_waitcnt vmcnt(16)
    v_add_f32 v136, v136, v140
    v_add_f32 v136, v136, v141
    v_add_f32 v136, v136, v142
    s_waitcnt lgkmcnt(8)
    v_mfma_f32_32x32x16_bf16 v[32:47], v[144:147], a[108:111], v[32:47]
    ds_read_b64_tr_b16 v[176:177], v216 offset:10240
    ds_read_b64_tr_b16 v[178:179], v216 offset:11264
    v_add_f32 v136, v136, v143
    v_cndmask_b32 v136, 0, v136, s[54:55]
    v_cvt_pk_bf16_f32 v137, v136, v136
    v_mfma_f32_32x32x16_bf16 v[48:63], v[148:151], a[108:111], v[48:63]
    ds_read_b64_tr_b16 v[180:181], v217 offset:10240
    ds_read_b64_tr_b16 v[182:183], v217 offset:11264
    s_add_u32 s99, s66, 28672
    s_add_u32 m0, s67, 36864
    s_nop 0
    buffer_load_dwordx4 v4, s[32:35], s99 offen offset:0 lds
    v_lshlrev_b32 v138, 16, v137
    v_sub_f32 v138, v136, v138
    v_cvt_pk_bf16_f32 v139, v138, v138
    v_mfma_f32_32x32x16_bf16 v[64:79], v[152:155], a[108:111], v[64:79]
    ds_read_b64_tr_b16 v[184:185], v218 offset:10240
    ds_read_b64_tr_b16 v[186:187], v218 offset:11264
    v_accvgpr_write_b32 a204, v137
    v_accvgpr_write_b32 a205, v139
    v_accvgpr_write_b32 a206, 0
    v_mfma_f32_32x32x16_bf16 v[80:95], v[156:159], a[108:111], v[80:95]
    ds_read_b64_tr_b16 v[188:189], v219 offset:10240
    ds_read_b64_tr_b16 v[190:191], v219 offset:11264
    buffer_load_dwordx4 v4, s[32:35], s99 offen offset:1024 lds
    v_accvgpr_write_b32 a207, 0
    s_waitcnt vmcnt(17)
    v_add_f32 v192, v192, v193
    v_add_f32 v192, v192, v194
    v_add_f32 v192, v192, v195
    s_waitcnt vmcnt(16)
    v_add_f32 v192, v192, v196
    s_waitcnt lgkmcnt(8)
    v_mfma_f32_32x32x16_bf16 v[32:47], v[160:163], a[112:115], v[32:47]
    ds_read_b64_tr_b16 v[144:145], v216 offset:12288
    ds_read_b64_tr_b16 v[146:147], v216 offset:13312
    v_add_f32 v192, v192, v197
    v_add_f32 v192, v192, v198
    v_add_f32 v192, v192, v199
    v_mfma_f32_32x32x16_bf16 v[48:63], v[164:167], a[112:115], v[48:63]
    ds_read_b64_tr_b16 v[148:149], v217 offset:12288
    ds_read_b64_tr_b16 v[150:151], v217 offset:13312
    v_cndmask_b32 v192, 0, v192, s[54:55]
    v_cvt_pk_bf16_f32 v193, v192, v192
    v_lshlrev_b32 v194, 16, v193
    v_mfma_f32_32x32x16_bf16 v[64:79], v[168:171], a[112:115], v[64:79]
    ds_read_b64_tr_b16 v[152:153], v218 offset:12288
    ds_read_b64_tr_b16 v[154:155], v218 offset:13312
    v_sub_f32 v194, v192, v194
    v_cvt_pk_bf16_f32 v195, v194, v194
    v_accvgpr_write_b32 a208, v193
    v_mfma_f32_32x32x16_bf16 v[80:95], v[172:175], a[112:115], v[80:95]
    ds_read_b64_tr_b16 v[156:157], v219 offset:12288
    ds_read_b64_tr_b16 v[158:159], v219 offset:13312
    v_accvgpr_write_b32 a209, v195
    v_accvgpr_write_b32 a210, 0
    v_accvgpr_write_b32 a211, 0
    s_waitcnt vmcnt(15)
    v_add_f32 v240, v240, v241
    v_add_f32 v240, v240, v242
    s_waitcnt lgkmcnt(8)
    v_mfma_f32_32x32x16_bf16 v[32:47], v[176:179], a[116:119], v[32:47]
    ds_read_b64_tr_b16 v[160:161], v216 offset:14336
    ds_read_b64_tr_b16 v[162:163], v216 offset:15360
    v_add_f32 v240, v240, v243
    s_waitcnt vmcnt(14)
    v_add_f32 v240, v240, v244
    v_add_f32 v240, v240, v245
    v_mfma_f32_32x32x16_bf16 v[48:63], v[180:183], a[116:119], v[48:63]
    ds_read_b64_tr_b16 v[164:165], v217 offset:14336
    ds_read_b64_tr_b16 v[166:167], v217 offset:15360
    v_add_f32 v240, v240, v246
    v_add_f32 v240, v240, v247
    v_cndmask_b32 v240, 0, v240, s[54:55]
    v_mfma_f32_32x32x16_bf16 v[64:79], v[184:187], a[116:119], v[64:79]
    ds_read_b64_tr_b16 v[168:169], v218 offset:14336
    ds_read_b64_tr_b16 v[170:171], v218 offset:15360
    v_cvt_pk_bf16_f32 v241, v240, v240
    v_lshlrev_b32 v242, 16, v241
    v_sub_f32 v242, v240, v242
    v_mfma_f32_32x32x16_bf16 v[80:95], v[188:191], a[116:119], v[80:95]
    ds_read_b64_tr_b16 v[172:173], v219 offset:14336
    ds_read_b64_tr_b16 v[174:175], v219 offset:15360
    v_cvt_pk_bf16_f32 v243, v242, v242
    v_accvgpr_write_b32 a212, v241
    v_accvgpr_write_b32 a213, v243
    v_accvgpr_write_b32 a214, 0
    v_accvgpr_write_b32 a215, 0
    s_barrier
    v_add_u32 v212, 131072, v20
    s_waitcnt lgkmcnt(8)
    v_mfma_f32_32x32x16_bf16 v[32:47], v[144:147], a[120:123], v[32:47]
    ds_read_b64_tr_b16 v[176:177], v212 offset:0
    ds_read_b64_tr_b16 v[178:179], v212 offset:768
    s_waitcnt vmcnt(13)
    v_add_f32 v248, v248, v249
    v_add_f32 v248, v248, v250
    v_add_f32 v248, v248, v251
    v_mfma_f32_32x32x16_bf16 v[48:63], v[148:151], a[120:123], v[48:63]
    ds_read_b64_tr_b16 v[180:181], v212 offset:32
    ds_read_b64_tr_b16 v[182:183], v212 offset:800
    s_add_u32 s99, s66, 36864
    s_add_u32 m0, s67, 65536
    s_nop 0
    buffer_load_dwordx4 v4, s[32:35], s99 offen offset:0 lds
    s_waitcnt vmcnt(13)
    v_add_f32 v248, v248, v252
    v_add_f32 v248, v248, v253
    v_add_f32 v248, v248, v254
    v_mfma_f32_32x32x16_bf16 v[64:79], v[152:155], a[120:123], v[64:79]
    ds_read_b64_tr_b16 v[184:185], v212 offset:64
    ds_read_b64_tr_b16 v[186:187], v212 offset:832
    v_add_f32 v248, v248, v255
    v_cndmask_b32 v248, 0, v248, s[54:55]
    v_cvt_pk_bf16_f32 v249, v248, v248
    v_mfma_f32_32x32x16_bf16 v[80:95], v[156:159], a[120:123], v[80:95]
    buffer_load_dwordx4 v4, s[32:35], s99 offen offset:1024 lds
    v_lshlrev_b32 v250, 16, v249
    v_sub_f32 v250, v248, v250
    v_cvt_pk_bf16_f32 v251, v250, v250
    v_accvgpr_write_b32 a216, v249
    v_accvgpr_write_b32 a217, v251
    s_waitcnt lgkmcnt(6)
    v_mfma_f32_32x32x16_bf16 v[32:47], v[160:163], a[124:127], v[32:47]
    ds_read_b64_tr_b16 v[144:145], v212 offset:1536
    ds_read_b64_tr_b16 v[146:147], v212 offset:2304
    v_accvgpr_write_b32 a218, 0
    v_accvgpr_write_b32 a219, 0
    v_mfma_f32_32x32x16_bf16 v[48:63], v[164:167], a[124:127], v[48:63]
    ds_read_b64_tr_b16 v[148:149], v212 offset:1568
    ds_read_b64_tr_b16 v[150:151], v212 offset:2336
    buffer_load_dwordx4 v4, s[32:35], s99 offen offset:2048 lds
    v_mfma_f32_32x32x16_bf16 v[64:79], v[168:171], a[124:127], v[64:79]
    ds_read_b64_tr_b16 v[152:153], v212 offset:1600
    ds_read_b64_tr_b16 v[154:155], v212 offset:2368
    v_mfma_f32_32x32x16_bf16 v[80:95], v[172:175], a[124:127], v[80:95]
    buffer_load_dwordx4 v4, s[32:35], s99 offen offset:3072 lds
    v_mfma_f32_32x32x16_bf16 v[32:47], a[192:195], v[204:207], v[32:47]
    v_mfma_f32_32x32x16_bf16 v[48:63], a[196:199], v[204:207], v[48:63]
    v_mfma_f32_32x32x16_bf16 v[64:79], a[200:203], v[204:207], v[64:79]
    v_mfma_f32_32x32x16_bf16 v[80:95], a[204:207], v[204:207], v[80:95]
    s_waitcnt lgkmcnt(6)
    v_mfma_f32_32x32x16_bf16 v[96:111], v[176:179], a[0:3], 0
    ds_read_b64_tr_b16 v[160:161], v212 offset:3072
    ds_read_b64_tr_b16 v[162:163], v212 offset:3840
    s_add_u32 s99, s66, 40960
    s_add_u32 m0, s67, 69632
    s_nop 0
    buffer_load_dwordx4 v4, s[32:35], s99 offen offset:0 lds
    s_nop 0
    v_mul_f32 v228, v32, v208
    v_mul_f32 v229, v33, v208
    v_mfma_f32_32x32x16_bf16 v[112:127], v[180:183], a[0:3], 0
    ds_read_b64_tr_b16 v[164:165], v212 offset:3104
    ds_read_b64_tr_b16 v[166:167], v212 offset:3872
    v_mul_f32 v230, v34, v208
    v_mul_f32 v231, v35, v208
    v_mul_f32 v232, v36, v208
    v_mfma_f32_32x32x16_bf16 v[128:143], v[184:187], a[0:3], 0
    ds_read_b64_tr_b16 v[168:169], v212 offset:3136
    ds_read_b64_tr_b16 v[170:171], v212 offset:3904
    v_mul_f32 v233, v37, v208
    v_mul_f32 v234, v38, v208
    v_mul_f32 v235, v39, v208
    s_waitcnt lgkmcnt(6)
    v_mfma_f32_32x32x16_bf16 v[96:111], v[144:147], a[4:7], v[96:111]
    ds_read_b64_tr_b16 v[176:177], v212 offset:4608
    ds_read_b64_tr_b16 v[178:179], v212 offset:5376
    buffer_load_dwordx4 v4, s[32:35], s99 offen offset:1024 lds
    v_exp_f32 v228, v228
    v_mul_f32 v32, v32, v40
    v_mfma_f32_32x32x16_bf16 v[112:127], v[148:151], a[4:7], v[112:127]
    ds_read_b64_tr_b16 v[180:181], v212 offset:4640
    ds_read_b64_tr_b16 v[182:183], v212 offset:5408
    v_exp_f32 v229, v229
    v_mul_f32 v33, v33, v41
    v_exp_f32 v230, v230
    v_mfma_f32_32x32x16_bf16 v[128:143], v[152:155], a[4:7], v[128:143]
    ds_read_b64_tr_b16 v[184:185], v212 offset:4672
    ds_read_b64_tr_b16 v[186:187], v212 offset:5440
    v_mul_f32 v34, v34, v42
    v_exp_f32 v231, v231
    v_mul_f32 v35, v35, v43
    s_waitcnt lgkmcnt(6)
    v_mfma_f32_32x32x16_bf16 v[96:111], v[160:163], a[8:11], v[96:111]
    ds_read_b64_tr_b16 v[144:145], v212 offset:6144
    ds_read_b64_tr_b16 v[146:147], v212 offset:6912
    v_exp_f32 v232, v232
    v_mul_f32 v36, v36, v44
    v_mfma_f32_32x32x16_bf16 v[112:127], v[164:167], a[8:11], v[112:127]
    ds_read_b64_tr_b16 v[148:149], v212 offset:6176
    ds_read_b64_tr_b16 v[150:151], v212 offset:6944
    v_exp_f32 v233, v233
    v_mul_f32 v37, v37, v45
    v_exp_f32 v234, v234
    v_mfma_f32_32x32x16_bf16 v[128:143], v[168:171], a[8:11], v[128:143]
    ds_read_b64_tr_b16 v[152:153], v212 offset:6208
    ds_read_b64_tr_b16 v[154:155], v212 offset:6976
    v_mul_f32 v38, v38, v46
    v_exp_f32 v235, v235
    v_mul_f32 v39, v39, v47
    s_waitcnt lgkmcnt(6)
    v_mfma_f32_32x32x16_bf16 v[96:111], v[176:179], a[12:15], v[96:111]
    ds_read_b64_tr_b16 v[160:161], v212 offset:7680
    ds_read_b64_tr_b16 v[162:163], v212 offset:8448
    v_fma_f32 v228, v228, v209, v209
    v_fma_f32 v229, v229, v209, v209
    v_mfma_f32_32x32x16_bf16 v[112:127], v[180:183], a[12:15], v[112:127]
    ds_read_b64_tr_b16 v[164:165], v212 offset:7712
    ds_read_b64_tr_b16 v[166:167], v212 offset:8480
    v_fma_f32 v230, v230, v209, v209
    v_fma_f32 v231, v231, v209, v209
    v_fma_f32 v232, v232, v209, v209
    v_mfma_f32_32x32x16_bf16 v[128:143], v[184:187], a[12:15], v[128:143]
    ds_read_b64_tr_b16 v[168:169], v212 offset:7744
    ds_read_b64_tr_b16 v[170:171], v212 offset:8512
    v_fma_f32 v233, v233, v209, v209
    v_fma_f32 v234, v234, v209, v209
    v_fma_f32 v235, v235, v209, v209
    s_waitcnt lgkmcnt(6)
    v_mfma_f32_32x32x16_bf16 v[96:111], v[144:147], a[16:19], v[96:111]
    ds_read_b64_tr_b16 v[176:177], v212 offset:9216
    ds_read_b64_tr_b16 v[178:179], v212 offset:9984
    v_rcp_f32 v228, v228
    v_rcp_f32 v229, v229
    v_mfma_f32_32x32x16_bf16 v[112:127], v[148:151], a[16:19], v[112:127]
    ds_read_b64_tr_b16 v[180:181], v212 offset:9248
    ds_read_b64_tr_b16 v[182:183], v212 offset:10016
    v_rcp_f32 v230, v230
    v_rcp_f32 v231, v231
    v_rcp_f32 v232, v232
    v_mfma_f32_32x32x16_bf16 v[128:143], v[152:155], a[16:19], v[128:143]
    ds_read_b64_tr_b16 v[184:185], v212 offset:9280
    ds_read_b64_tr_b16 v[186:187], v212 offset:10048
    v_rcp_f32 v233, v233
    v_rcp_f32 v234, v234
    v_rcp_f32 v235, v235
    s_waitcnt lgkmcnt(6)
    v_mfma_f32_32x32x16_bf16 v[96:111], v[160:163], a[20:23], v[96:111]
    ds_read_b64_tr_b16 v[144:145], v212 offset:10752
    ds_read_b64_tr_b16 v[146:147], v212 offset:11520
    v_mul_f32 v32, v32, v228
    v_mul_f32 v33, v33, v229
    v_mfma_f32_32x32x16_bf16 v[112:127], v[164:167], a[20:23], v[112:127]
    ds_read_b64_tr_b16 v[148:149], v212 offset:10784
    ds_read_b64_tr_b16 v[150:151], v212 offset:11552
    v_mul_f32 v34, v34, v230
    v_mul_f32 v35, v35, v231
    v_mul_f32 v36, v36, v232
    v_mfma_f32_32x32x16_bf16 v[128:143], v[168:171], a[20:23], v[128:143]
    ds_read_b64_tr_b16 v[152:153], v212 offset:10816
    ds_read_b64_tr_b16 v[154:155], v212 offset:11584
    v_mul_f32 v37, v37, v233
    v_mul_f32 v38, v38, v234
    v_mul_f32 v39, v39, v235
    s_waitcnt vmcnt(12)
    s_barrier
    v_add_u32 v216, 0, v20
    s_waitcnt lgkmcnt(6)
    v_mfma_f32_32x32x16_bf16 v[96:111], v[176:179], a[24:27], v[96:111]
    ds_read_b64_tr_b16 v[160:161], v216 offset:0
    ds_read_b64_tr_b16 v[162:163], v216 offset:768
    s_add_u32 s99, s68, 0
    s_add_u32 m0, s5, 98304
    s_nop 0
    buffer_load_dwordx4 v236, s[24:27], s99 offen offset:0 lds
    v_cvt_pk_bf16_f32 v220, v32, v33
    v_cvt_pk_bf16_f32 v221, v34, v35
    v_mfma_f32_32x32x16_bf16 v[112:127], v[180:183], a[24:27], v[112:127]
    ds_read_b64_tr_b16 v[164:165], v216 offset:32
    ds_read_b64_tr_b16 v[166:167], v216 offset:800
    v_cvt_pk_bf16_f32 v222, v36, v37
    v_cvt_pk_bf16_f32 v223, v38, v39
    buffer_store_dwordx4 v[220:223], v4, s[32:35], s88 offen offset:0 sc1
    v_mfma_f32_32x32x16_bf16 v[128:143], v[184:187], a[24:27], v[128:143]
    ds_read_b64_tr_b16 v[168:169], v216 offset:64
    ds_read_b64_tr_b16 v[170:171], v216 offset:832
    v_mul_f32 v228, v48, v208
    v_mul_f32 v229, v49, v208
    v_mul_f32 v230, v50, v208
    s_waitcnt lgkmcnt(6)
    v_mfma_f32_32x32x16_bf16 v[96:111], v[144:147], a[28:31], v[96:111]
    ds_read_b64_tr_b16 v[176:177], v216 offset:1536
    ds_read_b64_tr_b16 v[178:179], v216 offset:2304
    buffer_load_dwordx4 v237, s[24:27], s99 offen offset:1024 lds
    v_mul_f32 v231, v51, v208
    v_mul_f32 v232, v52, v208
    v_mfma_f32_32x32x16_bf16 v[112:127], v[148:151], a[28:31], v[112:127]
    ds_read_b64_tr_b16 v[180:181], v216 offset:1568
    ds_read_b64_tr_b16 v[182:183], v216 offset:2336
    v_mul_f32 v233, v53, v208
    v_mul_f32 v234, v54, v208
    v_mul_f32 v235, v55, v208
    v_mfma_f32_32x32x16_bf16 v[128:143], v[152:155], a[28:31], v[128:143]
    ds_read_b64_tr_b16 v[184:185], v216 offset:1600
    ds_read_b64_tr_b16 v[186:187], v216 offset:2368
    v_exp_f32 v228, v228
    v_mul_f32 v48, v48, v56
    v_exp_f32 v229, v229
    s_waitcnt lgkmcnt(6)
    v_mfma_f32_32x32x16_bf16 v[96:111], v[160:163], a[32:35], v[96:111]
    ds_read_b64_tr_b16 v[144:145], v216 offset:3072
    ds_read_b64_tr_b16 v[146:147], v216 offset:3840
    buffer_load_dwordx4 v238, s[24:27], s99 offen offset:2048 lds
    v_mul_f32 v49, v49, v57
    v_exp_f32 v230, v230
    v_mfma_f32_32x32x16_bf16 v[112:127], v[164:167], a[32:35], v[112:127]
    ds_read_b64_tr_b16 v[148:149], v216 offset:3104
    ds_read_b64_tr_b16 v[150:151], v216 offset:3872
    v_mul_f32 v50, v50, v58
    v_exp_f32 v231, v231
    v_mul_f32 v51, v51, v59
    v_mfma_f32_32x32x16_bf16 v[128:143], v[168:171], a[32:35], v[128:143]
    ds_read_b64_tr_b16 v[152:153], v216 offset:3136
    ds_read_b64_tr_b16 v[154:155], v216 offset:3904
    v_exp_f32 v232, v232
    v_mul_f32 v52, v52, v60
    v_exp_f32 v233, v233
    s_waitcnt lgkmcnt(6)
    v_mfma_f32_32x32x16_bf16 v[96:111], v[176:179], a[36:39], v[96:111]
    ds_read_b64_tr_b16 v[160:161], v216 offset:4608
    ds_read_b64_tr_b16 v[162:163], v216 offset:5376
    buffer_load_dwordx4 v239, s[24:27], s99 offen offset:3072 lds
    v_mul_f32 v53, v53, v61
    v_exp_f32 v234, v234
    v_mfma_f32_32x32x16_bf16 v[112:127], v[180:183], a[36:39], v[112:127]
    ds_read_b64_tr_b16 v[164:165], v216 offset:4640
    ds_read_b64_tr_b16 v[166:167], v216 offset:5408
    v_mul_f32 v54, v54, v62
    v_exp_f32 v235, v235
    v_mul_f32 v55, v55, v63
    v_mfma_f32_32x32x16_bf16 v[128:143], v[184:187], a[36:39], v[128:143]
    ds_read_b64_tr_b16 v[168:169], v216 offset:4672
    ds_read_b64_tr_b16 v[170:171], v216 offset:5440
    v_fma_f32 v228, v228, v209, v209
    v_fma_f32 v229, v229, v209, v209
    v_fma_f32 v230, v230, v209, v209
    s_waitcnt lgkmcnt(6)
    v_mfma_f32_32x32x16_bf16 v[96:111], v[144:147], a[40:43], v[96:111]
    ds_read_b64_tr_b16 v[176:177], v216 offset:6144
    ds_read_b64_tr_b16 v[178:179], v216 offset:6912
    s_add_u32 s99, s68, 32768
    s_add_u32 m0, s5, 102400
    s_nop 0
    buffer_load_dwordx4 v236, s[24:27], s99 offen offset:0 lds
    v_fma_f32 v231, v231, v209, v209
    v_fma_f32 v232, v232, v209, v209
    v_mfma_f32_32x32x16_bf16 v[112:127], v[148:151], a[40:43], v[112:127]
    ds_read_b64_tr_b16 v[180:181], v216 offset:6176
    ds_read_b64_tr_b16 v[182:183], v216 offset:6944
    v_fma_f32 v233, v233, v209, v209
    v_fma_f32 v234, v234, v209, v209
    v_fma_f32 v235, v235, v209, v209
    v_mfma_f32_32x32x16_bf16 v[128:143], v[152:155], a[40:43], v[128:143]
    ds_read_b64_tr_b16 v[184:185], v216 offset:6208
    ds_read_b64_tr_b16 v[186:187], v216 offset:6976
    v_rcp_f32 v228, v228
    v_rcp_f32 v229, v229
    v_rcp_f32 v230, v230
    s_waitcnt lgkmcnt(6)
    v_mfma_f32_32x32x16_bf16 v[96:111], v[160:163], a[44:47], v[96:111]
    ds_read_b64_tr_b16 v[144:145], v216 offset:7680
    ds_read_b64_tr_b16 v[146:147], v216 offset:8448
    buffer_load_dwordx4 v237, s[24:27], s99 offen offset:1024 lds
    v_rcp_f32 v231, v231
    v_rcp_f32 v232, v232
    v_mfma_f32_32x32x16_bf16 v[112:127], v[164:167], a[44:47], v[112:127]
    ds_read_b64_tr_b16 v[148:149], v216 offset:7712
    ds_read_b64_tr_b16 v[150:151], v216 offset:8480
    v_rcp_f32 v233, v233
    v_rcp_f32 v234, v234
    v_rcp_f32 v235, v235
    v_mfma_f32_32x32x16_bf16 v[128:143], v[168:171], a[44:47], v[128:143]
    ds_read_b64_tr_b16 v[152:153], v216 offset:7744
    ds_read_b64_tr_b16 v[154:155], v216 offset:8512
    v_mul_f32 v48, v48, v228
    v_mul_f32 v49, v49, v229
    v_mul_f32 v50, v50, v230
    s_waitcnt lgkmcnt(6)
    v_mfma_f32_32x32x16_bf16 v[96:111], v[176:179], a[48:51], v[96:111]
    ds_read_b64_tr_b16 v[160:161], v216 offset:9216
    ds_read_b64_tr_b16 v[162:163], v216 offset:9984
    buffer_load_dwordx4 v238, s[24:27], s99 offen offset:2048 lds
    v_mul_f32 v51, v51, v231
    v_mul_f32 v52, v52, v232
    v_mfma_f32_32x32x16_bf16 v[112:127], v[180:183], a[48:51], v[112:127]
    ds_read_b64_tr_b16 v[164:165], v216 offset:9248
    ds_read_b64_tr_b16 v[166:167], v216 offset:10016
    v_mul_f32 v53, v53, v233
    v_mul_f32 v54, v54, v234
    v_mul_f32 v55, v55, v235
    v_mfma_f32_32x32x16_bf16 v[128:143], v[184:187], a[48:51], v[128:143]
    ds_read_b64_tr_b16 v[168:169], v216 offset:9280
    ds_read_b64_tr_b16 v[170:171], v216 offset:10048
    v_cvt_pk_bf16_f32 v224, v48, v49
    v_cvt_pk_bf16_f32 v225, v50, v51
    v_cvt_pk_bf16_f32 v226, v52, v53
    s_waitcnt lgkmcnt(6)
    v_mfma_f32_32x32x16_bf16 v[96:111], v[144:147], a[52:55], v[96:111]
    ds_read_b64_tr_b16 v[176:177], v216 offset:10752
    ds_read_b64_tr_b16 v[178:179], v216 offset:11520
    buffer_load_dwordx4 v239, s[24:27], s99 offen offset:3072 lds
    v_cvt_pk_bf16_f32 v227, v54, v55
    buffer_store_dwordx4 v[224:227], v4, s[32:35], s88 offen offset:1024 sc1
    v_mfma_f32_32x32x16_bf16 v[112:127], v[148:151], a[52:55], v[112:127]
    ds_read_b64_tr_b16 v[180:181], v216 offset:10784
    ds_read_b64_tr_b16 v[182:183], v216 offset:11552
    v_mul_f32 v228, v64, v208
    v_mul_f32 v229, v65, v208
    v_mul_f32 v230, v66, v208
    v_mfma_f32_32x32x16_bf16 v[128:143], v[152:155], a[52:55], v[128:143]
    ds_read_b64_tr_b16 v[184:185], v216 offset:10816
    ds_read_b64_tr_b16 v[186:187], v216 offset:11584
    v_mul_f32 v231, v67, v208
    v_mul_f32 v232, v68, v208
    v_mul_f32 v233, v69, v208
    s_waitcnt vmcnt(16)
    s_barrier
    v_add_u32 v212, 32768, v20
    s_waitcnt lgkmcnt(6)
    v_mfma_f32_32x32x16_bf16 v[96:111], v[160:163], a[56:59], v[96:111]
    ds_read_b64_tr_b16 v[144:145], v212 offset:0
    ds_read_b64_tr_b16 v[146:147], v212 offset:768
    s_add_u32 s99, s68, 131072
    s_add_u32 m0, s5, 131072
    s_nop 0
    buffer_load_dwordx4 v236, s[24:27], s99 offen offset:0 lds
    v_mul_f32 v234, v70, v208
    v_mul_f32 v235, v71, v208
    v_mfma_f32_32x32x16_bf16 v[112:127], v[164:167], a[56:59], v[112:127]
    ds_read_b64_tr_b16 v[148:149], v212 offset:32
    ds_read_b64_tr_b16 v[150:151], v212 offset:800
    v_exp_f32 v228, v228
    v_mul_f32 v64, v64, v72
    v_exp_f32 v229, v229
    v_mfma_f32_32x32x16_bf16 v[128:143], v[168:171], a[56:59], v[128:143]
    ds_read_b64_tr_b16 v[152:153], v212 offset:64
    ds_read_b64_tr_b16 v[154:155], v212 offset:832
    v_mul_f32 v65, v65, v73
    v_exp_f32 v230, v230
    v_mul_f32 v66, v66, v74
    s_waitcnt lgkmcnt(6)
    v_mfma_f32_32x32x16_bf16 v[96:111], v[176:179], a[60:63], v[96:111]
    ds_read_b64_tr_b16 v[160:161], v212 offset:1536
    ds_read_b64_tr_b16 v[162:163], v212 offset:2304
    buffer_load_dwordx4 v237, s[24:27], s99 offen offset:1024 lds
    v_exp_f32 v231, v231
    v_mul_f32 v67, v67, v75
    v_mfma_f32_32x32x16_bf16 v[112:127], v[180:183], a[60:63], v[112:127]
    ds_read_b64_tr_b16 v[164:165], v212 offset:1568
    ds_read_b64_tr_b16 v[166:167], v212 offset:2336
    v_exp_f32 v232, v232
    v_mul_f32 v68, v68, v76
    v_exp_f32 v233, v233
    v_mfma_f32_32x32x16_bf16 v[128:143], v[184:187], a[60:63], v[128:143]
    ds_read_b64_tr_b16 v[168:169], v212 offset:1600
    ds_read_b64_tr_b16 v[170:171], v212 offset:2368
    v_mul_f32 v69, v69, v77
    v_exp_f32 v234, v234
    v_mul_f32 v70, v70, v78
    s_waitcnt lgkmcnt(6)
    v_mfma_f32_32x32x16_bf16 v[96:111], v[144:147], a[64:67], v[96:111]
    ds_read_b64_tr_b16 v[176:177], v212 offset:3072
    ds_read_b64_tr_b16 v[178:179], v212 offset:3840
    buffer_load_dwordx4 v238, s[24:27], s99 offen offset:2048 lds
    v_exp_f32 v235, v235
    v_mul_f32 v71, v71, v79
    v_mfma_f32_32x32x16_bf16 v[112:127], v[148:151], a[64:67], v[112:127]
    ds_read_b64_tr_b16 v[180:181], v212 offset:3104
    ds_read_b64_tr_b16 v[182:183], v212 offset:3872
    v_fma_f32 v228, v228, v209, v209
    v_fma_f32 v229, v229, v209, v209
    v_fma_f32 v230, v230, v209, v209
    v_mfma_f32_32x32x16_bf16 v[128:143], v[152:155], a[64:67], v[128:143]
    ds_read_b64_tr_b16 v[184:185], v212 offset:3136
    ds_read_b64_tr_b16 v[186:187], v212 offset:3904
    v_fma_f32 v231, v231, v209, v209
    v_fma_f32 v232, v232, v209, v209
    v_fma_f32 v233, v233, v209, v209
    s_waitcnt lgkmcnt(6)
    v_mfma_f32_32x32x16_bf16 v[96:111], v[160:163], a[68:71], v[96:111]
    ds_read_b64_tr_b16 v[144:145], v212 offset:4608
    ds_read_b64_tr_b16 v[146:147], v212 offset:5376
    buffer_load_dwordx4 v239, s[24:27], s99 offen offset:3072 lds
    v_fma_f32 v234, v234, v209, v209
    v_fma_f32 v235, v235, v209, v209
    v_mfma_f32_32x32x16_bf16 v[112:127], v[164:167], a[68:71], v[112:127]
    ds_read_b64_tr_b16 v[148:149], v212 offset:4640
    ds_read_b64_tr_b16 v[150:151], v212 offset:5408
    v_rcp_f32 v228, v228
    v_rcp_f32 v229, v229
    v_rcp_f32 v230, v230
    v_mfma_f32_32x32x16_bf16 v[128:143], v[168:171], a[68:71], v[128:143]
    ds_read_b64_tr_b16 v[152:153], v212 offset:4672
    ds_read_b64_tr_b16 v[154:155], v212 offset:5440
    v_rcp_f32 v231, v231
    v_rcp_f32 v232, v232
    v_rcp_f32 v233, v233
    s_waitcnt lgkmcnt(6)
    v_mfma_f32_32x32x16_bf16 v[96:111], v[176:179], a[72:75], v[96:111]
    ds_read_b64_tr_b16 v[160:161], v212 offset:6144
    ds_read_b64_tr_b16 v[162:163], v212 offset:6912
    s_add_u32 s99, s68, 163840
    s_add_u32 m0, s5, 135168
    s_nop 0
    buffer_load_dwordx4 v236, s[24:27], s99 offen offset:0 lds
    v_rcp_f32 v234, v234
    v_rcp_f32 v235, v235
    v_mfma_f32_32x32x16_bf16 v[112:127], v[180:183], a[72:75], v[112:127]
    ds_read_b64_tr_b16 v[164:165], v212 offset:6176
    ds_read_b64_tr_b16 v[166:167], v212 offset:6944
    v_mul_f32 v64, v64, v228
    v_mul_f32 v65, v65, v229
    v_mul_f32 v66, v66, v230
    v_mfma_f32_32x32x16_bf16 v[128:143], v[184:187], a[72:75], v[128:143]
    ds_read_b64_tr_b16 v[168:169], v212 offset:6208
    ds_read_b64_tr_b16 v[170:171], v212 offset:6976
    v_mul_f32 v67, v67, v231
    v_mul_f32 v68, v68, v232
    v_mul_f32 v69, v69, v233
    s_waitcnt lgkmcnt(6)
    v_mfma_f32_32x32x16_bf16 v[96:111], v[144:147], a[76:79], v[96:111]
    ds_read_b64_tr_b16 v[176:177], v212 offset:7680
    ds_read_b64_tr_b16 v[178:179], v212 offset:8448
    buffer_load_dwordx4 v237, s[24:27], s99 offen offset:1024 lds
    v_mul_f32 v70, v70, v234
    v_mul_f32 v71, v71, v235
    v_mfma_f32_32x32x16_bf16 v[112:127], v[148:151], a[76:79], v[112:127]
    ds_read_b64_tr_b16 v[180:181], v212 offset:7712
    ds_read_b64_tr_b16 v[182:183], v212 offset:8480
    v_cvt_pk_bf16_f32 v220, v64, v65
    v_cvt_pk_bf16_f32 v221, v66, v67
    v_cvt_pk_bf16_f32 v222, v68, v69
    v_mfma_f32_32x32x16_bf16 v[128:143], v[152:155], a[76:79], v[128:143]
    ds_read_b64_tr_b16 v[184:185], v212 offset:7744
    ds_read_b64_tr_b16 v[186:187], v212 offset:8512
    v_cvt_pk_bf16_f32 v223, v70, v71
    buffer_store_dwordx4 v[220:223], v4, s[32:35], s88 offen offset:2048 sc1
    v_mul_f32 v228, v80, v208
    s_waitcnt lgkmcnt(6)
    v_mfma_f32_32x32x16_bf16 v[96:111], v[160:163], a[80:83], v[96:111]
    ds_read_b64_tr_b16 v[144:145], v212 offset:9216
    ds_read_b64_tr_b16 v[146:147], v212 offset:9984
    buffer_load_dwordx4 v238, s[24:27], s99 offen offset:2048 lds
    v_mul_f32 v229, v81, v208
    v_mul_f32 v230, v82, v208
    v_mfma_f32_32x32x16_bf16 v[112:127], v[164:167], a[80:83], v[112:127]
    ds_read_b64_tr_b16 v[148:149], v212 offset:9248
    ds_read_b64_tr_b16 v[150:151], v212 offset:10016
    v_mul_f32 v231, v83, v208
    v_mul_f32 v232, v84, v208
    v_mul_f32 v233, v85, v208
    v_mfma_f32_32x32x16_bf16 v[128:143], v[168:171], a[80:83], v[128:143]
    ds_read_b64_tr_b16 v[152:153], v212 offset:9280
    ds_read_b64_tr_b16 v[154:155], v212 offset:10048
    v_mul_f32 v234, v86, v208
    v_mul_f32 v235, v87, v208
    v_exp_f32 v228, v228
    s_waitcnt lgkmcnt(6)
    v_mfma_f32_32x32x16_bf16 v[96:111], v[176:179], a[84:87], v[96:111]
    ds_read_b64_tr_b16 v[160:161], v212 offset:10752
    ds_read_b64_tr_b16 v[162:163], v212 offset:11520
    buffer_load_dwordx4 v239, s[24:27], s99 offen offset:3072 lds
    v_mul_f32 v80, v80, v88
    v_exp_f32 v229, v229
    v_mfma_f32_32x32x16_bf16 v[112:127], v[180:183], a[84:87], v[112:127]
    ds_read_b64_tr_b16 v[164:165], v212 offset:10784
    ds_read_b64_tr_b16 v[166:167], v212 offset:11552
    v_mul_f32 v81, v81, v89
    v_exp_f32 v230, v230
    v_mul_f32 v82, v82, v90
    v_mfma_f32_32x32x16_bf16 v[128:143], v[184:187], a[84:87], v[128:143]
    ds_read_b64_tr_b16 v[168:169], v212 offset:10816
    ds_read_b64_tr_b16 v[170:171], v212 offset:11584
    v_exp_f32 v231, v231
    v_mul_f32 v83, v83, v91
    v_exp_f32 v232, v232
    s_waitcnt vmcnt(19)
    s_barrier
    v_add_u32 v216, 65536, v20
    s_waitcnt lgkmcnt(6)
    v_mfma_f32_32x32x16_bf16 v[96:111], v[144:147], a[88:91], v[96:111]
    ds_read_b64_tr_b16 v[176:177], v216 offset:0
    ds_read_b64_tr_b16 v[178:179], v216 offset:768
    s_add_u32 s99, s68, 262144
    s_add_u32 m0, s5, 0
    s_nop 0
    buffer_load_dwordx4 v236, s[24:27], s99 offen offset:0 lds
    v_mul_f32 v84, v84, v92
    v_exp_f32 v233, v233
    v_mfma_f32_32x32x16_bf16 v[112:127], v[148:151], a[88:91], v[112:127]
    ds_read_b64_tr_b16 v[180:181], v216 offset:32
    ds_read_b64_tr_b16 v[182:183], v216 offset:800
    v_mul_f32 v85, v85, v93
    v_exp_f32 v234, v234
    v_mul_f32 v86, v86, v94
    v_mfma_f32_32x32x16_bf16 v[128:143], v[152:155], a[88:91], v[128:143]
    ds_read_b64_tr_b16 v[184:185], v216 offset:64
    ds_read_b64_tr_b16 v[186:187], v216 offset:832
    v_exp_f32 v235, v235
    v_mul_f32 v87, v87, v95
    v_fma_f32 v228, v228, v209, v209
    s_waitcnt lgkmcnt(6)
    v_mfma_f32_32x32x16_bf16 v[96:111], v[160:163], a[92:95], v[96:111]
    ds_read_b64_tr_b16 v[144:145], v216 offset:1536
    ds_read_b64_tr_b16 v[146:147], v216 offset:2304
    buffer_load_dwordx4 v237, s[24:27], s99 offen offset:1024 lds
    v_fma_f32 v229, v229, v209, v209
    v_fma_f32 v230, v230, v209, v209
    v_mfma_f32_32x32x16_bf16 v[112:127], v[164:167], a[92:95], v[112:127]
    ds_read_b64_tr_b16 v[148:149], v216 offset:1568
    ds_read_b64_tr_b16 v[150:151], v216 offset:2336
    v_fma_f32 v231, v231, v209, v209
    v_fma_f32 v232, v232, v209, v209
    v_fma_f32 v233, v233, v209, v209
    v_mfma_f32_32x32x16_bf16 v[128:143], v[168:171], a[92:95], v[128:143]
    ds_read_b64_tr_b16 v[152:153], v216 offset:1600
    ds_read_b64_tr_b16 v[154:155], v216 offset:2368
    v_fma_f32 v234, v234, v209, v209
    v_fma_f32 v235, v235, v209, v209
    v_rcp_f32 v228, v228
    s_waitcnt lgkmcnt(6)
    v_mfma_f32_32x32x16_bf16 v[96:111], v[176:179], a[96:99], v[96:111]
    ds_read_b64_tr_b16 v[160:161], v216 offset:3072
    ds_read_b64_tr_b16 v[162:163], v216 offset:3840
    buffer_load_dwordx4 v238, s[24:27], s99 offen offset:2048 lds
    v_rcp_f32 v229, v229
    v_rcp_f32 v230, v230
    v_mfma_f32_32x32x16_bf16 v[112:127], v[180:183], a[96:99], v[112:127]
    ds_read_b64_tr_b16 v[164:165], v216 offset:3104
    ds_read_b64_tr_b16 v[166:167], v216 offset:3872
    v_rcp_f32 v231, v231
    v_rcp_f32 v232, v232
    v_rcp_f32 v233, v233
    v_mfma_f32_32x32x16_bf16 v[128:143], v[184:187], a[96:99], v[128:143]
    ds_read_b64_tr_b16 v[168:169], v216 offset:3136
    ds_read_b64_tr_b16 v[170:171], v216 offset:3904
    v_rcp_f32 v234, v234
    v_rcp_f32 v235, v235
    v_mul_f32 v80, v80, v228
    s_waitcnt lgkmcnt(6)
    v_mfma_f32_32x32x16_bf16 v[96:111], v[144:147], a[100:103], v[96:111]
    ds_read_b64_tr_b16 v[176:177], v216 offset:4608
    ds_read_b64_tr_b16 v[178:179], v216 offset:5376
    buffer_load_dwordx4 v239, s[24:27], s99 offen offset:3072 lds
    v_mul_f32 v81, v81, v229
    v_mul_f32 v82, v82, v230
    v_mfma_f32_32x32x16_bf16 v[112:127], v[148:151], a[100:103], v[112:127]
    ds_read_b64_tr_b16 v[180:181], v216 offset:4640
    ds_read_b64_tr_b16 v[182:183], v216 offset:5408
    v_mul_f32 v83, v83, v231
    v_mul_f32 v84, v84, v232
    v_mul_f32 v85, v85, v233
    v_mfma_f32_32x32x16_bf16 v[128:143], v[152:155], a[100:103], v[128:143]
    ds_read_b64_tr_b16 v[184:185], v216 offset:4672
    ds_read_b64_tr_b16 v[186:187], v216 offset:5440
    v_mul_f32 v86, v86, v234
    v_mul_f32 v87, v87, v235
    v_cvt_pk_bf16_f32 v224, v80, v81
    s_waitcnt lgkmcnt(6)
    v_mfma_f32_32x32x16_bf16 v[96:111], v[160:163], a[104:107], v[96:111]
    ds_read_b64_tr_b16 v[144:145], v216 offset:6144
    ds_read_b64_tr_b16 v[146:147], v216 offset:6912
    s_add_u32 s99, s68, 294912
    s_add_u32 m0, s5, 4096
    s_nop 0
    buffer_load_dwordx4 v236, s[24:27], s99 offen offset:0 lds
    v_cvt_pk_bf16_f32 v225, v82, v83
    v_cvt_pk_bf16_f32 v226, v84, v85
    v_mfma_f32_32x32x16_bf16 v[112:127], v[164:167], a[104:107], v[112:127]
    ds_read_b64_tr_b16 v[148:149], v216 offset:6176
    ds_read_b64_tr_b16 v[150:151], v216 offset:6944
    v_cvt_pk_bf16_f32 v227, v86, v87
    buffer_store_dwordx4 v[224:227], v4, s[32:35], s88 offen offset:3072 sc1
    v_mfma_f32_32x32x16_bf16 v[128:143], v[168:171], a[104:107], v[128:143]
    ds_read_b64_tr_b16 v[152:153], v216 offset:6208
    ds_read_b64_tr_b16 v[154:155], v216 offset:6976
    s_waitcnt lgkmcnt(6)
    v_mfma_f32_32x32x16_bf16 v[96:111], v[176:179], a[108:111], v[96:111]
    ds_read_b64_tr_b16 v[160:161], v216 offset:7680
    ds_read_b64_tr_b16 v[162:163], v216 offset:8448
    buffer_load_dwordx4 v237, s[24:27], s99 offen offset:1024 lds
    v_mfma_f32_32x32x16_bf16 v[112:127], v[180:183], a[108:111], v[112:127]
    ds_read_b64_tr_b16 v[164:165], v216 offset:7712
    ds_read_b64_tr_b16 v[166:167], v216 offset:8480
    v_mfma_f32_32x32x16_bf16 v[128:143], v[184:187], a[108:111], v[128:143]
    ds_read_b64_tr_b16 v[168:169], v216 offset:7744
    ds_read_b64_tr_b16 v[170:171], v216 offset:8512
    s_waitcnt vmcnt(1)
    v_accvgpr_read_b32 v25, a235
    s_mov_b64 s[58:59], exec
    s_mov_b32 exec_lo, 255
    s_mov_b32 exec_hi, 0
    v_mov_b32 v24, 1
    buffer_atomic_add v24, v25, s[32:35], 0 offen offset:12 sc1
    s_mov_b64 exec, s[58:59]
    s_waitcnt lgkmcnt(6)
    v_mfma_f32_32x32x16_bf16 v[96:111], v[144:147], a[112:115], v[96:111]
    ds_read_b64_tr_b16 v[176:177], v216 offset:9216
    ds_read_b64_tr_b16 v[178:179], v216 offset:9984
    buffer_load_dwordx4 v238, s[24:27], s99 offen offset:2048 lds
    v_mfma_f32_32x32x16_bf16 v[112:127], v[148:151], a[112:115], v[112:127]
    ds_read_b64_tr_b16 v[180:181], v216 offset:9248
    ds_read_b64_tr_b16 v[182:183], v216 offset:10016
    v_mfma_f32_32x32x16_bf16 v[128:143], v[152:155], a[112:115], v[128:143]
    ds_read_b64_tr_b16 v[184:185], v216 offset:9280
    ds_read_b64_tr_b16 v[186:187], v216 offset:10048
    s_waitcnt lgkmcnt(6)
    v_mfma_f32_32x32x16_bf16 v[96:111], v[160:163], a[116:119], v[96:111]
    ds_read_b64_tr_b16 v[144:145], v216 offset:10752
    ds_read_b64_tr_b16 v[146:147], v216 offset:11520
    buffer_load_dwordx4 v239, s[24:27], s99 offen offset:3072 lds
    v_mfma_f32_32x32x16_bf16 v[112:127], v[164:167], a[116:119], v[112:127]
    ds_read_b64_tr_b16 v[148:149], v216 offset:10784
    ds_read_b64_tr_b16 v[150:151], v216 offset:11552
    v_mfma_f32_32x32x16_bf16 v[128:143], v[168:171], a[116:119], v[128:143]
    ds_read_b64_tr_b16 v[152:153], v216 offset:10816
    ds_read_b64_tr_b16 v[154:155], v216 offset:11584
    s_barrier
    s_waitcnt lgkmcnt(6)
    v_mfma_f32_32x32x16_bf16 v[96:111], v[176:179], a[120:123], v[96:111]
    s_add_u32 s99, s68, 393216
    s_add_u32 m0, s5, 32768
    s_nop 0
    buffer_load_dwordx4 v236, s[24:27], s99 offen offset:0 lds
    v_mfma_f32_32x32x16_bf16 v[112:127], v[180:183], a[120:123], v[112:127]
    v_mfma_f32_32x32x16_bf16 v[128:143], v[184:187], a[120:123], v[128:143]
    s_waitcnt lgkmcnt(0)
    v_mfma_f32_32x32x16_bf16 v[96:111], v[144:147], a[124:127], v[96:111]
    buffer_load_dwordx4 v237, s[24:27], s99 offen offset:1024 lds
    v_mfma_f32_32x32x16_bf16 v[112:127], v[148:151], a[124:127], v[112:127]
    v_mfma_f32_32x32x16_bf16 v[128:143], v[152:155], a[124:127], v[128:143]
    v_mfma_f32_32x32x16_bf16 v[96:111], a[208:211], v[204:207], v[96:111]
    v_mfma_f32_32x32x16_bf16 v[112:127], a[212:215], v[204:207], v[112:127]
    v_mfma_f32_32x32x16_bf16 v[128:143], a[216:219], v[204:207], v[128:143]
    s_waitcnt lgkmcnt(0)
    s_barrier
    s_add_u32 s3, s70, 12
    s_buffer_load_dword s4, s[32:35], s3 glc
    s_nop 5
    v_pk_mul_f32 v[228:229], v[96:97], v[208:209] op_sel_hi:[1,0]
    v_pk_mul_f32 v[230:231], v[98:99], v[208:209] op_sel_hi:[1,0]
    v_pk_mul_f32 v[232:233], v[100:101], v[208:209] op_sel_hi:[1,0]
    v_pk_mul_f32 v[234:235], v[102:103], v[208:209] op_sel_hi:[1,0]
    buffer_load_dwordx4 v238, s[24:27], s99 offen offset:2048 lds
    v_exp_f32 v228, v228
    v_exp_f32 v229, v229
    v_exp_f32 v230, v230
    v_exp_f32 v231, v231
    v_exp_f32 v232, v232
    v_exp_f32 v233, v233
    v_exp_f32 v234, v234
    v_exp_f32 v235, v235
    buffer_load_dwordx4 v239, s[24:27], s99 offen offset:3072 lds
    v_pk_mul_f32 v[96:97], v[96:97], v[104:105]
    v_pk_mul_f32 v[98:99], v[98:99], v[106:107]
    v_pk_mul_f32 v[100:101], v[100:101], v[108:109]
    v_pk_mul_f32 v[102:103], v[102:103], v[110:111]
    v_pk_fma_f32 v[228:229], v[228:229], v[208:209], v[208:209] op_sel:[0,1,1] op_sel_hi:[1,1,1]
    v_pk_fma_f32 v[230:231], v[230:231], v[208:209], v[208:209] op_sel:[0,1,1] op_sel_hi:[1,1,1]
    v_pk_fma_f32 v[232:233], v[232:233], v[208:209], v[208:209] op_sel:[0,1,1] op_sel_hi:[1,1,1]
    v_pk_fma_f32 v[234:235], v[234:235], v[208:209], v[208:209] op_sel:[0,1,1] op_sel_hi:[1,1,1]
    s_add_u32 s99, s68, 425984
    s_add_u32 m0, s5, 36864
    s_nop 0
    buffer_load_dwordx4 v236, s[24:27], s99 offen offset:0 lds
    v_rcp_f32 v228, v228
    v_rcp_f32 v229, v229
    v_rcp_f32 v230, v230
    v_rcp_f32 v231, v231
    v_rcp_f32 v232, v232
    v_rcp_f32 v233, v233
    v_rcp_f32 v234, v234
    v_rcp_f32 v235, v235
    buffer_load_dwordx4 v237, s[24:27], s99 offen offset:1024 lds
    v_pk_mul_f32 v[96:97], v[96:97], v[228:229]
    v_pk_mul_f32 v[98:99], v[98:99], v[230:231]
    v_pk_mul_f32 v[100:101], v[100:101], v[232:233]
    v_pk_mul_f32 v[102:103], v[102:103], v[234:235]
    v_cvt_pk_bf16_f32 v220, v96, v97
    v_cvt_pk_bf16_f32 v221, v98, v99
    v_cvt_pk_bf16_f32 v222, v100, v101
    v_cvt_pk_bf16_f32 v223, v102, v103
    buffer_load_dwordx4 v238, s[24:27], s99 offen offset:2048 lds
    buffer_store_dwordx4 v[220:223], v4, s[32:35], s89 offen offset:0 sc1
    v_pk_mul_f32 v[228:229], v[112:113], v[208:209] op_sel_hi:[1,0]
    v_pk_mul_f32 v[230:231], v[114:115], v[208:209] op_sel_hi:[1,0]
    v_pk_mul_f32 v[232:233], v[116:117], v[208:209] op_sel_hi:[1,0]
    v_pk_mul_f32 v[234:235], v[118:119], v[208:209] op_sel_hi:[1,0]
    buffer_load_dwordx4 v239, s[24:27], s99 offen offset:3072 lds
    v_exp_f32 v228, v228
    v_exp_f32 v229, v229
    v_exp_f32 v230, v230
    v_exp_f32 v231, v231
    v_exp_f32 v232, v232
    v_exp_f32 v233, v233
    v_exp_f32 v234, v234
    v_exp_f32 v235, v235
    s_add_u32 s99, s49, 0
    s_add_u32 m0, s5, 65536
    s_nop 0
    buffer_load_dwordx4 v236, s[24:27], s99 offen offset:0 lds
    v_pk_mul_f32 v[112:113], v[112:113], v[120:121]
    v_pk_mul_f32 v[114:115], v[114:115], v[122:123]
    v_pk_mul_f32 v[116:117], v[116:117], v[124:125]
    v_pk_mul_f32 v[118:119], v[118:119], v[126:127]
    v_pk_fma_f32 v[228:229], v[228:229], v[208:209], v[208:209] op_sel:[0,1,1] op_sel_hi:[1,1,1]
    v_pk_fma_f32 v[230:231], v[230:231], v[208:209], v[208:209] op_sel:[0,1,1] op_sel_hi:[1,1,1]
    v_pk_fma_f32 v[232:233], v[232:233], v[208:209], v[208:209] op_sel:[0,1,1] op_sel_hi:[1,1,1]
    v_pk_fma_f32 v[234:235], v[234:235], v[208:209], v[208:209] op_sel:[0,1,1] op_sel_hi:[1,1,1]
    buffer_load_dwordx4 v237, s[24:27], s99 offen offset:1024 lds
    v_rcp_f32 v228, v228
    v_rcp_f32 v229, v229
    v_rcp_f32 v230, v230
    v_rcp_f32 v231, v231
    v_rcp_f32 v232, v232
    v_rcp_f32 v233, v233
    v_rcp_f32 v234, v234
    v_rcp_f32 v235, v235
    buffer_load_dwordx4 v238, s[24:27], s99 offen offset:2048 lds
    v_pk_mul_f32 v[112:113], v[112:113], v[228:229]
    v_pk_mul_f32 v[114:115], v[114:115], v[230:231]
    v_pk_mul_f32 v[116:117], v[116:117], v[232:233]
    v_pk_mul_f32 v[118:119], v[118:119], v[234:235]
    v_cvt_pk_bf16_f32 v224, v112, v113
    v_cvt_pk_bf16_f32 v225, v114, v115
    v_cvt_pk_bf16_f32 v226, v116, v117
    v_cvt_pk_bf16_f32 v227, v118, v119
    buffer_load_dwordx4 v239, s[24:27], s99 offen offset:3072 lds
    buffer_store_dwordx4 v[224:227], v4, s[32:35], s89 offen offset:1024 sc1
    v_pk_mul_f32 v[228:229], v[128:129], v[208:209] op_sel_hi:[1,0]
    v_pk_mul_f32 v[230:231], v[130:131], v[208:209] op_sel_hi:[1,0]
    v_pk_mul_f32 v[232:233], v[132:133], v[208:209] op_sel_hi:[1,0]
    v_pk_mul_f32 v[234:235], v[134:135], v[208:209] op_sel_hi:[1,0]
    s_add_u32 s99, s49, 32768
    s_add_u32 m0, s5, 69632
    s_nop 0
    buffer_load_dwordx4 v236, s[24:27], s99 offen offset:0 lds
    v_exp_f32 v228, v228
    v_exp_f32 v229, v229
    v_exp_f32 v230, v230
    v_exp_f32 v231, v231
    v_exp_f32 v232, v232
    v_exp_f32 v233, v233
    v_exp_f32 v234, v234
    v_exp_f32 v235, v235
    buffer_load_dwordx4 v237, s[24:27], s99 offen offset:1024 lds
    v_pk_mul_f32 v[128:129], v[128:129], v[136:137]
    v_pk_mul_f32 v[130:131], v[130:131], v[138:139]
    v_pk_mul_f32 v[132:133], v[132:133], v[140:141]
    v_pk_mul_f32 v[134:135], v[134:135], v[142:143]
    v_pk_fma_f32 v[228:229], v[228:229], v[208:209], v[208:209] op_sel:[0,1,1] op_sel_hi:[1,1,1]
    v_pk_fma_f32 v[230:231], v[230:231], v[208:209], v[208:209] op_sel:[0,1,1] op_sel_hi:[1,1,1]
    v_pk_fma_f32 v[232:233], v[232:233], v[208:209], v[208:209] op_sel:[0,1,1] op_sel_hi:[1,1,1]
    v_pk_fma_f32 v[234:235], v[234:235], v[208:209], v[208:209] op_sel:[0,1,1] op_sel_hi:[1,1,1]
    buffer_load_dwordx4 v238, s[24:27], s99 offen offset:2048 lds
    v_rcp_f32 v228, v228
    v_rcp_f32 v229, v229
    v_rcp_f32 v230, v230
    v_rcp_f32 v231, v231
    v_rcp_f32 v232, v232
    v_rcp_f32 v233, v233
    v_rcp_f32 v234, v234
    v_rcp_f32 v235, v235
    buffer_load_dwordx4 v239, s[24:27], s99 offen offset:3072 lds
    v_pk_mul_f32 v[128:129], v[128:129], v[228:229]
    v_pk_mul_f32 v[130:131], v[130:131], v[230:231]
    v_pk_mul_f32 v[132:133], v[132:133], v[232:233]
    v_pk_mul_f32 v[134:135], v[134:135], v[234:235]
    v_cvt_pk_bf16_f32 v220, v128, v129
    v_cvt_pk_bf16_f32 v221, v130, v131
    v_cvt_pk_bf16_f32 v222, v132, v133
    v_cvt_pk_bf16_f32 v223, v134, v135
    buffer_store_dwordx4 v[220:223], v4, s[32:35], s89 offen offset:2048 sc1
    s_mul_i32 s90, s72, 114688
    s_add_u32 s90, s90, 16777216
    s_and_b32 s75, s44, 1
    s_mul_i32 s91, s75, 24576
    s_add_u32 s91, s91, s90
    s_add_u32 s91, s91, 65536
    s_lshl_b32 s75, s75, 15
    s_add_u32 s90, s90, s75
    s_and_b32 s75, s44, 1
    s_lshl_b32 s75, s75, 14
    v_add_u32 v112, s75, v14
    v_add_u32 v113, s75, v15
    v_add_u32 v114, s75, v14
    v_add_u32 v114, 65536, v114
    v_add_u32 v115, s75, v15
    v_add_u32 v115, 65536, v115
    v_add_u32 v116, s75, v14
    v_add_u32 v116, 131072, v116
    v_add_u32 v117, s75, v15
    v_add_u32 v117, 131072, v117
    s_waitcnt lgkmcnt(0)
    s_cmp_ge_u32 s4, 8
    s_cbranch_scc1 PD_120
    s_mov_b32 s60, 0
PL_119:
    s_buffer_load_dword s4, s[32:35], s3 glc
    s_add_u32 s60, s60, 1
    s_cmp_gt_u32 s60, 0x80000
    s_cbranch_scc1 L_bail
    s_waitcnt lgkmcnt(0)
    s_cmp_lt_u32 s4, 8
    s_cbranch_scc1 PL_119
PD_120:
    s_add_u32 s98, s90, 0
    buffer_load_dwordx4 a[0:3], v4, s[32:35], s98 offen offset:0 sc1
    s_add_u32 s98, s90, 0
    buffer_load_dwordx4 a[4:7], v4, s[32:35], s98 offen offset:1024 sc1
    s_add_u32 s98, s90, 0
    buffer_load_dwordx4 a[8:11], v4, s[32:35], s98 offen offset:2048 sc1
    s_add_u32 s98, s90, 0
    buffer_load_dwordx4 a[12:15], v4, s[32:35], s98 offen offset:3072 sc1
    s_waitcnt vmcnt(4)
    v_accvgpr_read_b32 v25, a235
    s_mov_b64 s[58:59], exec
    s_mov_b32 exec_lo, 255
    s_mov_b32 exec_hi, 0
    v_mov_b32 v24, 1
    buffer_atomic_add v24, v25, s[32:35], 0 offen offset:16 sc1
    s_mov_b64 exec, s[58:59]
    s_add_u32 s98, s90, 4096
    buffer_load_dwordx4 a[16:19], v4, s[32:35], s98 offen offset:0 sc1
    s_add_u32 s98, s90, 4096
    buffer_load_dwordx4 a[20:23], v4, s[32:35], s98 offen offset:1024 sc1
    s_add_u32 s98, s90, 4096
    buffer_load_dwordx4 a[24:27], v4, s[32:35], s98 offen offset:2048 sc1
    s_add_u32 s98, s90, 4096
    buffer_load_dwordx4 a[28:31], v4, s[32:35], s98 offen offset:3072 sc1
    s_add_u32 s98, s90, 8192
    buffer_load_dwordx4 a[32:35], v4, s[32:35], s98 offen offset:0 sc1
    s_add_u32 s98, s90, 8192
    buffer_load_dwordx4 a[36:39], v4, s[32:35], s98 offen offset:1024 sc1
    s_add_u32 s98, s90, 8192
    buffer_load_dwordx4 a[40:43], v4, s[32:35], s98 offen offset:2048 sc1
    s_add_u32 s98, s90, 8192
    buffer_load_dwordx4 a[44:47], v4, s[32:35], s98 offen offset:3072 sc1
    s_add_u32 s98, s90, 12288
    buffer_load_dwordx4 a[48:51], v4, s[32:35], s98 offen offset:0 sc1
    s_add_u32 s98, s90, 12288
    buffer_load_dwordx4 a[52:55], v4, s[32:35], s98 offen offset:1024 sc1
    s_lshr_b32 s76, s44, 1
    s_lshl_b32 s76, s76, 15
    s_add_u32 s76, s76, s75
    s_add_u32 s76, s76, 98304
    v_add_u32 v118, s76, v4
    s_barrier
    ds_read_b64_tr_b16 v[64:65], v114 offset:32768
    ds_read_b64_tr_b16 v[66:67], v114 offset:33792
    ds_read_b64_tr_b16 v[68:69], v115 offset:32768
    ds_read_b64_tr_b16 v[70:71], v115 offset:33792
    ds_read_b64_tr_b16 v[72:73], v114 offset:34816
    ds_read_b64_tr_b16 v[74:75], v114 offset:35840
    ds_read_b64_tr_b16 v[76:77], v115 offset:34816
    ds_read_b64_tr_b16 v[78:79], v115 offset:35840
    s_waitcnt vmcnt(14) lgkmcnt(6)
    v_mfma_f32_32x32x16_bf16 v[32:47], v[64:67], a[0:3], 0
    ds_read_b64_tr_b16 v[80:81], v114 offset:36864
    ds_read_b64_tr_b16 v[82:83], v114 offset:37888
    s_add_u32 s98, s90, 12288
    buffer_load_dwordx4 a[56:59], v4, s[32:35], s98 offen offset:2048 sc1
    s_waitcnt lgkmcnt(6)
    v_mfma_f32_32x32x16_bf16 v[48:63], v[68:71], a[0:3], 0
    ds_read_b64_tr_b16 v[84:85], v115 offset:36864
    ds_read_b64_tr_b16 v[86:87], v115 offset:37888
    s_waitcnt vmcnt(14) lgkmcnt(6)
    v_mfma_f32_32x32x16_bf16 v[32:47], v[72:75], a[4:7], v[32:47]
    ds_read_b64_tr_b16 v[64:65], v114 offset:38912
    ds_read_b64_tr_b16 v[66:67], v114 offset:39936
    s_add_u32 s98, s90, 12288
    buffer_load_dwordx4 a[60:63], v4, s[32:35], s98 offen offset:3072 sc1
    s_waitcnt lgkmcnt(6)
    v_mfma_f32_32x32x16_bf16 v[48:63], v[76:79], a[4:7], v[48:63]
    ds_read_b64_tr_b16 v[68:69], v115 offset:38912
    ds_read_b64_tr_b16 v[70:71], v115 offset:39936
    s_waitcnt vmcnt(14) lgkmcnt(6)
    v_mfma_f32_32x32x16_bf16 v[32:47], v[80:83], a[8:11], v[32:47]
    ds_read_b64_tr_b16 v[72:73], v114 offset:40960
    ds_read_b64_tr_b16 v[74:75], v114 offset:41984
    s_add_u32 s98, s90, 16384
    buffer_load_dwordx4 a[64:67], v4, s[32:35], s98 offen offset:0 sc1
    s_waitcnt lgkmcnt(6)
    v_mfma_f32_32x32x16_bf16 v[48:63], v[84:87], a[8:11], v[48:63]
    ds_read_b64_tr_b16 v[76:77], v115 offset:40960
    ds_read_b64_tr_b16 v[78:79], v115 offset:41984
    s_waitcnt vmcnt(14) lgkmcnt(6)
    v_mfma_f32_32x32x16_bf16 v[32:47], v[64:67], a[12:15], v[32:47]
    ds_read_b64_tr_b16 v[80:81], v114 offset:43008
    ds_read_b64_tr_b16 v[82:83], v114 offset:44032
    s_add_u32 s98, s90, 16384
    buffer_load_dwordx4 a[68:71], v4, s[32:35], s98 offen offset:1024 sc1
    s_waitcnt lgkmcnt(6)
    v_mfma_f32_32x32x16_bf16 v[48:63], v[68:71], a[12:15], v[48:63]
    ds_read_b64_tr_b16 v[84:85], v115 offset:43008
    ds_read_b64_tr_b16 v[86:87], v115 offset:44032
    s_waitcnt vmcnt(13) lgkmcnt(6)
    v_mfma_f32_32x32x16_bf16 v[32:47], v[72:75], a[16:19], v[32:47]
    ds_read_b64_tr_b16 v[64:65], v114 offset:45056
    ds_read_b64_tr_b16 v[66:67], v114 offset:46080
    s_add_u32 s98, s90, 16384
    buffer_load_dwordx4 a[72:75], v4, s[32:35], s98 offen offset:2048 sc1
    s_waitcnt lgkmcnt(6)
    v_mfma_f32_32x32x16_bf16 v[48:63], v[76:79], a[16:19], v[48:63]
    ds_read_b64_tr_b16 v[68:69], v115 offset:45056
    ds_read_b64_tr_b16 v[70:71], v115 offset:46080
    s_waitcnt vmcnt(13) lgkmcnt(6)
    v_mfma_f32_32x32x16_bf16 v[32:47], v[80:83], a[20:23], v[32:47]
    ds_read_b64_tr_b16 v[72:73], v114 offset:47104
    ds_read_b64_tr_b16 v[74:75], v114 offset:48128
    s_add_u32 s98, s90, 16384
    buffer_load_dwordx4 a[76:79], v4, s[32:35], s98 offen offset:3072 sc1
    s_waitcnt lgkmcnt(6)
    v_mfma_f32_32x32x16_bf16 v[48:63], v[84:87], a[20:23], v[48:63]
    ds_read_b64_tr_b16 v[76:77], v115 offset:47104
    ds_read_b64_tr_b16 v[78:79], v115 offset:48128
    s_waitcnt vmcnt(13) lgkmcnt(6)
    v_mfma_f32_32x32x16_bf16 v[32:47], v[64:67], a[24:27], v[32:47]
    ds_read_b64_tr_b16 v[80:81], v116 offset:0
    ds_read_b64_tr_b16 v[82:83], v116 offset:1024
    s_add_u32 s98, s90, 20480
    buffer_load_dwordx4 a[80:83], v4, s[32:35], s98 offen offset:0 sc1
    s_waitcnt lgkmcnt(6)
    v_mfma_f32_32x32x16_bf16 v[48:63], v[68:71], a[24:27], v[48:63]
    ds_read_b64_tr_b16 v[84:85], v117 offset:0
    ds_read_b64_tr_b16 v[86:87], v117 offset:1024
    s_waitcnt vmcnt(13) lgkmcnt(6)
    v_mfma_f32_32x32x16_bf16 v[32:47], v[72:75], a[28:31], v[32:47]
    ds_read_b64_tr_b16 v[64:65], v116 offset:2048
    ds_read_b64_tr_b16 v[66:67], v116 offset:3072
    s_add_u32 s98, s90, 20480
    buffer_load_dwordx4 a[84:87], v4, s[32:35], s98 offen offset:1024 sc1
    s_waitcnt lgkmcnt(6)
    v_mfma_f32_32x32x16_bf16 v[48:63], v[76:79], a[28:31], v[48:63]
    ds_read_b64_tr_b16 v[68:69], v117 offset:2048
    ds_read_b64_tr_b16 v[70:71], v117 offset:3072
    s_waitcnt vmcnt(13) lgkmcnt(6)
    v_mfma_f32_32x32x16_bf16 v[32:47], v[80:83], a[32:35], v[32:47]
    ds_read_b64_tr_b16 v[72:73], v116 offset:4096
    ds_read_b64_tr_b16 v[74:75], v116 offset:5120
    s_add_u32 s98, s90, 20480
    buffer_load_dwordx4 a[88:91], v4, s[32:35], s98 offen offset:2048 sc1
    s_waitcnt lgkmcnt(6)
    v_mfma_f32_32x32x16_bf16 v[48:63], v[84:87], a[32:35], v[48:63]
    ds_read_b64_tr_b16 v[76:77], v117 offset:4096
    ds_read_b64_tr_b16 v[78:79], v117 offset:5120
    s_waitcnt vmcnt(13) lgkmcnt(6)
    v_mfma_f32_32x32x16_bf16 v[32:47], v[64:67], a[36:39], v[32:47]
    ds_read_b64_tr_b16 v[80:81], v116 offset:6144
    ds_read_b64_tr_b16 v[82:83], v116 offset:7168
    s_add_u32 s98, s90, 20480
    buffer_load_dwordx4 a[92:95], v4, s[32:35], s98 offen offset:3072 sc1
    s_waitcnt lgkmcnt(6)
    v_mfma_f32_32x32x16_bf16 v[48:63], v[68:71], a[36:39], v[48:63]
    ds_read_b64_tr_b16 v[84:85], v117 offset:6144
    ds_read_b64_tr_b16 v[86:87], v117 offset:7168
    s_waitcnt vmcnt(13) lgkmcnt(6)
    v_mfma_f32_32x32x16_bf16 v[32:47], v[72:75], a[40:43], v[32:47]
    ds_read_b64_tr_b16 v[64:65], v116 offset:8192
    ds_read_b64_tr_b16 v[66:67], v116 offset:9216
    s_add_u32 s98, s90, 24576
    buffer_load_dwordx4 a[96:99], v4, s[32:35], s98 offen offset:0 sc1
    s_waitcnt lgkmcnt(6)
    v_mfma_f32_32x32x16_bf16 v[48:63], v[76:79], a[40:43], v[48:63]
    ds_read_b64_tr_b16 v[68:69], v117 offset:8192
    ds_read_b64_tr_b16 v[70:71], v117 offset:9216
    s_waitcnt vmcnt(13) lgkmcnt(6)
    v_mfma_f32_32x32x16_bf16 v[32:47], v[80:83], a[44:47], v[32:47]
    ds_read_b64_tr_b16 v[72:73], v116 offset:10240
    ds_read_b64_tr_b16 v[74:75], v116 offset:11264
    s_add_u32 s98, s90, 24576
    buffer_load_dwordx4 a[100:103], v4, s[32:35], s98 offen offset:1024 sc1
    s_waitcnt lgkmcnt(6)
    v_mfma_f32_32x32x16_bf16 v[48:63], v[84:87], a[44:47], v[48:63]
    ds_read_b64_tr_b16 v[76:77], v117 offset:10240
    ds_read_b64_tr_b16 v[78:79], v117 offset:11264
    s_waitcnt vmcnt(13) lgkmcnt(6)
    v_mfma_f32_32x32x16_bf16 v[32:47], v[64:67], a[48:51], v[32:47]
    ds_read_b64_tr_b16 v[80:81], v116 offset:12288
    ds_read_b64_tr_b16 v[82:83], v116 offset:13312
    s_add_u32 s98, s90, 24576
    buffer_load_dwordx4 a[104:107], v4, s[32:35], s98 offen offset:2048 sc1
    s_waitcnt lgkmcnt(6)
    v_mfma_f32_32x32x16_bf16 v[48:63], v[68:71], a[48:51], v[48:63]
    ds_read_b64_tr_b16 v[84:85], v117 offset:12288
    ds_read_b64_tr_b16 v[86:87], v117 offset:13312
    s_waitcnt vmcnt(13) lgkmcnt(6)
    v_mfma_f32_32x32x16_bf16 v[32:47], v[72:75], a[52:55], v[32:47]
    ds_read_b64_tr_b16 v[64:65], v116 offset:14336
    ds_read_b64_tr_b16 v[66:67], v116 offset:15360
    s_add_u32 s98, s90, 24576
    buffer_load_dwordx4 a[108:111], v4, s[32:35], s98 offen offset:3072 sc1
    s_waitcnt lgkmcnt(6)
    v_mfma_f32_32x32x16_bf16 v[48:63], v[76:79], a[52:55], v[48:63]
    ds_read_b64_tr_b16 v[68:69], v117 offset:14336
    ds_read_b64_tr_b16 v[70:71], v117 offset:15360
    s_waitcnt vmcnt(13) lgkmcnt(6)
    v_mfma_f32_32x32x16_bf16 v[32:47], v[80:83], a[56:59], v[32:47]
    ds_read_b64_tr_b16 v[72:73], v112 offset:0
    ds_read_b64_tr_b16 v[74:75], v112 offset:1024
    s_add_u32 s98, s90, 28672
    buffer_load_dwordx4 a[112:115], v4, s[32:35], s98 offen offset:0 sc1
    s_waitcnt lgkmcnt(6)
    v_mfma_f32_32x32x16_bf16 v[48:63], v[84:87], a[56:59], v[48:63]
    ds_read_b64_tr_b16 v[76:77], v113 offset:0
    ds_read_b64_tr_b16 v[78:79], v113 offset:1024
    s_mov_b64 s[58:59], exec
    s_mov_b64 exec, 1
    v_mov_b32 v120, 0
    v_mov_b32 v23, s70
    buffer_atomic_add v120, v23, s[32:35], 0 offen offset:16 sc0 sc1
    s_mov_b64 exec, s[58:59]
    s_waitcnt vmcnt(14) lgkmcnt(6)
    v_mfma_f32_32x32x16_bf16 v[32:47], v[64:67], a[60:63], v[32:47]
    ds_read_b64_tr_b16 v[80:81], v112 offset:2048
    ds_read_b64_tr_b16 v[82:83], v112 offset:3072
    s_add_u32 s98, s90, 28672
    buffer_load_dwordx4 a[116:119], v4, s[32:35], s98 offen offset:1024 sc1
    s_waitcnt lgkmcnt(6)
    v_mfma_f32_32x32x16_bf16 v[48:63], v[68:71], a[60:63], v[48:63]
    ds_read_b64_tr_b16 v[84:85], v113 offset:2048
    ds_read_b64_tr_b16 v[86:87], v113 offset:3072
    s_barrier
    s_cmp_lg_u32 s44, 0
    s_cbranch_scc1 LW_121
    ds_write_b128 v118, a[128:131] offset:0
    ds_write_b128 v118, a[132:135] offset:1024
    ds_write_b128 v118, a[136:139] offset:2048
    ds_write_b128 v118, a[140:143] offset:3072
LW_121:
    s_waitcnt vmcnt(14) lgkmcnt(6)
    v_mfma_f32_32x32x16_bf16 v[32:47], v[72:75], a[64:67], v[32:47]
    ds_read_b64_tr_b16 v[64:65], v112 offset:4096
    ds_read_b64_tr_b16 v[66:67], v112 offset:5120
    s_add_u32 s98, s90, 28672
    buffer_load_dwordx4 a[120:123], v4, s[32:35], s98 offen offset:2048 sc1
    s_waitcnt lgkmcnt(6)
    v_mfma_f32_32x32x16_bf16 v[48:63], v[76:79], a[64:67], v[48:63]
    ds_read_b64_tr_b16 v[68:69], v113 offset:4096
    ds_read_b64_tr_b16 v[70:71], v113 offset:5120
    s_cmp_lg_u32 s44, 1
    s_cbranch_scc1 LW_122
    ds_write_b128 v118, a[128:131] offset:0
    ds_write_b128 v118, a[132:135] offset:1024
    ds_write_b128 v118, a[136:139] offset:2048
    ds_write_b128 v118, a[140:143] offset:3072
LW_122:
    s_waitcnt vmcnt(14) lgkmcnt(6)
    v_mfma_f32_32x32x16_bf16 v[32:47], v[80:83], a[68:71], v[32:47]
    ds_read_b64_tr_b16 v[72:73], v112 offset:6144
    ds_read_b64_tr_b16 v[74:75], v112 offset:7168
    s_add_u32 s98, s90, 28672
    buffer_load_dwordx4 a[124:127], v4, s[32:35], s98 offen offset:3072 sc1
    s_waitcnt lgkmcnt(6)
    v_mfma_f32_32x32x16_bf16 v[48:63], v[84:87], a[68:71], v[48:63]
    ds_read_b64_tr_b16 v[76:77], v113 offset:6144
    ds_read_b64_tr_b16 v[78:79], v113 offset:7168
    s_cmp_lg_u32 s44, 2
    s_cbranch_scc1 LW_123
    ds_write_b128 v118, a[128:131] offset:0
    ds_write_b128 v118, a[132:135] offset:1024
    ds_write_b128 v118, a[136:139] offset:2048
    ds_write_b128 v118, a[140:143] offset:3072
LW_123:
    s_waitcnt vmcnt(14) lgkmcnt(6)
    v_mfma_f32_32x32x16_bf16 v[32:47], v[64:67], a[72:75], v[32:47]
    ds_read_b64_tr_b16 v[80:81], v112 offset:8192
    ds_read_b64_tr_b16 v[82:83], v112 offset:9216
    s_waitcnt lgkmcnt(6)
    v_mfma_f32_32x32x16_bf16 v[48:63], v[68:71], a[72:75], v[48:63]
    ds_read_b64_tr_b16 v[84:85], v113 offset:8192
    ds_read_b64_tr_b16 v[86:87], v113 offset:9216
    s_cmp_lg_u32 s44, 3
    s_cbranch_scc1 LW_124
    ds_write_b128 v118, a[128:131] offset:0
    ds_write_b128 v118, a[132:135] offset:1024
    ds_write_b128 v118, a[136:139] offset:2048
    ds_write_b128 v118, a[140:143] offset:3072
LW_124:
    s_waitcnt vmcnt(3)
    v_readfirstlane_b32 s4, v120
    s_nop 1
    s_cmp_ge_u32 s4, 8
    s_cbranch_scc1 PD_126
    s_add_u32 s3, s70, 16
    s_mov_b32 s60, 0
PL_125:
    s_buffer_load_dword s4, s[32:35], s3 glc
    s_add_u32 s60, s60, 1
    s_cmp_gt_u32 s60, 0x80000
    s_cbranch_scc1 L_bail
    s_waitcnt lgkmcnt(0)
    s_cmp_lt_u32 s4, 8
    s_cbranch_scc1 PL_125
PD_126:
    s_waitcnt lgkmcnt(6)
    v_mfma_f32_32x32x16_bf16 v[32:47], v[72:75], a[76:79], v[32:47]
    ds_read_b64_tr_b16 v[64:65], v112 offset:10240
    ds_read_b64_tr_b16 v[66:67], v112 offset:11264
    s_add_u32 s98, s91, 0
    buffer_load_dwordx4 a[0:3], v4, s[32:35], s98 offen offset:0 sc1
    s_waitcnt lgkmcnt(6)
    v_mfma_f32_32x32x16_bf16 v[48:63], v[76:79], a[76:79], v[48:63]
    ds_read_b64_tr_b16 v[68:69], v113 offset:10240
    ds_read_b64_tr_b16 v[70:71], v113 offset:11264
    s_cmp_lg_u32 s44, 0
    s_cbranch_scc1 LW_127
    ds_write_b128 v118, a[144:147] offset:4096
    ds_write_b128 v118, a[148:151] offset:5120
    ds_write_b128 v118, a[152:155] offset:6144
    ds_write_b128 v118, a[156:159] offset:7168
LW_127:
    s_waitcnt lgkmcnt(6)
    v_mfma_f32_32x32x16_bf16 v[32:47], v[80:83], a[80:83], v[32:47]
    ds_read_b64_tr_b16 v[72:73], v112 offset:12288
    ds_read_b64_tr_b16 v[74:75], v112 offset:13312
    s_add_u32 s98, s91, 0
    buffer_load_dwordx4 a[4:7], v4, s[32:35], s98 offen offset:1024 sc1
    s_waitcnt lgkmcnt(6)
    v_mfma_f32_32x32x16_bf16 v[48:63], v[84:87], a[80:83], v[48:63]
    ds_read_b64_tr_b16 v[76:77], v113 offset:12288
    ds_read_b64_tr_b16 v[78:79], v113 offset:13312
    s_cmp_lg_u32 s44, 1
    s_cbranch_scc1 LW_128
    ds_write_b128 v118, a[144:147] offset:4096
    ds_write_b128 v118, a[148:151] offset:5120
    ds_write_b128 v118, a[152:155] offset:6144
    ds_write_b128 v118, a[156:159] offset:7168
LW_128:
    s_waitcnt lgkmcnt(6)
    v_mfma_f32_32x32x16_bf16 v[32:47], v[64:67], a[84:87], v[32:47]
    ds_read_b64_tr_b16 v[80:81], v112 offset:14336
    ds_read_b64_tr_b16 v[82:83], v112 offset:15360
    s_add_u32 s98, s91, 0
    buffer_load_dwordx4 a[8:11], v4, s[32:35], s98 offen offset:2048 sc1
    s_waitcnt lgkmcnt(6)
    v_mfma_f32_32x32x16_bf16 v[48:63], v[68:71], a[84:87], v[48:63]
    ds_read_b64_tr_b16 v[84:85], v113 offset:14336
    ds_read_b64_tr_b16 v[86:87], v113 offset:15360
    s_cmp_lg_u32 s44, 2
    s_cbranch_scc1 LW_129
    ds_write_b128 v118, a[144:147] offset:4096
    ds_write_b128 v118, a[148:151] offset:5120
    ds_write_b128 v118, a[152:155] offset:6144
    ds_write_b128 v118, a[156:159] offset:7168
LW_129:
    s_waitcnt lgkmcnt(6)
    v_mfma_f32_32x32x16_bf16 v[32:47], v[72:75], a[88:91], v[32:47]
    ds_read_b64_tr_b16 v[64:65], v112 offset:32768
    ds_read_b64_tr_b16 v[66:67], v112 offset:33792
    s_add_u32 s98, s91, 0
    buffer_load_dwordx4 a[12:15], v4, s[32:35], s98 offen offset:3072 sc1
    s_waitcnt lgkmcnt(6)
    v_mfma_f32_32x32x16_bf16 v[48:63], v[76:79], a[88:91], v[48:63]
    ds_read_b64_tr_b16 v[68:69], v113 offset:32768
    ds_read_b64_tr_b16 v[70:71], v113 offset:33792
    s_cmp_lg_u32 s44, 3
    s_cbranch_scc1 LW_130
    ds_write_b128 v118, a[144:147] offset:4096
    ds_write_b128 v118, a[148:151] offset:5120
    ds_write_b128 v118, a[152:155] offset:6144
    ds_write_b128 v118, a[156:159] offset:7168
LW_130:
    s_waitcnt lgkmcnt(6)
    v_mfma_f32_32x32x16_bf16 v[32:47], v[80:83], a[92:95], v[32:47]
    ds_read_b64_tr_b16 v[72:73], v112 offset:34816
    ds_read_b64_tr_b16 v[74:75], v112 offset:35840
    s_add_u32 s98, s91, 4096
    buffer_load_dwordx4 a[16:19], v4, s[32:35], s98 offen offset:0 sc1
    s_waitcnt lgkmcnt(6)
    v_mfma_f32_32x32x16_bf16 v[48:63], v[84:87], a[92:95], v[48:63]
    ds_read_b64_tr_b16 v[76:77], v113 offset:34816
    ds_read_b64_tr_b16 v[78:79], v113 offset:35840
    s_cmp_lg_u32 s44, 0
    s_cbranch_scc1 LW_131
    ds_write_b128 v118, a[160:163] offset:8192
    ds_write_b128 v118, a[164:167] offset:9216
    ds_write_b128 v118, a[168:171] offset:10240
    ds_write_b128 v118, a[172:175] offset:11264
LW_131:
    s_waitcnt lgkmcnt(6)
    v_mfma_f32_32x32x16_bf16 v[32:47], v[64:67], a[96:99], v[32:47]
    ds_read_b64_tr_b16 v[80:81], v112 offset:36864
    ds_read_b64_tr_b16 v[82:83], v112 offset:37888
    s_add_u32 s98, s91, 4096
    buffer_load_dwordx4 a[20:23], v4, s[32:35], s98 offen offset:1024 sc1
    s_waitcnt lgkmcnt(6)
    v_mfma_f32_32x32x16_bf16 v[48:63], v[68:71], a[96:99], v[48:63]
    ds_read_b64_tr_b16 v[84:85], v113 offset:36864
    ds_read_b64_tr_b16 v[86:87], v113 offset:37888
    s_cmp_lg_u32 s44, 1
    s_cbranch_scc1 LW_132
    ds_write_b128 v118, a[160:163] offset:8192
    ds_write_b128 v118, a[164:167] offset:9216
    ds_write_b128 v118, a[168:171] offset:10240
    ds_write_b128 v118, a[172:175] offset:11264
LW_132:
    s_waitcnt lgkmcnt(6)
    v_mfma_f32_32x32x16_bf16 v[32:47], v[72:75], a[100:103], v[32:47]
    ds_read_b64_tr_b16 v[64:65], v112 offset:38912
    ds_read_b64_tr_b16 v[66:67], v112 offset:39936
    s_add_u32 s98, s91, 4096
    buffer_load_dwordx4 a[24:27], v4, s[32:35], s98 offen offset:2048 sc1
    s_waitcnt lgkmcnt(6)
    v_mfma_f32_32x32x16_bf16 v[48:63], v[76:79], a[100:103], v[48:63]
    ds_read_b64_tr_b16 v[68:69], v113 offset:38912
    ds_read_b64_tr_b16 v[70:71], v113 offset:39936
    s_cmp_lg_u32 s44, 2
    s_cbranch_scc1 LW_133
    ds_write_b128 v118, a[160:163] offset:8192
    ds_write_b128 v118, a[164:167] offset:9216
    ds_write_b128 v118, a[168:171] offset:10240
    ds_write_b128 v118, a[172:175] offset:11264
LW_133:
    s_waitcnt lgkmcnt(6)
    v_mfma_f32_32x32x16_bf16 v[32:47], v[80:83], a[104:107], v[32:47]
    ds_read_b64_tr_b16 v[72:73], v112 offset:40960
    ds_read_b64_tr_b16 v[74:75], v112 offset:41984
    s_add_u32 s98, s91, 4096
    buffer_load_dwordx4 a[28:31], v4, s[32:35], s98 offen offset:3072 sc1
    s_waitcnt lgkmcnt(6)
    v_mfma_f32_32x32x16_bf16 v[48:63], v[84:87], a[104:107], v[48:63]
    ds_read_b64_tr_b16 v[76:77], v113 offset:40960
    ds_read_b64_tr_b16 v[78:79], v113 offset:41984
    s_cmp_lg_u32 s44, 3
    s_cbranch_scc1 LW_134
    ds_write_b128 v118, a[160:163] offset:8192
    ds_write_b128 v118, a[164:167] offset:9216
    ds_write_b128 v118, a[168:171] offset:10240
    ds_write_b128 v118, a[172:175] offset:11264
LW_134:
    s_waitcnt lgkmcnt(6)
    v_mfma_f32_32x32x16_bf16 v[32:47], v[64:67], a[108:111], v[32:47]
    ds_read_b64_tr_b16 v[80:81], v112 offset:43008
    ds_read_b64_tr_b16 v[82:83], v112 offset:44032
    s_add_u32 s98, s91, 8192
    buffer_load_dwordx4 a[32:35], v4, s[32:35], s98 offen offset:0 sc1
    s_waitcnt lgkmcnt(6)
    v_mfma_f32_32x32x16_bf16 v[48:63], v[68:71], a[108:111], v[48:63]
    ds_read_b64_tr_b16 v[84:85], v113 offset:43008
    ds_read_b64_tr_b16 v[86:87], v113 offset:44032
    s_cmp_lg_u32 s44, 0
    s_cbranch_scc1 LW_135
    ds_write_b128 v118, a[176:179] offset:12288
    ds_write_b128 v118, a[180:183] offset:13312
    ds_write_b128 v118, a[184:187] offset:14336
    ds_write_b128 v118, a[188:191] offset:15360
LW_135:
    s_waitcnt lgkmcnt(6)
    v_mfma_f32_32x32x16_bf16 v[32:47], v[72:75], a[112:115], v[32:47]
    ds_read_b64_tr_b16 v[64:65], v112 offset:45056
    ds_read_b64_tr_b16 v[66:67], v112 offset:46080
    s_add_u32 s98, s91, 8192
    buffer_load_dwordx4 a[36:39], v4, s[32:35], s98 offen offset:1024 sc1
    s_waitcnt lgkmcnt(6)
    v_mfma_f32_32x32x16_bf16 v[48:63], v[76:79], a[112:115], v[48:63]
    ds_read_b64_tr_b16 v[68:69], v113 offset:45056
    ds_read_b64_tr_b16 v[70:71], v113 offset:46080
    s_cmp_lg_u32 s44, 1
    s_cbranch_scc1 LW_136
    ds_write_b128 v118, a[176:179] offset:12288
    ds_write_b128 v118, a[180:183] offset:13312
    ds_write_b128 v118, a[184:187] offset:14336
    ds_write_b128 v118, a[188:191] offset:15360
LW_136:
    s_waitcnt vmcnt(12) lgkmcnt(6)
    v_mfma_f32_32x32x16_bf16 v[32:47], v[80:83], a[116:119], v[32:47]
    ds_read_b64_tr_b16 v[72:73], v112 offset:47104
    ds_read_b64_tr_b16 v[74:75], v112 offset:48128
    s_add_u32 s98, s91, 8192
    buffer_load_dwordx4 a[40:43], v4, s[32:35], s98 offen offset:2048 sc1
    s_waitcnt lgkmcnt(6)
    v_mfma_f32_32x32x16_bf16 v[48:63], v[84:87], a[116:119], v[48:63]
    ds_read_b64_tr_b16 v[76:77], v113 offset:47104
    ds_read_b64_tr_b16 v[78:79], v113 offset:48128
    s_cmp_lg_u32 s44, 2
    s_cbranch_scc1 LW_137
    ds_write_b128 v118, a[176:179] offset:12288
    ds_write_b128 v118, a[180:183] offset:13312
    ds_write_b128 v118, a[184:187] offset:14336
    ds_write_b128 v118, a[188:191] offset:15360
LW_137:
    s_waitcnt vmcnt(12) lgkmcnt(6)
    v_mfma_f32_32x32x16_bf16 v[32:47], v[64:67], a[120:123], v[32:47]
    ds_read_b64_tr_b16 v[80:81], v114 offset:0
    ds_read_b64_tr_b16 v[82:83], v114 offset:1024
    s_add_u32 s98, s91, 8192
    buffer_load_dwordx4 a[44:47], v4, s[32:35], s98 offen offset:3072 sc1
    s_waitcnt lgkmcnt(6)
    v_mfma_f32_32x32x16_bf16 v[48:63], v[68:71], a[120:123], v[48:63]
    ds_read_b64_tr_b16 v[84:85], v115 offset:0
    ds_read_b64_tr_b16 v[86:87], v115 offset:1024
    s_cmp_lg_u32 s44, 3
    s_cbranch_scc1 LW_138
    ds_write_b128 v118, a[176:179] offset:12288
    ds_write_b128 v118, a[180:183] offset:13312
    ds_write_b128 v118, a[184:187] offset:14336
    ds_write_b128 v118, a[188:191] offset:15360
LW_138:
    s_waitcnt vmcnt(12) lgkmcnt(6)
    v_mfma_f32_32x32x16_bf16 v[32:47], v[72:75], a[124:127], v[32:47]
    ds_read_b64_tr_b16 v[64:65], v114 offset:2048
    ds_read_b64_tr_b16 v[66:67], v114 offset:3072
    s_add_u32 s98, s91, 12288
    buffer_load_dwordx4 a[48:51], v4, s[32:35], s98 offen offset:0 sc1
    s_waitcnt lgkmcnt(6)
    v_mfma_f32_32x32x16_bf16 v[48:63], v[76:79], a[124:127], v[48:63]
    ds_read_b64_tr_b16 v[68:69], v115 offset:2048
    ds_read_b64_tr_b16 v[70:71], v115 offset:3072
    s_waitcnt vmcnt(12) lgkmcnt(6)
    v_mfma_f32_32x32x16_bf16 v[32:47], v[80:83], a[0:3], v[32:47]
    ds_read_b64_tr_b16 v[72:73], v114 offset:4096
    ds_read_b64_tr_b16 v[74:75], v114 offset:5120
    s_add_u32 s98, s91, 12288
    buffer_load_dwordx4 a[52:55], v4, s[32:35], s98 offen offset:1024 sc1
    s_waitcnt lgkmcnt(6)
    v_mfma_f32_32x32x16_bf16 v[48:63], v[84:87], a[0:3], v[48:63]
    ds_read_b64_tr_b16 v[76:77], v115 offset:4096
    ds_read_b64_tr_b16 v[78:79], v115 offset:5120
    s_waitcnt vmcnt(12) lgkmcnt(6)
    v_mfma_f32_32x32x16_bf16 v[32:47], v[64:67], a[4:7], v[32:47]
    ds_read_b64_tr_b16 v[80:81], v114 offset:6144
    ds_read_b64_tr_b16 v[82:83], v114 offset:7168
    s_add_u32 s98, s91, 12288
    buffer_load_dwordx4 a[56:59], v4, s[32:35], s98 offen offset:2048 sc1
    s_waitcnt lgkmcnt(6)
    v_mfma_f32_32x32x16_bf16 v[48:63], v[68:71], a[4:7], v[48:63]
    ds_read_b64_tr_b16 v[84:85], v115 offset:6144
    ds_read_b64_tr_b16 v[86:87], v115 offset:7168
    s_waitcnt vmcnt(12) lgkmcnt(6)
    v_mfma_f32_32x32x16_bf16 v[32:47], v[72:75], a[8:11], v[32:47]
    ds_read_b64_tr_b16 v[64:65], v114 offset:8192
    ds_read_b64_tr_b16 v[66:67], v114 offset:9216
    s_add_u32 s98, s91, 12288
    buffer_load_dwordx4 a[60:63], v4, s[32:35], s98 offen offset:3072 sc1
    s_waitcnt lgkmcnt(6)
    v_mfma_f32_32x32x16_bf16 v[48:63], v[76:79], a[8:11], v[48:63]
    ds_read_b64_tr_b16 v[68:69], v115 offset:8192
    ds_read_b64_tr_b16 v[70:71], v115 offset:9216
    s_waitcnt vmcnt(12) lgkmcnt(6)
    v_mfma_f32_32x32x16_bf16 v[32:47], v[80:83], a[12:15], v[32:47]
    ds_read_b64_tr_b16 v[72:73], v114 offset:10240
    ds_read_b64_tr_b16 v[74:75], v114 offset:11264
    s_add_u32 s98, s91, 16384
    buffer_load_dwordx4 a[64:67], v4, s[32:35], s98 offen offset:0 sc1
    s_waitcnt lgkmcnt(6)
    v_mfma_f32_32x32x16_bf16 v[48:63], v[84:87], a[12:15], v[48:63]
    ds_read_b64_tr_b16 v[76:77], v115 offset:10240
    ds_read_b64_tr_b16 v[78:79], v115 offset:11264
    s_waitcnt vmcnt(12) lgkmcnt(6)
    v_mfma_f32_32x32x16_bf16 v[32:47], v[64:67], a[16:19], v[32:47]
    ds_read_b64_tr_b16 v[80:81], v114 offset:12288
    ds_read_b64_tr_b16 v[82:83], v114 offset:13312
    s_add_u32 s98, s91, 16384
    buffer_load_dwordx4 a[68:71], v4, s[32:35], s98 offen offset:1024 sc1
    s_waitcnt lgkmcnt(6)
    v_mfma_f32_32x32x16_bf16 v[48:63], v[68:71], a[16:19], v[48:63]
    ds_read_b64_tr_b16 v[84:85], v115 offset:12288
    ds_read_b64_tr_b16 v[86:87], v115 offset:13312
    s_waitcnt vmcnt(12) lgkmcnt(6)
    v_mfma_f32_32x32x16_bf16 v[32:47], v[72:75], a[20:23], v[32:47]
    ds_read_b64_tr_b16 v[64:65], v114 offset:14336
    ds_read_b64_tr_b16 v[66:67], v114 offset:15360
    s_add_u32 s98, s91, 16384
    buffer_load_dwordx4 a[72:75], v4, s[32:35], s98 offen offset:2048 sc1
    s_waitcnt lgkmcnt(6)
    v_mfma_f32_32x32x16_bf16 v[48:63], v[76:79], a[20:23], v[48:63]
    ds_read_b64_tr_b16 v[68:69], v115 offset:14336
    ds_read_b64_tr_b16 v[70:71], v115 offset:15360
    s_waitcnt lgkmcnt(0)
    s_barrier
    s_waitcnt vmcnt(12)
    v_mfma_f32_32x32x16_bf16 v[32:47], v[80:83], a[24:27], v[32:47]
    ds_read_b64_tr_b16 v[72:73], v114 offset:32768
    ds_read_b64_tr_b16 v[74:75], v114 offset:33792
    s_add_u32 s98, s91, 16384
    buffer_load_dwordx4 a[76:79], v4, s[32:35], s98 offen offset:3072 sc1
    v_mfma_f32_32x32x16_bf16 v[48:63], v[84:87], a[24:27], v[48:63]
    ds_read_b64_tr_b16 v[76:77], v115 offset:32768
    ds_read_b64_tr_b16 v[78:79], v115 offset:33792
    s_waitcnt vmcnt(12)
    v_mfma_f32_32x32x16_bf16 v[32:47], v[64:67], a[28:31], v[32:47]
    ds_read_b64_tr_b16 v[80:81], v114 offset:34816
    ds_read_b64_tr_b16 v[82:83], v114 offset:35840
    s_add_u32 s98, s91, 20480
    buffer_load_dwordx4 a[80:83], v4, s[32:35], s98 offen offset:0 sc1
    v_mfma_f32_32x32x16_bf16 v[48:63], v[68:71], a[28:31], v[48:63]
    ds_read_b64_tr_b16 v[84:85], v115 offset:34816
    ds_read_b64_tr_b16 v[86:87], v115 offset:35840
    s_waitcnt vmcnt(12) lgkmcnt(6)
    v_mfma_f32_32x32x16_bf16 v[32:47], v[72:75], a[32:35], v[32:47]
    ds_read_b64_tr_b16 v[64:65], v114 offset:36864
    ds_read_b64_tr_b16 v[66:67], v114 offset:37888
    s_add_u32 s98, s91, 20480
    buffer_load_dwordx4 a[84:87], v4, s[32:35], s98 offen offset:1024 sc1
    s_waitcnt lgkmcnt(6)
    v_mfma_f32_32x32x16_bf16 v[48:63], v[76:79], a[32:35], v[48:63]
    ds_read_b64_tr_b16 v[68:69], v115 offset:36864
    ds_read_b64_tr_b16 v[70:71], v115 offset:37888
    v_accvgpr_read_b32 v193, a240
    v_lshlrev_b32 v192, 16, v193
    s_waitcnt vmcnt(12) lgkmcnt(6)
    v_mfma_f32_32x32x16_bf16 v[32:47], v[80:83], a[36:39], v[32:47]
    ds_read_b64_tr_b16 v[72:73], v114 offset:38912
    ds_read_b64_tr_b16 v[74:75], v114 offset:39936
    s_add_u32 s98, s91, 20480
    buffer_load_dwordx4 a[88:91], v4, s[32:35], s98 offen offset:2048 sc1
    s_waitcnt lgkmcnt(6)
    v_mfma_f32_32x32x16_bf16 v[48:63], v[84:87], a[36:39], v[48:63]
    ds_read_b64_tr_b16 v[76:77], v115 offset:38912
    ds_read_b64_tr_b16 v[78:79], v115 offset:39936
    v_and_b32 v193, 0xffff0000, v193
    v_accvgpr_read_b32 v195, a241
    s_mul_i32 s61, s46, 98304
    s_add_u32 s61, s61, s62
    s_add_u32 s61, s61, 14680064
    s_waitcnt vmcnt(12) lgkmcnt(6)
    v_mfma_f32_32x32x16_bf16 v[32:47], v[64:67], a[40:43], v[32:47]
    ds_read_b64_tr_b16 v[80:81], v114 offset:40960
    ds_read_b64_tr_b16 v[82:83], v114 offset:41984
    s_add_u32 s98, s91, 20480
    buffer_load_dwordx4 a[92:95], v4, s[32:35], s98 offen offset:3072 sc1
    s_waitcnt lgkmcnt(6)
    v_mfma_f32_32x32x16_bf16 v[48:63], v[68:71], a[40:43], v[48:63]
    ds_read_b64_tr_b16 v[84:85], v115 offset:40960
    ds_read_b64_tr_b16 v[86:87], v115 offset:41984
    v_lshlrev_b32 v194, 16, v195
    v_and_b32 v195, 0xffff0000, v195
    s_waitcnt vmcnt(12) lgkmcnt(6)
    v_mfma_f32_32x32x16_bf16 v[32:47], v[72:75], a[44:47], v[32:47]
    ds_read_b64_tr_b16 v[64:65], v114 offset:43008
    ds_read_b64_tr_b16 v[66:67], v114 offset:44032
    s_waitcnt lgkmcnt(6)
    v_mfma_f32_32x32x16_bf16 v[48:63], v[76:79], a[44:47], v[48:63]
    ds_read_b64_tr_b16 v[68:69], v115 offset:43008
    ds_read_b64_tr_b16 v[70:71], v115 offset:44032
    v_accvgpr_read_b32 v197, a242
    v_lshlrev_b32 v196, 16, v197
    s_waitcnt vmcnt(11) lgkmcnt(6)
    v_mfma_f32_32x32x16_bf16 v[32:47], v[80:83], a[48:51], v[32:47]
    ds_read_b64_tr_b16 v[72:73], v114 offset:45056
    ds_read_b64_tr_b16 v[74:75], v114 offset:46080
    s_add_u32 s99, s61, 0
    s_add_u32 m0, s62, 0
    s_nop 0
    buffer_load_dwordx4 v4, s[32:35], s99 offen offset:0 lds
    s_waitcnt lgkmcnt(6)
    v_mfma_f32_32x32x16_bf16 v[48:63], v[84:87], a[48:51], v[48:63]
    ds_read_b64_tr_b16 v[76:77], v115 offset:45056
    ds_read_b64_tr_b16 v[78:79], v115 offset:46080
    v_and_b32 v197, 0xffff0000, v197
    v_accvgpr_read_b32 v199, a243
    s_waitcnt vmcnt(11) lgkmcnt(6)
    v_mfma_f32_32x32x16_bf16 v[32:47], v[64:67], a[52:55], v[32:47]
    ds_read_b64_tr_b16 v[80:81], v114 offset:47104
    ds_read_b64_tr_b16 v[82:83], v114 offset:48128
    s_waitcnt lgkmcnt(6)
    v_mfma_f32_32x32x16_bf16 v[48:63], v[68:71], a[52:55], v[48:63]
    ds_read_b64_tr_b16 v[84:85], v115 offset:47104
    ds_read_b64_tr_b16 v[86:87], v115 offset:48128
    v_lshlrev_b32 v198, 16, v199
    v_and_b32 v199, 0xffff0000, v199
    s_waitcnt vmcnt(10) lgkmcnt(6)
    v_mfma_f32_32x32x16_bf16 v[32:47], v[72:75], a[56:59], v[32:47]
    ds_read_b64_tr_b16 v[64:65], v116 offset:0
    ds_read_b64_tr_b16 v[66:67], v116 offset:1024
    buffer_load_dwordx4 v4, s[32:35], s99 offen offset:1024 lds
    s_waitcnt lgkmcnt(6)
    v_mfma_f32_32x32x16_bf16 v[48:63], v[76:79], a[56:59], v[48:63]
    ds_read_b64_tr_b16 v[68:69], v117 offset:0
    ds_read_b64_tr_b16 v[70:71], v117 offset:1024
    v_accvgpr_read_b32 v201, a244
    v_lshlrev_b32 v200, 16, v201
    s_waitcnt vmcnt(10) lgkmcnt(6)
    v_mfma_f32_32x32x16_bf16 v[32:47], v[80:83], a[60:63], v[32:47]
    ds_read_b64_tr_b16 v[72:73], v116 offset:2048
    ds_read_b64_tr_b16 v[74:75], v116 offset:3072
    s_waitcnt lgkmcnt(6)
    v_mfma_f32_32x32x16_bf16 v[48:63], v[84:87], a[60:63], v[48:63]
    ds_read_b64_tr_b16 v[76:77], v117 offset:2048
    ds_read_b64_tr_b16 v[78:79], v117 offset:3072
    v_and_b32 v201, 0xffff0000, v201
    v_accvgpr_read_b32 v203, a245
    s_waitcnt vmcnt(9) lgkmcnt(6)
    v_mfma_f32_32x32x16_bf16 v[32:47], v[64:67], a[64:67], v[32:47]
    ds_read_b64_tr_b16 v[80:81], v116 offset:4096
    ds_read_b64_tr_b16 v[82:83], v116 offset:5120
    buffer_load_dwordx4 v4, s[32:35], s99 offen offset:2048 lds
    s_waitcnt lgkmcnt(6)
    v_mfma_f32_32x32x16_bf16 v[48:63], v[68:71], a[64:67], v[48:63]
    ds_read_b64_tr_b16 v[84:85], v117 offset:4096
    ds_read_b64_tr_b16 v[86:87], v117 offset:5120
    v_lshlrev_b32 v202, 16, v203
    v_and_b32 v203, 0xffff0000, v203
    s_waitcnt vmcnt(9) lgkmcnt(6)
    v_mfma_f32_32x32x16_bf16 v[32:47], v[72:75], a[68:71], v[32:47]
    ds_read_b64_tr_b16 v[64:65], v116 offset:6144
    ds_read_b64_tr_b16 v[66:67], v116 offset:7168
    s_waitcnt lgkmcnt(6)
    v_mfma_f32_32x32x16_bf16 v[48:63], v[76:79], a[68:71], v[48:63]
    ds_read_b64_tr_b16 v[68:69], v117 offset:6144
    ds_read_b64_tr_b16 v[70:71], v117 offset:7168
    v_accvgpr_read_b32 v205, a246
    v_lshlrev_b32 v204, 16, v205
    s_waitcnt vmcnt(8) lgkmcnt(6)
    v_mfma_f32_32x32x16_bf16 v[32:47], v[80:83], a[72:75], v[32:47]
    ds_read_b64_tr_b16 v[72:73], v116 offset:8192
    ds_read_b64_tr_b16 v[74:75], v116 offset:9216
    buffer_load_dwordx4 v4, s[32:35], s99 offen offset:3072 lds
    s_waitcnt lgkmcnt(6)
    v_mfma_f32_32x32x16_bf16 v[48:63], v[84:87], a[72:75], v[48:63]
    ds_read_b64_tr_b16 v[76:77], v117 offset:8192
    ds_read_b64_tr_b16 v[78:79], v117 offset:9216
    v_and_b32 v205, 0xffff0000, v205
    v_accvgpr_read_b32 v207, a247
    s_waitcnt vmcnt(8) lgkmcnt(6)
    v_mfma_f32_32x32x16_bf16 v[32:47], v[64:67], a[76:79], v[32:47]
    ds_read_b64_tr_b16 v[80:81], v116 offset:10240
    ds_read_b64_tr_b16 v[82:83], v116 offset:11264
    s_waitcnt lgkmcnt(6)
    v_mfma_f32_32x32x16_bf16 v[48:63], v[68:71], a[76:79], v[48:63]
    ds_read_b64_tr_b16 v[84:85], v117 offset:10240
    ds_read_b64_tr_b16 v[86:87], v117 offset:11264
    v_lshlrev_b32 v206, 16, v207
    v_and_b32 v207, 0xffff0000, v207
    s_waitcnt vmcnt(7) lgkmcnt(6)
    v_mfma_f32_32x32x16_bf16 v[32:47], v[72:75], a[80:83], v[32:47]
    ds_read_b64_tr_b16 v[64:65], v116 offset:12288
    ds_read_b64_tr_b16 v[66:67], v116 offset:13312
    s_add_u32 s99, s61, 4096
    s_add_u32 m0, s62, 4096
    s_nop 0
    buffer_load_dwordx4 v4, s[32:35], s99 offen offset:0 lds
    s_waitcnt lgkmcnt(6)
    v_mfma_f32_32x32x16_bf16 v[48:63], v[76:79], a[80:83], v[48:63]
    ds_read_b64_tr_b16 v[68:69], v117 offset:12288
    ds_read_b64_tr_b16 v[70:71], v117 offset:13312
    s_waitcnt vmcnt(7) lgkmcnt(6)
    v_mfma_f32_32x32x16_bf16 v[32:47], v[80:83], a[84:87], v[32:47]
    ds_read_b64_tr_b16 v[72:73], v116 offset:14336
    ds_read_b64_tr_b16 v[74:75], v116 offset:15360
    s_waitcnt lgkmcnt(6)
    v_mfma_f32_32x32x16_bf16 v[48:63], v[84:87], a[84:87], v[48:63]
    ds_read_b64_tr_b16 v[76:77], v117 offset:14336
    ds_read_b64_tr_b16 v[78:79], v117 offset:15360
    s_waitcnt vmcnt(6) lgkmcnt(6)
    v_mfma_f32_32x32x16_bf16 v[32:47], v[64:67], a[88:91], v[32:47]
    buffer_load_dwordx4 v4, s[32:35], s99 offen offset:1024 lds
    s_waitcnt lgkmcnt(4)
    v_mfma_f32_32x32x16_bf16 v[48:63], v[68:71], a[88:91], v[48:63]
    s_waitcnt vmcnt(6) lgkmcnt(2)
    v_mfma_f32_32x32x16_bf16 v[32:47], v[72:75], a[92:95], v[32:47]
    s_waitcnt lgkmcnt(0)
    v_mfma_f32_32x32x16_bf16 v[48:63], v[76:79], a[92:95], v[48:63]
    s_lshl_b32 s84, s44, 12
    s_xor_b32 s85, s84, 4096
    v_add_u32 v26, s84, v4
    v_add_u32 v27, s85, v4
    v_add_u32 v26, 65536, v26
    v_add_u32 v27, 65536, v27
    s_nop 5
    ds_write_b128 v26, v[48:51] offset:0
    buffer_load_dwordx4 v4, s[32:35], s99 offen offset:2048 lds
    ds_write_b128 v26, v[52:55] offset:1024
    buffer_load_dwordx4 v4, s[32:35], s99 offen offset:3072 lds
    ds_write_b128 v26, v[56:59] offset:2048
    ds_write_b128 v26, v[60:63] offset:3072
    s_waitcnt lgkmcnt(0)
    s_barrier
    ds_read_b128 v[128:131], v27 offset:0
    ds_read_b128 v[132:135], v27 offset:1024
    ds_read_b128 v[136:139], v27 offset:2048
    ds_read_b128 v[140:143], v27 offset:3072
    s_waitcnt lgkmcnt(3)
    v_pk_add_f32 v[32:33], v[32:33], v[128:129]
    v_pk_add_f32 v[34:35], v[34:35], v[130:131]
    s_waitcnt lgkmcnt(2)
    v_pk_add_f32 v[36:37], v[36:37], v[132:133]
    v_pk_add_f32 v[38:39], v[38:39], v[134:135]
    s_waitcnt lgkmcnt(1)
    v_pk_add_f32 v[40:41], v[40:41], v[136:137]
    v_pk_add_f32 v[42:43], v[42:43], v[138:139]
    s_waitcnt lgkmcnt(0)
    v_pk_add_f32 v[44:45], v[44:45], v[140:141]
    v_pk_add_f32 v[46:47], v[46:47], v[142:143]
    v_pk_add_f32 v[32:33], v[32:33], v[192:193]
    v_pk_add_f32 v[34:35], v[34:35], v[194:195]
    v_pk_add_f32 v[36:37], v[36:37], v[196:197]
    v_pk_add_f32 v[38:39], v[38:39], v[198:199]
    v_pk_add_f32 v[40:41], v[40:41], v[200:201]
    v_pk_add_f32 v[42:43], v[42:43], v[202:203]
    v_pk_add_f32 v[44:45], v[44:45], v[204:205]
    v_pk_add_f32 v[46:47], v[46:47], v[206:207]
    v_cvt_pk_bf16_f32 v160, v32, v33
    v_cvt_pk_bf16_f32 v161, v34, v35
    v_cvt_pk_bf16_f32 v162, v36, v37
    v_cvt_pk_bf16_f32 v163, v38, v39
    v_cvt_pk_bf16_f32 v164, v40, v41
    v_cvt_pk_bf16_f32 v165, v42, v43
    v_cvt_pk_bf16_f32 v166, v44, v45
    v_cvt_pk_bf16_f32 v167, v46, v47
    s_lshl_b32 s76, s72, 15
    s_lshl_b32 s77, s73, 11
    s_add_u32 s76, s76, s77
    s_add_u32 s76, s76, 12582912
    buffer_store_dwordx4 v[160:163], v4, s[32:35], s76 offen sc1
    buffer_store_dwordx4 v[164:167], v4, s[32:35], s76 offen offset:1024 sc1
    v_mov_b32 v168, 0
    v_mov_b32 v169, 0
    v_mov_b32 v172, 0
    v_mov_b32 v173, 0
    v_mov_b32 v170, 0x3f803f80
    v_dot2c_f32_bf16 v168, v160, v170
    v_dot2c_f32_bf16 v169, v160, v160
    v_dot2c_f32_bf16 v172, v161, v170
    v_dot2c_f32_bf16 v173, v161, v161
    v_dot2c_f32_bf16 v168, v162, v170
    v_dot2c_f32_bf16 v169, v162, v162
    v_dot2c_f32_bf16 v172, v163, v170
    v_dot2c_f32_bf16 v173, v163, v163
    v_dot2c_f32_bf16 v168, v164, v170
    v_dot2c_f32_bf16 v169, v164, v164
    v_dot2c_f32_bf16 v172, v165, v170
    v_dot2c_f32_bf16 v173, v165, v165
    v_dot2c_f32_bf16 v168, v166, v170
    v_dot2c_f32_bf16 v169, v166, v166
    v_dot2c_f32_bf16 v172, v167, v170
    v_dot2c_f32_bf16 v173, v167, v167
    s_nop 1
    v_add_f32 v168, v168, v172
    v_add_f32 v169, v169, v173
    v_mov_b32 v171, v168
    v_mov_b32 v172, v169
    v_nop
    v_permlane32_swap_b32 v168, v171
    v_permlane32_swap_b32 v169, v172
    v_add_f32 v168, v168, v171
    v_add_f32 v169, v169, v172
    s_lshl_b32 s76, s72, 12
    s_lshl_b32 s77, s73, 8
    s_add_u32 s76, s76, s77
    s_add_u32 s76, s76, 3407872
    v_lshlrev_b32 v171, 3, v2
    s_mov_b64 s[58:59], exec
    s_mov_b32 exec_hi, 0
    buffer_store_dwordx2 v[168:169], v171, s[32:35], s76 offen sc1
    s_mov_b64 exec, s[58:59]
    v_accvgpr_write_b32 a240, v160
    v_accvgpr_write_b32 a241, v161
    v_accvgpr_write_b32 a242, v162
    v_accvgpr_write_b32 a243, v163
    v_accvgpr_write_b32 a244, v164
    v_accvgpr_write_b32 a245, v165
    v_accvgpr_write_b32 a246, v166
    v_accvgpr_write_b32 a247, v167
    s_add_u32 s99, s61, 32768
    s_add_u32 m0, s62, 32768
    s_nop 0
    buffer_load_dwordx4 v4, s[32:35], s99 offen offset:0 lds
    buffer_load_dwordx4 v4, s[32:35], s99 offen offset:1024 lds
    buffer_load_dwordx4 v4, s[32:35], s99 offen offset:2048 lds
    buffer_load_dwordx4 v4, s[32:35], s99 offen offset:3072 lds
    s_add_u32 s99, s61, 36864
    s_add_u32 m0, s62, 36864
    s_nop 0
    buffer_load_dwordx4 v4, s[32:35], s99 offen offset:0 lds
    buffer_load_dwordx4 v4, s[32:35], s99 offen offset:1024 lds
    buffer_load_dwordx4 v4, s[32:35], s99 offen offset:2048 lds
    buffer_load_dwordx4 v4, s[32:35], s99 offen offset:3072 lds
    s_waitcnt vmcnt(8)
    v_accvgpr_read_b32 v25, a234
    s_mov_b64 s[58:59], exec
    s_mov_b32 exec_lo, 65535
    s_mov_b32 exec_hi, 0
    v_mov_b32 v24, 1
    buffer_atomic_add v24, v25, s[32:35], 0 offen offset:84 sc1
    s_mov_b64 exec, s[58:59]
    s_waitcnt lgkmcnt(0)
    s_barrier
    s_add_u32 s99, s61, 65536
    s_add_u32 m0, s62, 65536
    s_nop 0
    buffer_load_dwordx4 v4, s[32:35], s99 offen offset:0 lds
    buffer_load_dwordx4 v4, s[32:35], s99 offen offset:1024 lds
    buffer_load_dwordx4 v4, s[32:35], s99 offen offset:2048 lds
    buffer_load_dwordx4 v4, s[32:35], s99 offen offset:3072 lds
    s_add_u32 s99, s61, 69632
    s_add_u32 m0, s62, 69632
    s_nop 0
    buffer_load_dwordx4 v4, s[32:35], s99 offen offset:0 lds
    buffer_load_dwordx4 v4, s[32:35], s99 offen offset:1024 lds
    buffer_load_dwordx4 v4, s[32:35], s99 offen offset:2048 lds
    buffer_load_dwordx4 v4, s[32:35], s99 offen offset:3072 lds
    s_add_u32 s3, s70, 84
    s_buffer_load_dword s4, s[32:35], s3 glc
    s_waitcnt lgkmcnt(0)
    s_cmp_ge_u32 s4, 16
    s_cbranch_scc1 PD_140
    s_mov_b32 s60, 0
PL_139:
    s_buffer_load_dword s4, s[32:35], s3 glc
    s_add_u32 s60, s60, 1
    s_cmp_gt_u32 s60, 0x80000
    s_cbranch_scc1 L_bail
    s_waitcnt lgkmcnt(0)
    s_cmp_lt_u32 s4, 16
    s_cbranch_scc1 PL_139
PD_140:
    s_lshl_b32 s76, s71, 15
    s_add_u32 s76, s76, 12582912
    s_add_u32 s98, s76, 0
    buffer_load_dwordx4 v[128:131], v4, s[32:35], s98 offen offset:0 sc1
    s_add_u32 s98, s76, 0
    buffer_load_dwordx4 v[132:135], v4, s[32:35], s98 offen offset:1024 sc1
    s_add_u32 s98, s76, 0
    buffer_load_dwordx4 v[136:139], v4, s[32:35], s98 offen offset:2048 sc1
    s_add_u32 s98, s76, 0
    buffer_load_dwordx4 v[140:143], v4, s[32:35], s98 offen offset:3072 sc1
    s_add_u32 s98, s76, 4096
    buffer_load_dwordx4 v[144:147], v4, s[32:35], s98 offen offset:0 sc1
    s_add_u32 s98, s76, 4096
    buffer_load_dwordx4 v[148:151], v4, s[32:35], s98 offen offset:1024 sc1
    s_lshl_b32 s75, s71, 12
    s_add_u32 s75, s75, 3407872
    v_lshlrev_b32 v26, 3, v2
    v_lshl_add_u32 v26, v3, 11, v26
    buffer_load_dwordx2 v[112:113], v26, s[32:35], s75 offen offset:0 sc1
    buffer_load_dwordx2 v[114:115], v26, s[32:35], s75 offen offset:256 sc1
    buffer_load_dwordx2 v[116:117], v26, s[32:35], s75 offen offset:512 sc1
    buffer_load_dwordx2 v[118:119], v26, s[32:35], s75 offen offset:768 sc1
    buffer_load_dwordx2 v[120:121], v26, s[32:35], s75 offen offset:1024 sc1
    buffer_load_dwordx2 v[122:123], v26, s[32:35], s75 offen offset:1280 sc1
    buffer_load_dwordx2 v[124:125], v26, s[32:35], s75 offen offset:1536 sc1
    buffer_load_dwordx2 v[126:127], v26, s[32:35], s75 offen offset:1792 sc1
    s_add_u32 s98, s76, 4096
    buffer_load_dwordx4 v[152:155], v4, s[32:35], s98 offen offset:2048 sc1
    s_add_u32 s98, s76, 4096
    buffer_load_dwordx4 v[156:159], v4, s[32:35], s98 offen offset:3072 sc1
    s_add_u32 s98, s76, 8192
    buffer_load_dwordx4 v[160:163], v4, s[32:35], s98 offen offset:0 sc1
    s_add_u32 s98, s76, 8192
    buffer_load_dwordx4 v[164:167], v4, s[32:35], s98 offen offset:1024 sc1
    s_add_u32 s98, s76, 8192
    buffer_load_dwordx4 v[168:171], v4, s[32:35], s98 offen offset:2048 sc1
    s_add_u32 s98, s76, 8192
    buffer_load_dwordx4 v[172:175], v4, s[32:35], s98 offen offset:3072 sc1
    s_waitcnt vmcnt(29)
    s_barrier
    ds_read_b64_tr_b16 v[96:97], v12 offset:0
    ds_read_b64_tr_b16 v[98:99], v12 offset:512
    ds_read_b64_tr_b16 v[100:101], v12 offset:32768
    ds_read_b64_tr_b16 v[102:103], v12 offset:33280
    s_waitcnt vmcnt(19) lgkmcnt(2)
    v_mfma_f32_32x32x16_bf16 v[32:47], v[96:99], v[128:131], 0
    ds_read_b64_tr_b16 v[104:105], v12 offset:1024
    ds_read_b64_tr_b16 v[106:107], v12 offset:1536
    s_add_u32 s98, s76, 12288
    buffer_load_dwordx4 v[176:179], v4, s[32:35], s98 offen offset:0 sc1
    s_waitcnt lgkmcnt(2)
    v_mfma_f32_32x32x16_bf16 v[48:63], v[100:103], v[128:131], 0
    ds_read_b64_tr_b16 v[108:109], v12 offset:33792
    ds_read_b64_tr_b16 v[110:111], v12 offset:34304
    s_waitcnt vmcnt(19) lgkmcnt(2)
    v_mfma_f32_32x32x16_bf16 v[32:47], v[104:107], v[132:135], v[32:47]
    ds_read_b64_tr_b16 v[96:97], v12 offset:2048
    ds_read_b64_tr_b16 v[98:99], v12 offset:2560
    s_add_u32 s98, s76, 12288
    buffer_load_dwordx4 v[180:183], v4, s[32:35], s98 offen offset:1024 sc1
    s_waitcnt lgkmcnt(2)
    v_mfma_f32_32x32x16_bf16 v[48:63], v[108:111], v[132:135], v[48:63]
    ds_read_b64_tr_b16 v[100:101], v12 offset:34816
    ds_read_b64_tr_b16 v[102:103], v12 offset:35328
    s_waitcnt vmcnt(19) lgkmcnt(2)
    v_mfma_f32_32x32x16_bf16 v[32:47], v[96:99], v[136:139], v[32:47]
    ds_read_b64_tr_b16 v[104:105], v12 offset:3072
    ds_read_b64_tr_b16 v[106:107], v12 offset:3584
    s_add_u32 s98, s76, 12288
    buffer_load_dwordx4 v[184:187], v4, s[32:35], s98 offen offset:2048 sc1
    s_waitcnt lgkmcnt(2)
    v_mfma_f32_32x32x16_bf16 v[48:63], v[100:103], v[136:139], v[48:63]
    ds_read_b64_tr_b16 v[108:109], v12 offset:35840
    ds_read_b64_tr_b16 v[110:111], v12 offset:36352
    s_waitcnt vmcnt(19) lgkmcnt(2)
    v_mfma_f32_32x32x16_bf16 v[32:47], v[104:107], v[140:143], v[32:47]
    ds_read_b64_tr_b16 v[96:97], v12 offset:4096
    ds_read_b64_tr_b16 v[98:99], v12 offset:4608
    s_add_u32 s98, s76, 12288
    buffer_load_dwordx4 v[188:191], v4, s[32:35], s98 offen offset:3072 sc1
    s_waitcnt lgkmcnt(2)
    v_mfma_f32_32x32x16_bf16 v[48:63], v[108:111], v[140:143], v[48:63]
    ds_read_b64_tr_b16 v[100:101], v12 offset:36864
    ds_read_b64_tr_b16 v[102:103], v12 offset:37376
    s_waitcnt vmcnt(19) lgkmcnt(2)
    v_mfma_f32_32x32x16_bf16 v[32:47], v[96:99], v[144:147], v[32:47]
    ds_read_b64_tr_b16 v[104:105], v12 offset:5120
    ds_read_b64_tr_b16 v[106:107], v12 offset:5632
    s_add_u32 s98, s76, 16384
    buffer_load_dwordx4 v[192:195], v4, s[32:35], s98 offen offset:0 sc1
    s_waitcnt lgkmcnt(2)
    v_mfma_f32_32x32x16_bf16 v[48:63], v[100:103], v[144:147], v[48:63]
    ds_read_b64_tr_b16 v[108:109], v12 offset:37888
    ds_read_b64_tr_b16 v[110:111], v12 offset:38400
    s_waitcnt vmcnt(19) lgkmcnt(2)
    v_mfma_f32_32x32x16_bf16 v[32:47], v[104:107], v[148:151], v[32:47]
    ds_read_b64_tr_b16 v[96:97], v12 offset:6144
    ds_read_b64_tr_b16 v[98:99], v12 offset:6656
    s_add_u32 s98, s76, 16384
    buffer_load_dwordx4 v[196:199], v4, s[32:35], s98 offen offset:1024 sc1
    s_waitcnt lgkmcnt(2)
    v_mfma_f32_32x32x16_bf16 v[48:63], v[108:111], v[148:151], v[48:63]
    ds_read_b64_tr_b16 v[100:101], v12 offset:38912
    ds_read_b64_tr_b16 v[102:103], v12 offset:39424
    s_waitcnt vmcnt(11) lgkmcnt(2)
    v_mfma_f32_32x32x16_bf16 v[32:47], v[96:99], v[152:155], v[32:47]
    ds_read_b64_tr_b16 v[104:105], v12 offset:7168
    ds_read_b64_tr_b16 v[106:107], v12 offset:7680
    s_add_u32 s98, s76, 16384
    buffer_load_dwordx4 v[200:203], v4, s[32:35], s98 offen offset:2048 sc1
    s_waitcnt lgkmcnt(2)
    v_mfma_f32_32x32x16_bf16 v[48:63], v[100:103], v[152:155], v[48:63]
    ds_read_b64_tr_b16 v[108:109], v12 offset:39936
    ds_read_b64_tr_b16 v[110:111], v12 offset:40448
    s_waitcnt vmcnt(11) lgkmcnt(2)
    v_mfma_f32_32x32x16_bf16 v[32:47], v[104:107], v[156:159], v[32:47]
    ds_read_b64_tr_b16 v[96:97], v12 offset:8192
    ds_read_b64_tr_b16 v[98:99], v12 offset:8704
    s_add_u32 s98, s76, 16384
    buffer_load_dwordx4 v[204:207], v4, s[32:35], s98 offen offset:3072 sc1
    s_waitcnt lgkmcnt(2)
    v_mfma_f32_32x32x16_bf16 v[48:63], v[108:111], v[156:159], v[48:63]
    ds_read_b64_tr_b16 v[100:101], v12 offset:40960
    ds_read_b64_tr_b16 v[102:103], v12 offset:41472
    s_waitcnt vmcnt(11) lgkmcnt(2)
    v_mfma_f32_32x32x16_bf16 v[32:47], v[96:99], v[160:163], v[32:47]
    ds_read_b64_tr_b16 v[104:105], v12 offset:9216
    ds_read_b64_tr_b16 v[106:107], v12 offset:9728
    s_add_u32 s98, s76, 20480
    buffer_load_dwordx4 v[208:211], v4, s[32:35], s98 offen offset:0 sc1
    s_waitcnt lgkmcnt(2)
    v_mfma_f32_32x32x16_bf16 v[48:63], v[100:103], v[160:163], v[48:63]
    ds_read_b64_tr_b16 v[108:109], v12 offset:41984
    ds_read_b64_tr_b16 v[110:111], v12 offset:42496
    s_waitcnt vmcnt(11) lgkmcnt(2)
    v_mfma_f32_32x32x16_bf16 v[32:47], v[104:107], v[164:167], v[32:47]
    ds_read_b64_tr_b16 v[96:97], v12 offset:10240
    ds_read_b64_tr_b16 v[98:99], v12 offset:10752
    s_add_u32 s98, s76, 20480
    buffer_load_dwordx4 v[212:215], v4, s[32:35], s98 offen offset:1024 sc1
    s_waitcnt lgkmcnt(2)
    v_mfma_f32_32x32x16_bf16 v[48:63], v[108:111], v[164:167], v[48:63]
    ds_read_b64_tr_b16 v[100:101], v12 offset:43008
    ds_read_b64_tr_b16 v[102:103], v12 offset:43520
    s_waitcnt vmcnt(11) lgkmcnt(2)
    v_mfma_f32_32x32x16_bf16 v[32:47], v[96:99], v[168:171], v[32:47]
    ds_read_b64_tr_b16 v[104:105], v12 offset:11264
    ds_read_b64_tr_b16 v[106:107], v12 offset:11776
    s_add_u32 s98, s76, 20480
    buffer_load_dwordx4 v[216:219], v4, s[32:35], s98 offen offset:2048 sc1
    v_add_f32 v112, v112, v114
    v_add_f32 v113, v113, v115
    v_add_f32 v112, v112, v116
    s_waitcnt lgkmcnt(2)
    v_mfma_f32_32x32x16_bf16 v[48:63], v[100:103], v[168:171], v[48:63]
    ds_read_b64_tr_b16 v[108:109], v12 offset:44032
    ds_read_b64_tr_b16 v[110:111], v12 offset:44544
    v_add_f32 v113, v113, v117
    v_add_f32 v112, v112, v118
    v_add_f32 v113, v113, v119
    s_waitcnt vmcnt(11) lgkmcnt(2)
    v_mfma_f32_32x32x16_bf16 v[32:47], v[104:107], v[172:175], v[32:47]
    ds_read_b64_tr_b16 v[96:97], v12 offset:12288
    ds_read_b64_tr_b16 v[98:99], v12 offset:12800
    s_add_u32 s98, s76, 20480
    buffer_load_dwordx4 v[220:223], v4, s[32:35], s98 offen offset:3072 sc1
    v_add_f32 v112, v112, v120
    v_add_f32 v113, v113, v121
    v_add_f32 v112, v112, v122
    s_waitcnt lgkmcnt(2)
    v_mfma_f32_32x32x16_bf16 v[48:63], v[108:111], v[172:175], v[48:63]
    ds_read_b64_tr_b16 v[100:101], v12 offset:45056
    ds_read_b64_tr_b16 v[102:103], v12 offset:45568
    v_add_f32 v113, v113, v123
    v_add_f32 v112, v112, v124
    v_add_f32 v113, v113, v125
    s_waitcnt vmcnt(11) lgkmcnt(2)
    v_mfma_f32_32x32x16_bf16 v[32:47], v[96:99], v[176:179], v[32:47]
    ds_read_b64_tr_b16 v[104:105], v12 offset:13312
    ds_read_b64_tr_b16 v[106:107], v12 offset:13824
    s_add_u32 s98, s76, 24576
    buffer_load_dwordx4 v[224:227], v4, s[32:35], s98 offen offset:0 sc1
    v_add_f32 v112, v112, v126
    v_add_f32 v113, v113, v127
    v_mov_b32 v26, v112
    s_waitcnt lgkmcnt(2)
    v_mfma_f32_32x32x16_bf16 v[48:63], v[100:103], v[176:179], v[48:63]
    ds_read_b64_tr_b16 v[108:109], v12 offset:46080
    ds_read_b64_tr_b16 v[110:111], v12 offset:46592
    v_mov_b32 v27, v113
    v_nop
    v_permlane32_swap_b32 v112, v26
    s_waitcnt vmcnt(11) lgkmcnt(2)
    v_mfma_f32_32x32x16_bf16 v[32:47], v[104:107], v[180:183], v[32:47]
    ds_read_b64_tr_b16 v[96:97], v12 offset:14336
    ds_read_b64_tr_b16 v[98:99], v12 offset:14848
    s_add_u32 s98, s76, 24576
    buffer_load_dwordx4 v[228:231], v4, s[32:35], s98 offen offset:1024 sc1
    v_permlane32_swap_b32 v113, v27
    v_add_f32 v112, v112, v26
    v_add_f32 v113, v113, v27
    s_waitcnt lgkmcnt(2)
    v_mfma_f32_32x32x16_bf16 v[48:63], v[108:111], v[180:183], v[48:63]
    ds_read_b64_tr_b16 v[100:101], v12 offset:47104
    ds_read_b64_tr_b16 v[102:103], v12 offset:47616
    v_mul_f32 v22, s51, v112
    v_mul_f32 v113, s51, v113
    v_fma_f32 v113, -v22, v22, v113
    s_waitcnt vmcnt(11) lgkmcnt(2)
    v_mfma_f32_32x32x16_bf16 v[32:47], v[96:99], v[184:187], v[32:47]
    ds_read_b64_tr_b16 v[104:105], v12 offset:15360
    ds_read_b64_tr_b16 v[106:107], v12 offset:15872
    s_add_u32 s98, s76, 24576
    buffer_load_dwordx4 v[232:235], v4, s[32:35], s98 offen offset:2048 sc1
    v_max_f32 v113, 0, v113
    v_add_f32 v113, s52, v113
    v_rsq_f32 v21, v113
    s_waitcnt lgkmcnt(2)
    v_mfma_f32_32x32x16_bf16 v[48:63], v[100:103], v[184:187], v[48:63]
    ds_read_b64_tr_b16 v[108:109], v12 offset:48128
    ds_read_b64_tr_b16 v[110:111], v12 offset:48640
    v_sub_f32 v28, 0, v22
    v_cndmask_b32 v28, 0, v28, s[54:55]
    v_cvt_pk_bf16_f32 v124, v28, v28
    s_waitcnt vmcnt(11) lgkmcnt(2)
    v_mfma_f32_32x32x16_bf16 v[32:47], v[104:107], v[188:191], v[32:47]
    ds_read_b64_tr_b16 v[96:97], v12 offset:16384
    ds_read_b64_tr_b16 v[98:99], v12 offset:16896
    s_add_u32 s98, s76, 24576
    buffer_load_dwordx4 v[236:239], v4, s[32:35], s98 offen offset:3072 sc1
    v_lshlrev_b32 v26, 16, v124
    v_sub_f32 v26, v28, v26
    v_cvt_pk_bf16_f32 v124, v28, v26
    s_waitcnt lgkmcnt(2)
    v_mfma_f32_32x32x16_bf16 v[48:63], v[108:111], v[188:191], v[48:63]
    ds_read_b64_tr_b16 v[100:101], v12 offset:49152
    ds_read_b64_tr_b16 v[102:103], v12 offset:49664
    v_mov_b32 v125, v124
    v_mov_b32 v126, 0
    v_mov_b32 v127, 0
    s_waitcnt vmcnt(11) lgkmcnt(2)
    v_mfma_f32_32x32x16_bf16 v[32:47], v[96:99], v[192:195], v[32:47]
    ds_read_b64_tr_b16 v[104:105], v12 offset:17408
    ds_read_b64_tr_b16 v[106:107], v12 offset:17920
    s_add_u32 s98, s76, 28672
    buffer_load_dwordx4 v[240:243], v4, s[32:35], s98 offen offset:0 sc1
    s_lshl_b32 s74, s44, 5
    v_add_u32 v26, s74, v2
    v_mul_u32_u24 v112, 104, v26
    s_waitcnt lgkmcnt(2)
    v_mfma_f32_32x32x16_bf16 v[48:63], v[100:103], v[192:195], v[48:63]
    ds_read_b64_tr_b16 v[108:109], v12 offset:50176
    ds_read_b64_tr_b16 v[110:111], v12 offset:50688
    v_lshl_add_u32 v112, v3, 3, v112
    v_add_u32 v112, 149504, v112
    v_mul_u32_u24 v113, 136, v26
    s_waitcnt vmcnt(11) lgkmcnt(2)
    v_mfma_f32_32x32x16_bf16 v[32:47], v[104:107], v[196:199], v[32:47]
    ds_read_b64_tr_b16 v[96:97], v12 offset:18432
    ds_read_b64_tr_b16 v[98:99], v12 offset:18944
    s_add_u32 s98, s76, 28672
    buffer_load_dwordx4 v[244:247], v4, s[32:35], s98 offen offset:1024 sc1
    v_lshl_add_u32 v113, v3, 3, v113
    v_add_u32 v113, 132096, v113
    v_mov_b32 v114, 0x3f803f80
    s_waitcnt lgkmcnt(2)
    v_mfma_f32_32x32x16_bf16 v[48:63], v[108:111], v[196:199], v[48:63]
    ds_read_b64_tr_b16 v[100:101], v12 offset:51200
    ds_read_b64_tr_b16 v[102:103], v12 offset:51712
    v_mov_b32 v115, 0x3f803f80
    v_bfe_u32 v26, v0, 2, 2
    v_lshl_add_u32 v26, v3, 3, v26
    s_waitcnt vmcnt(11) lgkmcnt(2)
    v_mfma_f32_32x32x16_bf16 v[32:47], v[96:99], v[200:203], v[32:47]
    ds_read_b64_tr_b16 v[104:105], v12 offset:19456
    ds_read_b64_tr_b16 v[106:107], v12 offset:19968
    s_add_u32 s98, s76, 28672
    buffer_load_dwordx4 v[248:251], v4, s[32:35], s98 offen offset:2048 sc1
    v_and_b32 v27, 3, v0
    v_lshlrev_b32 v27, 3, v27
    v_bfe_u32 v28, v0, 4, 1
    s_waitcnt lgkmcnt(2)
    v_mfma_f32_32x32x16_bf16 v[48:63], v[100:103], v[200:203], v[48:63]
    ds_read_b64_tr_b16 v[108:109], v12 offset:52224
    ds_read_b64_tr_b16 v[110:111], v12 offset:52736
    v_mul_u32_u24 v116, 136, v26
    v_add_u32 v116, v116, v27
    v_lshl_add_u32 v116, v28, 5, v116
    s_waitcnt vmcnt(11) lgkmcnt(2)
    v_mfma_f32_32x32x16_bf16 v[32:47], v[104:107], v[204:207], v[32:47]
    ds_read_b64_tr_b16 v[96:97], v12 offset:20480
    ds_read_b64_tr_b16 v[98:99], v12 offset:20992
    s_add_u32 s98, s76, 28672
    buffer_load_dwordx4 v[252:255], v4, s[32:35], s98 offen offset:3072 sc1
    s_lshl_b32 s74, s44, 6
    s_add_u32 s74, s74, 132096
    v_add_u32 v116, s74, v116
    s_waitcnt lgkmcnt(2)
    v_mfma_f32_32x32x16_bf16 v[48:63], v[108:111], v[204:207], v[48:63]
    ds_read_b64_tr_b16 v[100:101], v12 offset:53248
    ds_read_b64_tr_b16 v[102:103], v12 offset:53760
    s_lshl_b32 s74, s44, 5
    v_mov_b32 v29, s74
    v_cmp_eq_u32 vcc, 0, v28
    s_waitcnt vmcnt(11) lgkmcnt(2)
    v_mfma_f32_32x32x16_bf16 v[32:47], v[96:99], v[208:211], v[32:47]
    ds_read_b64_tr_b16 v[104:105], v12 offset:21504
    ds_read_b64_tr_b16 v[106:107], v12 offset:22016
    v_cndmask_b32 v29, 64, v29, vcc
    v_mul_u32_u24 v117, 104, v26
    v_add_u32 v117, v117, v27
    s_waitcnt lgkmcnt(2)
    v_mfma_f32_32x32x16_bf16 v[48:63], v[100:103], v[208:211], v[48:63]
    ds_read_b64_tr_b16 v[108:109], v12 offset:54272
    ds_read_b64_tr_b16 v[110:111], v12 offset:54784
    v_add_u32 v117, v117, v29
    v_add_u32 v117, 149504, v117
    v_mul_u32_u24 v118, 17, v3
    s_waitcnt vmcnt(10) lgkmcnt(2)
    v_mfma_f32_32x32x16_bf16 v[32:47], v[104:107], v[212:215], v[32:47]
    ds_read_b64_tr_b16 v[96:97], v12 offset:22528
    ds_read_b64_tr_b16 v[98:99], v12 offset:23040
    v_add_u32 v118, v118, v2
    v_lshlrev_b32 v118, 4, v118
    s_waitcnt lgkmcnt(2)
    v_mfma_f32_32x32x16_bf16 v[48:63], v[108:111], v[212:215], v[48:63]
    ds_read_b64_tr_b16 v[100:101], v12 offset:55296
    ds_read_b64_tr_b16 v[102:103], v12 offset:55808
    s_waitcnt vmcnt(9) lgkmcnt(2)
    v_mfma_f32_32x32x16_bf16 v[32:47], v[96:99], v[216:219], v[32:47]
    ds_read_b64_tr_b16 v[104:105], v12 offset:23552
    ds_read_b64_tr_b16 v[106:107], v12 offset:24064
    s_waitcnt lgkmcnt(2)
    v_mfma_f32_32x32x16_bf16 v[48:63], v[100:103], v[216:219], v[48:63]
    ds_read_b64_tr_b16 v[108:109], v12 offset:56320
    ds_read_b64_tr_b16 v[110:111], v12 offset:56832
    s_waitcnt vmcnt(8) lgkmcnt(2)
    v_mfma_f32_32x32x16_bf16 v[32:47], v[104:107], v[220:223], v[32:47]
    ds_read_b64_tr_b16 v[96:97], v12 offset:24576
    ds_read_b64_tr_b16 v[98:99], v12 offset:25088
    s_waitcnt lgkmcnt(2)
    v_mfma_f32_32x32x16_bf16 v[48:63], v[108:111], v[220:223], v[48:63]
    ds_read_b64_tr_b16 v[100:101], v12 offset:57344
    ds_read_b64_tr_b16 v[102:103], v12 offset:57856
    s_waitcnt vmcnt(7) lgkmcnt(2)
    v_mfma_f32_32x32x16_bf16 v[32:47], v[96:99], v[224:227], v[32:47]
    ds_read_b64_tr_b16 v[104:105], v12 offset:25600
    ds_read_b64_tr_b16 v[106:107], v12 offset:26112
    s_waitcnt lgkmcnt(2)
    v_mfma_f32_32x32x16_bf16 v[48:63], v[100:103], v[224:227], v[48:63]
    ds_read_b64_tr_b16 v[108:109], v12 offset:58368
    ds_read_b64_tr_b16 v[110:111], v12 offset:58880
    s_waitcnt vmcnt(6) lgkmcnt(2)
    v_mfma_f32_32x32x16_bf16 v[32:47], v[104:107], v[228:231], v[32:47]
    ds_read_b64_tr_b16 v[96:97], v12 offset:26624
    ds_read_b64_tr_b16 v[98:99], v12 offset:27136
    s_waitcnt lgkmcnt(2)
    v_mfma_f32_32x32x16_bf16 v[48:63], v[108:111], v[228:231], v[48:63]
    ds_read_b64_tr_b16 v[100:101], v12 offset:59392
    ds_read_b64_tr_b16 v[102:103], v12 offset:59904
    s_waitcnt vmcnt(5) lgkmcnt(2)
    v_mfma_f32_32x32x16_bf16 v[32:47], v[96:99], v[232:235], v[32:47]
    ds_read_b64_tr_b16 v[104:105], v12 offset:27648
    ds_read_b64_tr_b16 v[106:107], v12 offset:28160
    s_waitcnt lgkmcnt(2)
    v_mfma_f32_32x32x16_bf16 v[48:63], v[100:103], v[232:235], v[48:63]
    ds_read_b64_tr_b16 v[108:109], v12 offset:60416
    ds_read_b64_tr_b16 v[110:111], v12 offset:60928
    s_waitcnt vmcnt(4) lgkmcnt(2)
    v_mfma_f32_32x32x16_bf16 v[32:47], v[104:107], v[236:239], v[32:47]
    ds_read_b64_tr_b16 v[96:97], v12 offset:28672
    ds_read_b64_tr_b16 v[98:99], v12 offset:29184
    s_waitcnt lgkmcnt(2)
    v_mfma_f32_32x32x16_bf16 v[48:63], v[108:111], v[236:239], v[48:63]
    ds_read_b64_tr_b16 v[100:101], v12 offset:61440
    ds_read_b64_tr_b16 v[102:103], v12 offset:61952
    s_waitcnt vmcnt(3) lgkmcnt(2)
    v_mfma_f32_32x32x16_bf16 v[32:47], v[96:99], v[240:243], v[32:47]
    ds_read_b64_tr_b16 v[104:105], v12 offset:29696
    ds_read_b64_tr_b16 v[106:107], v12 offset:30208
    s_waitcnt lgkmcnt(2)
    v_mfma_f32_32x32x16_bf16 v[48:63], v[100:103], v[240:243], v[48:63]
    ds_read_b64_tr_b16 v[108:109], v12 offset:62464
    ds_read_b64_tr_b16 v[110:111], v12 offset:62976
    s_waitcnt vmcnt(2) lgkmcnt(2)
    v_mfma_f32_32x32x16_bf16 v[32:47], v[104:107], v[244:247], v[32:47]
    ds_read_b64_tr_b16 v[96:97], v12 offset:30720
    ds_read_b64_tr_b16 v[98:99], v12 offset:31232
    s_waitcnt lgkmcnt(2)
    v_mfma_f32_32x32x16_bf16 v[48:63], v[108:111], v[244:247], v[48:63]
    ds_read_b64_tr_b16 v[100:101], v12 offset:63488
    ds_read_b64_tr_b16 v[102:103], v12 offset:64000
    s_waitcnt vmcnt(1) lgkmcnt(2)
    v_mfma_f32_32x32x16_bf16 v[32:47], v[96:99], v[248:251], v[32:47]
    ds_read_b64_tr_b16 v[104:105], v12 offset:31744
    ds_read_b64_tr_b16 v[106:107], v12 offset:32256
    s_waitcnt lgkmcnt(2)
    v_mfma_f32_32x32x16_bf16 v[48:63], v[100:103], v[248:251], v[48:63]
    ds_read_b64_tr_b16 v[108:109], v12 offset:64512
    ds_read_b64_tr_b16 v[110:111], v12 offset:65024
    s_waitcnt vmcnt(0) lgkmcnt(2)
    v_mfma_f32_32x32x16_bf16 v[32:47], v[104:107], v[252:255], v[32:47]
    s_waitcnt lgkmcnt(0)
    v_mfma_f32_32x32x16_bf16 v[48:63], v[108:111], v[252:255], v[48:63]
    v_mfma_f32_32x32x16_bf16 v[32:47], a[220:223], v[124:127], v[32:47]
    v_mfma_f32_32x32x16_bf16 v[48:63], a[224:227], v[124:127], v[48:63]
    s_nop 10
    v_pk_mul_f32 v[32:33], v[32:33], v[20:21] op_sel:[0,1] op_sel_hi:[1,1]
    v_pk_mul_f32 v[34:35], v[34:35], v[20:21] op_sel:[0,1] op_sel_hi:[1,1]
    v_pk_mul_f32 v[36:37], v[36:37], v[20:21] op_sel:[0,1] op_sel_hi:[1,1]
    v_pk_mul_f32 v[38:39], v[38:39], v[20:21] op_sel:[0,1] op_sel_hi:[1,1]
    v_pk_mul_f32 v[40:41], v[40:41], v[20:21] op_sel:[0,1] op_sel_hi:[1,1]
    v_pk_mul_f32 v[42:43], v[42:43], v[20:21] op_sel:[0,1] op_sel_hi:[1,1]
    v_pk_mul_f32 v[44:45], v[44:45], v[20:21] op_sel:[0,1] op_sel_hi:[1,1]
    v_pk_mul_f32 v[46:47], v[46:47], v[20:21] op_sel:[0,1] op_sel_hi:[1,1]
    v_cvt_pk_bf16_f32 v96, v32, v33
    v_cvt_pk_bf16_f32 v97, v34, v35
    v_cvt_pk_bf16_f32 v98, v36, v37
    v_cvt_pk_bf16_f32 v99, v38, v39
    v_cvt_pk_bf16_f32 v100, v40, v41
    v_cvt_pk_bf16_f32 v101, v42, v43
    v_cvt_pk_bf16_f32 v102, v44, v45
    v_cvt_pk_bf16_f32 v103, v46, v47
    v_mfma_f32_32x32x16_bf16 v[80:95], a[248:251], v[96:99], 0
    s_nop 0
    v_mfma_f32_32x32x16_bf16 v[80:95], a[252:255], v[100:103], v[80:95]
    v_mul_f32 v48, v48, v21
    v_mul_f32 v49, v49, v21
    v_mul_f32 v50, v50, v21
    v_mul_f32 v51, v51, v21
    v_mul_f32 v52, v52, v21
    v_mul_f32 v53, v53, v21
    v_mul_f32 v54, v54, v21
    v_mul_f32 v55, v55, v21
    v_mul_f32 v56, v56, v21
    v_mul_f32 v57, v57, v21
    v_mul_f32 v58, v58, v21
    v_mul_f32 v59, v59, v21
    v_mul_f32 v60, v60, v21
    v_mul_f32 v61, v61, v21
    v_mul_f32 v62, v62, v21
    v_mul_f32 v63, v63, v21
    v_cvt_pk_bf16_f32 v104, v48, v49
    v_cvt_pk_bf16_f32 v105, v50, v51
    v_cvt_pk_bf16_f32 v106, v52, v53
    v_cvt_pk_bf16_f32 v107, v54, v55
    v_cvt_pk_bf16_f32 v108, v56, v57
    v_cvt_pk_bf16_f32 v109, v58, v59
    v_cvt_pk_bf16_f32 v110, v60, v61
    v_cvt_pk_bf16_f32 v111, v62, v63
    ds_write_b64 v112, v[104:105] offset:0
    ds_write_b64 v112, v[106:107] offset:16
    ds_write_b64 v112, v[108:109] offset:32
    ds_write_b64 v112, v[110:111] offset:48
    ds_write_b64 v112, v[114:115] offset:64
    ds_write_b64 v112, v[114:115] offset:80
    v_max3_f32 v24, v80, v81, v82
    v_min3_f32 v26, v80, v81, v82
    v_max3_f32 v24, v24, v83, v84
    v_min3_f32 v26, v26, v83, v84
    v_max3_f32 v24, v24, v85, v86
    v_min3_f32 v26, v26, v85, v86
    v_max_f32 v24, v24, v87
    v_min_f32 v26, v26, v87
    v_mov_b32 v25, v24
    v_mov_b32 v27, v26
    v_nop
    v_permlane32_swap_b32 v24, v25
    v_permlane32_swap_b32 v26, v27
    v_max_f32 v24, v24, v25
    v_min_f32 v26, v26, v27
    v_mul_f32 v24, s50, v24
    v_mul_f32 v26, s50, v26
    v_pk_fma_f32 v[64:65], v[80:81], s[50:51], v[24:25] op_sel_hi:[1,0,0] neg_lo:[0,0,1] neg_hi:[0,0,1]
    v_pk_fma_f32 v[72:73], v[80:81], s[50:51], v[26:27] op_sel_hi:[1,0,0] neg_lo:[1,0,0] neg_hi:[1,0,0]
    v_pk_fma_f32 v[66:67], v[82:83], s[50:51], v[24:25] op_sel_hi:[1,0,0] neg_lo:[0,0,1] neg_hi:[0,0,1]
    v_pk_fma_f32 v[74:75], v[82:83], s[50:51], v[26:27] op_sel_hi:[1,0,0] neg_lo:[1,0,0] neg_hi:[1,0,0]
    v_pk_fma_f32 v[68:69], v[84:85], s[50:51], v[24:25] op_sel_hi:[1,0,0] neg_lo:[0,0,1] neg_hi:[0,0,1]
    v_pk_fma_f32 v[76:77], v[84:85], s[50:51], v[26:27] op_sel_hi:[1,0,0] neg_lo:[1,0,0] neg_hi:[1,0,0]
    v_pk_fma_f32 v[70:71], v[86:87], s[50:51], v[24:25] op_sel_hi:[1,0,0] neg_lo:[0,0,1] neg_hi:[0,0,1]
    v_pk_fma_f32 v[78:79], v[86:87], s[50:51], v[26:27] op_sel_hi:[1,0,0] neg_lo:[1,0,0] neg_hi:[1,0,0]
    v_exp_f32 v64, v64
    v_exp_f32 v72, v72
    v_exp_f32 v65, v65
    v_exp_f32 v73, v73
    v_exp_f32 v66, v66
    v_exp_f32 v74, v74
    v_exp_f32 v67, v67
    v_exp_f32 v75, v75
    v_exp_f32 v68, v68
    v_exp_f32 v76, v76
    v_exp_f32 v69, v69
    v_exp_f32 v77, v77
    v_exp_f32 v70, v70
    v_exp_f32 v78, v78
    v_exp_f32 v71, v71
    v_exp_f32 v79, v79
    v_pk_add_f32 v[24:25], v[64:65], v[66:67]
    v_pk_add_f32 v[26:27], v[72:73], v[74:75]
    v_pk_add_f32 v[24:25], v[24:25], v[68:69]
    v_pk_add_f32 v[26:27], v[26:27], v[76:77]
    v_pk_add_f32 v[24:25], v[24:25], v[70:71]
    v_pk_add_f32 v[26:27], v[26:27], v[78:79]
    v_add_f32 v28, v24, v25
    v_add_f32 v29, v26, v27
    v_mov_b32 v25, v28
    v_mov_b32 v27, v29
    v_nop
    v_permlane32_swap_b32 v28, v25
    v_permlane32_swap_b32 v29, v27
    v_add_f32 v28, v28, v25
    v_add_f32 v29, v29, v27
    v_rcp_f32 v24, v28
    v_rcp_f32 v26, v29
    v_nop
    v_pk_mul_f32 v[64:65], v[64:65], v[24:25] op_sel_hi:[1,0]
    v_pk_mul_f32 v[72:73], v[72:73], v[26:27] op_sel_hi:[1,0]
    v_pk_mul_f32 v[66:67], v[66:67], v[24:25] op_sel_hi:[1,0]
    v_pk_mul_f32 v[74:75], v[74:75], v[26:27] op_sel_hi:[1,0]
    v_pk_mul_f32 v[68:69], v[68:69], v[24:25] op_sel_hi:[1,0]
    v_pk_mul_f32 v[76:77], v[76:77], v[26:27] op_sel_hi:[1,0]
    v_pk_mul_f32 v[70:71], v[70:71], v[24:25] op_sel_hi:[1,0]
    v_pk_mul_f32 v[78:79], v[78:79], v[26:27] op_sel_hi:[1,0]
    v_cvt_pk_bf16_f32 v32, v64, v65
    v_cvt_pk_bf16_f32 v36, v72, v73
    v_cvt_pk_bf16_f32 v33, v66, v67
    v_cvt_pk_bf16_f32 v37, v74, v75
    v_cvt_pk_bf16_f32 v34, v68, v69
    v_cvt_pk_bf16_f32 v38, v76, v77
    v_cvt_pk_bf16_f32 v35, v70, v71
    v_cvt_pk_bf16_f32 v39, v78, v79
    v_max3_f32 v24, v88, v89, v90
    v_min3_f32 v26, v88, v89, v90
    v_max3_f32 v24, v24, v91, v92
    v_min3_f32 v26, v26, v91, v92
    v_max3_f32 v24, v24, v93, v94
    v_min3_f32 v26, v26, v93, v94
    v_max_f32 v24, v24, v95
    v_min_f32 v26, v26, v95
    v_mov_b32 v25, v24
    v_mov_b32 v27, v26
    v_nop
    v_permlane32_swap_b32 v24, v25
    v_permlane32_swap_b32 v26, v27
    v_max_f32 v24, v24, v25
    v_min_f32 v26, v26, v27
    v_mul_f32 v24, s50, v24
    v_mul_f32 v26, s50, v26
    v_pk_fma_f32 v[64:65], v[88:89], s[50:51], v[24:25] op_sel_hi:[1,0,0] neg_lo:[0,0,1] neg_hi:[0,0,1]
    v_pk_fma_f32 v[72:73], v[88:89], s[50:51], v[26:27] op_sel_hi:[1,0,0] neg_lo:[1,0,0] neg_hi:[1,0,0]
    v_pk_fma_f32 v[66:67], v[90:91], s[50:51], v[24:25] op_sel_hi:[1,0,0] neg_lo:[0,0,1] neg_hi:[0,0,1]
    v_pk_fma_f32 v[74:75], v[90:91], s[50:51], v[26:27] op_sel_hi:[1,0,0] neg_lo:[1,0,0] neg_hi:[1,0,0]
    v_pk_fma_f32 v[68:69], v[92:93], s[50:51], v[24:25] op_sel_hi:[1,0,0] neg_lo:[0,0,1] neg_hi:[0,0,1]
    v_pk_fma_f32 v[76:77], v[92:93], s[50:51], v[26:27] op_sel_hi:[1,0,0] neg_lo:[1,0,0] neg_hi:[1,0,0]
    v_pk_fma_f32 v[70:71], v[94:95], s[50:51], v[24:25] op_sel_hi:[1,0,0] neg_lo:[0,0,1] neg_hi:[0,0,1]
    v_pk_fma_f32 v[78:79], v[94:95], s[50:51], v[26:27] op_sel_hi:[1,0,0] neg_lo:[1,0,0] neg_hi:[1,0,0]
    v_exp_f32 v64, v64
    v_exp_f32 v72, v72
    v_exp_f32 v65, v65
    v_exp_f32 v73, v73
    v_exp_f32 v66, v66
    v_exp_f32 v74, v74
    v_exp_f32 v67, v67
    v_exp_f32 v75, v75
    v_exp_f32 v68, v68
    v_exp_f32 v76, v76
    v_exp_f32 v69, v69
    v_exp_f32 v77, v77
    v_exp_f32 v70, v70
    v_exp_f32 v78, v78
    v_exp_f32 v71, v71
    v_exp_f32 v79, v79
    v_pk_add_f32 v[24:25], v[64:65], v[66:67]
    v_pk_add_f32 v[26:27], v[72:73], v[74:75]
    v_pk_add_f32 v[24:25], v[24:25], v[68:69]
    v_pk_add_f32 v[26:27], v[26:27], v[76:77]
    v_pk_add_f32 v[24:25], v[24:25], v[70:71]
    v_pk_add_f32 v[26:27], v[26:27], v[78:79]
    v_add_f32 v28, v24, v25
    v_add_f32 v29, v26, v27
    v_mov_b32 v25, v28
    v_mov_b32 v27, v29
    v_nop
    v_permlane32_swap_b32 v28, v25
    v_permlane32_swap_b32 v29, v27
    v_add_f32 v28, v28, v25
    v_add_f32 v29, v29, v27
    v_rcp_f32 v24, v28
    v_rcp_f32 v26, v29
    v_nop
    v_pk_mul_f32 v[64:65], v[64:65], v[24:25] op_sel_hi:[1,0]
    v_pk_mul_f32 v[72:73], v[72:73], v[26:27] op_sel_hi:[1,0]
    v_pk_mul_f32 v[66:67], v[66:67], v[24:25] op_sel_hi:[1,0]
    v_pk_mul_f32 v[74:75], v[74:75], v[26:27] op_sel_hi:[1,0]
    v_pk_mul_f32 v[68:69], v[68:69], v[24:25] op_sel_hi:[1,0]
    v_pk_mul_f32 v[76:77], v[76:77], v[26:27] op_sel_hi:[1,0]
    v_pk_mul_f32 v[70:71], v[70:71], v[24:25] op_sel_hi:[1,0]
    v_pk_mul_f32 v[78:79], v[78:79], v[26:27] op_sel_hi:[1,0]
    v_cvt_pk_bf16_f32 v40, v64, v65
    v_cvt_pk_bf16_f32 v44, v72, v73
    v_cvt_pk_bf16_f32 v41, v66, v67
    v_cvt_pk_bf16_f32 v45, v74, v75
    v_cvt_pk_bf16_f32 v42, v68, v69
    v_cvt_pk_bf16_f32 v46, v76, v77
    v_cvt_pk_bf16_f32 v43, v70, v71
    v_cvt_pk_bf16_f32 v47, v78, v79
    ds_write_b64 v113, v[32:33] offset:0
    ds_write_b64 v113, v[34:35] offset:16
    ds_write_b64 v113, v[36:37] offset:32
    ds_write_b64 v113, v[38:39] offset:48
    ds_write_b64 v113, v[40:41] offset:64
    ds_write_b64 v113, v[42:43] offset:80
    ds_write_b64 v113, v[44:45] offset:96
    ds_write_b64 v113, v[46:47] offset:112
    s_waitcnt lgkmcnt(0)
    s_barrier
    s_cmp_ge_u32 s44, 2
    s_cbranch_scc1 W23_141
    ds_read_b64_tr_b16 v[32:33], v116 offset:0
    ds_read_b64_tr_b16 v[34:35], v116 offset:544
    ds_read_b64_tr_b16 v[36:37], v117 offset:0
    ds_read_b64_tr_b16 v[38:39], v117 offset:416
    ds_read_b64_tr_b16 v[40:41], v116 offset:2176
    ds_read_b64_tr_b16 v[42:43], v116 offset:2720
    ds_read_b64_tr_b16 v[44:45], v117 offset:1664
    ds_read_b64_tr_b16 v[46:47], v117 offset:2080
    ds_read_b64_tr_b16 v[48:49], v116 offset:4352
    ds_read_b64_tr_b16 v[50:51], v116 offset:4896
    ds_read_b64_tr_b16 v[52:53], v117 offset:3328
    ds_read_b64_tr_b16 v[54:55], v117 offset:3744
    s_lshl_b32 s74, s46, 4
    s_add_u32 s74, s74, s45
    s_mul_i32 s74, s74, 4352
    s_mul_i32 s75, s44, 2176
    s_add_u32 s74, s74, s75
    s_add_u32 s74, s74, 1703936
    s_waitcnt lgkmcnt(8)
    v_mfma_f32_32x32x16_bf16 v[80:95], v[32:35], v[36:39], 0
    ds_read_b64_tr_b16 v[56:57], v116 offset:6528
    ds_read_b64_tr_b16 v[58:59], v116 offset:7072
    ds_read_b64_tr_b16 v[60:61], v117 offset:4992
    ds_read_b64_tr_b16 v[62:63], v117 offset:5408
    s_waitcnt lgkmcnt(8)
    v_mfma_f32_32x32x16_bf16 v[80:95], v[40:43], v[44:47], v[80:95]
    ds_read_b64_tr_b16 v[64:65], v116 offset:8704
    ds_read_b64_tr_b16 v[66:67], v116 offset:9248
    ds_read_b64_tr_b16 v[68:69], v117 offset:6656
    ds_read_b64_tr_b16 v[70:71], v117 offset:7072
    s_waitcnt lgkmcnt(8)
    v_mfma_f32_32x32x16_bf16 v[80:95], v[48:51], v[52:55], v[80:95]
    ds_read_b64_tr_b16 v[72:73], v116 offset:10880
    ds_read_b64_tr_b16 v[74:75], v116 offset:11424
    ds_read_b64_tr_b16 v[76:77], v117 offset:8320
    ds_read_b64_tr_b16 v[78:79], v117 offset:8736
    s_waitcnt lgkmcnt(8)
    v_mfma_f32_32x32x16_bf16 v[80:95], v[56:59], v[60:63], v[80:95]
    ds_read_b64_tr_b16 v[96:97], v116 offset:13056
    ds_read_b64_tr_b16 v[98:99], v116 offset:13600
    ds_read_b64_tr_b16 v[100:101], v117 offset:9984
    ds_read_b64_tr_b16 v[102:103], v117 offset:10400
    s_waitcnt lgkmcnt(8)
    v_mfma_f32_32x32x16_bf16 v[80:95], v[64:67], v[68:71], v[80:95]
    ds_read_b64_tr_b16 v[104:105], v116 offset:15232
    ds_read_b64_tr_b16 v[106:107], v116 offset:15776
    ds_read_b64_tr_b16 v[108:109], v117 offset:11648
    ds_read_b64_tr_b16 v[110:111], v117 offset:12064
    s_waitcnt lgkmcnt(8)
    v_mfma_f32_32x32x16_bf16 v[80:95], v[72:75], v[76:79], v[80:95]
    s_waitcnt lgkmcnt(4)
    v_mfma_f32_32x32x16_bf16 v[80:95], v[96:99], v[100:103], v[80:95]
    s_waitcnt lgkmcnt(0)
    v_mfma_f32_32x32x16_bf16 v[80:95], v[104:107], v[108:111], v[80:95]
    s_mov_b64 s[58:59], exec
    s_mov_b32 exec_lo, 0x1ffff
    s_mov_b32 exec_hi, 0x1ffff
    s_nop 8
    buffer_store_dwordx4 v[80:83], v118, s[32:35], s74 offen offset:0 sc1
    buffer_store_dwordx4 v[84:87], v118, s[32:35], s74 offen offset:544 sc1
    buffer_store_dwordx4 v[88:91], v118, s[32:35], s74 offen offset:1088 sc1
    buffer_store_dwordx4 v[92:95], v118, s[32:35], s74 offen offset:1632 sc1
    s_mov_b64 exec, s[58:59]
    s_barrier
    ds_read_b64_tr_b16 v[96:97], v13 offset:0
    ds_read_b64_tr_b16 v[98:99], v13 offset:512
    ds_read_b64_tr_b16 v[100:101], v13 offset:1024
    ds_read_b64_tr_b16 v[102:103], v13 offset:1536
    s_waitcnt lgkmcnt(2)
    v_mfma_f32_32x32x16_bf16 v[64:79], v[96:99], v[128:131], 0
    ds_read_b64_tr_b16 v[104:105], v13 offset:2048
    ds_read_b64_tr_b16 v[106:107], v13 offset:2560
    s_add_u32 s99, s65, 0
    s_add_u32 m0, s62, 0
    s_nop 0
    buffer_load_dwordx4 v7, s[20:23], s99 offen lds
    s_waitcnt lgkmcnt(2)
    v_mfma_f32_32x32x16_bf16 v[64:79], v[100:103], v[132:135], v[64:79]
    ds_read_b64_tr_b16 v[108:109], v13 offset:3072
    ds_read_b64_tr_b16 v[110:111], v13 offset:3584
    s_waitcnt lgkmcnt(2)
    v_mfma_f32_32x32x16_bf16 v[64:79], v[104:107], v[136:139], v[64:79]
    ds_read_b64_tr_b16 v[96:97], v13 offset:4096
    ds_read_b64_tr_b16 v[98:99], v13 offset:4608
    s_add_u32 s99, s65, 28672
    s_add_u32 m0, s62, 1024
    s_nop 0
    buffer_load_dwordx4 v7, s[20:23], s99 offen lds
    s_waitcnt lgkmcnt(2)
    v_mfma_f32_32x32x16_bf16 v[64:79], v[108:111], v[140:143], v[64:79]
    ds_read_b64_tr_b16 v[100:101], v13 offset:5120
    ds_read_b64_tr_b16 v[102:103], v13 offset:5632
    s_waitcnt lgkmcnt(2)
    v_mfma_f32_32x32x16_bf16 v[64:79], v[96:99], v[144:147], v[64:79]
    ds_read_b64_tr_b16 v[104:105], v13 offset:6144
    ds_read_b64_tr_b16 v[106:107], v13 offset:6656
    s_add_u32 s99, s65, 57344
    s_add_u32 m0, s62, 2048
    s_nop 0
    buffer_load_dwordx4 v7, s[20:23], s99 offen lds
    s_waitcnt lgkmcnt(2)
    v_mfma_f32_32x32x16_bf16 v[64:79], v[100:103], v[148:151], v[64:79]
    ds_read_b64_tr_b16 v[108:109], v13 offset:7168
    ds_read_b64_tr_b16 v[110:111], v13 offset:7680
    s_waitcnt lgkmcnt(2)
    v_mfma_f32_32x32x16_bf16 v[64:79], v[104:107], v[152:155], v[64:79]
    ds_read_b64_tr_b16 v[96:97], v13 offset:8192
    ds_read_b64_tr_b16 v[98:99], v13 offset:8704
    s_add_u32 s99, s65, 86016
    s_add_u32 m0, s62, 3072
    s_nop 0
    buffer_load_dwordx4 v7, s[20:23], s99 offen lds
    s_waitcnt lgkmcnt(2)
    v_mfma_f32_32x32x16_bf16 v[64:79], v[108:111], v[156:159], v[64:79]
    ds_read_b64_tr_b16 v[100:101], v13 offset:9216
    ds_read_b64_tr_b16 v[102:103], v13 offset:9728
    s_waitcnt lgkmcnt(2)
    v_mfma_f32_32x32x16_bf16 v[64:79], v[96:99], v[160:163], v[64:79]
    ds_read_b64_tr_b16 v[104:105], v13 offset:10240
    ds_read_b64_tr_b16 v[106:107], v13 offset:10752
    s_add_u32 s99, s65, 114688
    s_add_u32 m0, s62, 4096
    s_nop 0
    buffer_load_dwordx4 v7, s[20:23], s99 offen lds
    s_waitcnt lgkmcnt(2)
    v_mfma_f32_32x32x16_bf16 v[64:79], v[100:103], v[164:167], v[64:79]
    ds_read_b64_tr_b16 v[108:109], v13 offset:11264
    ds_read_b64_tr_b16 v[110:111], v13 offset:11776
    s_waitcnt lgkmcnt(2)
    v_mfma_f32_32x32x16_bf16 v[64:79], v[104:107], v[168:171], v[64:79]
    ds_read_b64_tr_b16 v[96:97], v13 offset:12288
    ds_read_b64_tr_b16 v[98:99], v13 offset:12800
    s_add_u32 s99, s65, 143360
    s_add_u32 m0, s62, 5120
    s_nop 0
    buffer_load_dwordx4 v7, s[20:23], s99 offen lds
    s_waitcnt lgkmcnt(2)
    v_mfma_f32_32x32x16_bf16 v[64:79], v[108:111], v[172:175], v[64:79]
    ds_read_b64_tr_b16 v[100:101], v13 offset:13312
    ds_read_b64_tr_b16 v[102:103], v13 offset:13824
    s_waitcnt lgkmcnt(2)
    v_mfma_f32_32x32x16_bf16 v[64:79], v[96:99], v[176:179], v[64:79]
    ds_read_b64_tr_b16 v[104:105], v13 offset:14336
    ds_read_b64_tr_b16 v[106:107], v13 offset:14848
    s_add_u32 s99, s65, 172032
    s_add_u32 m0, s62, 6144
    s_nop 0
    buffer_load_dwordx4 v7, s[20:23], s99 offen lds
    s_waitcnt lgkmcnt(2)
    v_mfma_f32_32x32x16_bf16 v[64:79], v[100:103], v[180:183], v[64:79]
    ds_read_b64_tr_b16 v[108:109], v13 offset:15360
    ds_read_b64_tr_b16 v[110:111], v13 offset:15872
    s_waitcnt lgkmcnt(2)
    v_mfma_f32_32x32x16_bf16 v[64:79], v[104:107], v[184:187], v[64:79]
    ds_read_b64_tr_b16 v[96:97], v13 offset:16384
    ds_read_b64_tr_b16 v[98:99], v13 offset:16896
    s_add_u32 s99, s65, 200704
    s_add_u32 m0, s62, 7168
    s_nop 0
    buffer_load_dwordx4 v7, s[20:23], s99 offen lds
    s_waitcnt lgkmcnt(2)
    v_mfma_f32_32x32x16_bf16 v[64:79], v[108:111], v[188:191], v[64:79]
    ds_read_b64_tr_b16 v[100:101], v13 offset:17408
    ds_read_b64_tr_b16 v[102:103], v13 offset:17920
    s_waitcnt lgkmcnt(2)
    v_mfma_f32_32x32x16_bf16 v[64:79], v[96:99], v[192:195], v[64:79]
    ds_read_b64_tr_b16 v[104:105], v13 offset:18432
    ds_read_b64_tr_b16 v[106:107], v13 offset:18944
    s_waitcnt lgkmcnt(2)
    v_mfma_f32_32x32x16_bf16 v[64:79], v[100:103], v[196:199], v[64:79]
    ds_read_b64_tr_b16 v[108:109], v13 offset:19456
    ds_read_b64_tr_b16 v[110:111], v13 offset:19968
    s_waitcnt lgkmcnt(2)
    v_mfma_f32_32x32x16_bf16 v[64:79], v[104:107], v[200:203], v[64:79]
    ds_read_b64_tr_b16 v[96:97], v13 offset:20480
    ds_read_b64_tr_b16 v[98:99], v13 offset:20992
    s_waitcnt lgkmcnt(2)
    v_mfma_f32_32x32x16_bf16 v[64:79], v[108:111], v[204:207], v[64:79]
    ds_read_b64_tr_b16 v[100:101], v13 offset:21504
    ds_read_b64_tr_b16 v[102:103], v13 offset:22016
    s_waitcnt lgkmcnt(2)
    v_mfma_f32_32x32x16_bf16 v[64:79], v[96:99], v[208:211], v[64:79]
    ds_read_b64_tr_b16 v[104:105], v13 offset:22528
    ds_read_b64_tr_b16 v[106:107], v13 offset:23040
    s_waitcnt vmcnt(8)
    s_mov_b64 s[58:59], exec
    s_mov_b32 exec_lo, 65535
    s_mov_b32 exec_hi, 0
    v_mov_b32 v24, 1
    buffer_atomic_add v24, v8, s[32:35], 0 offen offset:64 sc1
    s_mov_b64 exec, s[58:59]
    s_waitcnt lgkmcnt(2)
    v_mfma_f32_32x32x16_bf16 v[64:79], v[100:103], v[212:215], v[64:79]
    ds_read_b64_tr_b16 v[108:109], v13 offset:23552
    ds_read_b64_tr_b16 v[110:111], v13 offset:24064
    s_waitcnt lgkmcnt(2)
    v_mfma_f32_32x32x16_bf16 v[64:79], v[104:107], v[216:219], v[64:79]
    ds_read_b64_tr_b16 v[96:97], v13 offset:24576
    ds_read_b64_tr_b16 v[98:99], v13 offset:25088
    s_waitcnt lgkmcnt(2)
    v_mfma_f32_32x32x16_bf16 v[64:79], v[108:111], v[220:223], v[64:79]
    ds_read_b64_tr_b16 v[100:101], v13 offset:25600
    ds_read_b64_tr_b16 v[102:103], v13 offset:26112
    s_waitcnt lgkmcnt(2)
    v_mfma_f32_32x32x16_bf16 v[64:79], v[96:99], v[224:227], v[64:79]
    ds_read_b64_tr_b16 v[104:105], v13 offset:26624
    ds_read_b64_tr_b16 v[106:107], v13 offset:27136
    s_waitcnt lgkmcnt(2)
    v_mfma_f32_32x32x16_bf16 v[64:79], v[100:103], v[228:231], v[64:79]
    ds_read_b64_tr_b16 v[108:109], v13 offset:27648
    ds_read_b64_tr_b16 v[110:111], v13 offset:28160
    s_waitcnt lgkmcnt(2)
    v_mfma_f32_32x32x16_bf16 v[64:79], v[104:107], v[232:235], v[64:79]
    ds_read_b64_tr_b16 v[96:97], v13 offset:28672
    ds_read_b64_tr_b16 v[98:99], v13 offset:29184
    s_waitcnt lgkmcnt(2)
    v_mfma_f32_32x32x16_bf16 v[64:79], v[108:111], v[236:239], v[64:79]
    ds_read_b64_tr_b16 v[100:101], v13 offset:29696
    ds_read_b64_tr_b16 v[102:103], v13 offset:30208
    s_waitcnt lgkmcnt(2)
    v_mfma_f32_32x32x16_bf16 v[64:79], v[96:99], v[240:243], v[64:79]
    ds_read_b64_tr_b16 v[104:105], v13 offset:30720
    ds_read_b64_tr_b16 v[106:107], v13 offset:31232
    s_waitcnt lgkmcnt(2)
    v_mfma_f32_32x32x16_bf16 v[64:79], v[100:103], v[244:247], v[64:79]
    ds_read_b64_tr_b16 v[108:109], v13 offset:31744
    ds_read_b64_tr_b16 v[110:111], v13 offset:32256
    s_waitcnt lgkmcnt(2)
    v_mfma_f32_32x32x16_bf16 v[64:79], v[104:107], v[248:251], v[64:79]
    s_waitcnt lgkmcnt(0)
    v_mfma_f32_32x32x16_bf16 v[64:79], v[108:111], v[252:255], v[64:79]
    v_mfma_f32_32x32x16_bf16 v[64:79], a[228:231], v[124:127], v[64:79]
    s_nop 11
    v_pk_mul_f32 v[64:65], v[64:65], v[20:21] op_sel:[0,1] op_sel_hi:[1,1]
    v_pk_mul_f32 v[66:67], v[66:67], v[20:21] op_sel:[0,1] op_sel_hi:[1,1]
    v_pk_mul_f32 v[68:69], v[68:69], v[20:21] op_sel:[0,1] op_sel_hi:[1,1]
    v_pk_mul_f32 v[70:71], v[70:71], v[20:21] op_sel:[0,1] op_sel_hi:[1,1]
    v_pk_mul_f32 v[72:73], v[72:73], v[20:21] op_sel:[0,1] op_sel_hi:[1,1]
    v_pk_mul_f32 v[74:75], v[74:75], v[20:21] op_sel:[0,1] op_sel_hi:[1,1]
    v_pk_mul_f32 v[76:77], v[76:77], v[20:21] op_sel:[0,1] op_sel_hi:[1,1]
    v_pk_mul_f32 v[78:79], v[78:79], v[20:21] op_sel:[0,1] op_sel_hi:[1,1]
    v_cvt_pk_bf16_f32 v96, v64, v65
    v_cvt_pk_bf16_f32 v97, v66, v67
    v_cvt_pk_bf16_f32 v98, v68, v69
    v_cvt_pk_bf16_f32 v99, v70, v71
    v_cvt_pk_bf16_f32 v100, v72, v73
    v_cvt_pk_bf16_f32 v101, v74, v75
    v_cvt_pk_bf16_f32 v102, v76, v77
    v_cvt_pk_bf16_f32 v103, v78, v79
    v_mfma_f32_32x32x16_bf16 v[80:95], a[248:251], v[96:99], 0
    s_nop 0
    v_mfma_f32_32x32x16_bf16 v[80:95], a[252:255], v[100:103], v[80:95]
    s_nop 11
    v_max3_f32 v24, v80, v81, v82
    v_min3_f32 v26, v80, v81, v82
    v_max3_f32 v24, v24, v83, v84
    v_min3_f32 v26, v26, v83, v84
    v_max3_f32 v24, v24, v85, v86
    v_min3_f32 v26, v26, v85, v86
    v_max_f32 v24, v24, v87
    v_min_f32 v26, v26, v87
    v_mov_b32 v25, v24
    v_mov_b32 v27, v26
    v_nop
    v_permlane32_swap_b32 v24, v25
    v_permlane32_swap_b32 v26, v27
    v_max_f32 v24, v24, v25
    v_min_f32 v26, v26, v27
    v_mul_f32 v24, s50, v24
    v_mul_f32 v26, s50, v26
    v_pk_fma_f32 v[64:65], v[80:81], s[50:51], v[24:25] op_sel_hi:[1,0,0] neg_lo:[0,0,1] neg_hi:[0,0,1]
    v_pk_fma_f32 v[72:73], v[80:81], s[50:51], v[26:27] op_sel_hi:[1,0,0] neg_lo:[1,0,0] neg_hi:[1,0,0]
    v_pk_fma_f32 v[66:67], v[82:83], s[50:51], v[24:25] op_sel_hi:[1,0,0] neg_lo:[0,0,1] neg_hi:[0,0,1]
    v_pk_fma_f32 v[74:75], v[82:83], s[50:51], v[26:27] op_sel_hi:[1,0,0] neg_lo:[1,0,0] neg_hi:[1,0,0]
    v_pk_fma_f32 v[68:69], v[84:85], s[50:51], v[24:25] op_sel_hi:[1,0,0] neg_lo:[0,0,1] neg_hi:[0,0,1]
    v_pk_fma_f32 v[76:77], v[84:85], s[50:51], v[26:27] op_sel_hi:[1,0,0] neg_lo:[1,0,0] neg_hi:[1,0,0]
    v_pk_fma_f32 v[70:71], v[86:87], s[50:51], v[24:25] op_sel_hi:[1,0,0] neg_lo:[0,0,1] neg_hi:[0,0,1]
    v_pk_fma_f32 v[78:79], v[86:87], s[50:51], v[26:27] op_sel_hi:[1,0,0] neg_lo:[1,0,0] neg_hi:[1,0,0]
    v_exp_f32 v64, v64
    v_exp_f32 v72, v72
    v_exp_f32 v65, v65
    v_exp_f32 v73, v73
    v_exp_f32 v66, v66
    v_exp_f32 v74, v74
    v_exp_f32 v67, v67
    v_exp_f32 v75, v75
    v_exp_f32 v68, v68
    v_exp_f32 v76, v76
    v_exp_f32 v69, v69
    v_exp_f32 v77, v77
    v_exp_f32 v70, v70
    v_exp_f32 v78, v78
    v_exp_f32 v71, v71
    v_exp_f32 v79, v79
    v_pk_add_f32 v[24:25], v[64:65], v[66:67]
    v_pk_add_f32 v[26:27], v[72:73], v[74:75]
    v_pk_add_f32 v[24:25], v[24:25], v[68:69]
    v_pk_add_f32 v[26:27], v[26:27], v[76:77]
    v_pk_add_f32 v[24:25], v[24:25], v[70:71]
    v_pk_add_f32 v[26:27], v[26:27], v[78:79]
    v_add_f32 v28, v24, v25
    v_add_f32 v29, v26, v27
    v_mov_b32 v25, v28
    v_mov_b32 v27, v29
    v_nop
    v_permlane32_swap_b32 v28, v25
    v_permlane32_swap_b32 v29, v27
    v_add_f32 v28, v28, v25
    v_add_f32 v29, v29, v27
    v_rcp_f32 v24, v28
    v_rcp_f32 v26, v29
    v_nop
    v_pk_mul_f32 v[64:65], v[64:65], v[24:25] op_sel_hi:[1,0]
    v_pk_mul_f32 v[72:73], v[72:73], v[26:27] op_sel_hi:[1,0]
    v_pk_mul_f32 v[66:67], v[66:67], v[24:25] op_sel_hi:[1,0]
    v_pk_mul_f32 v[74:75], v[74:75], v[26:27] op_sel_hi:[1,0]
    v_pk_mul_f32 v[68:69], v[68:69], v[24:25] op_sel_hi:[1,0]
    v_pk_mul_f32 v[76:77], v[76:77], v[26:27] op_sel_hi:[1,0]
    v_pk_mul_f32 v[70:71], v[70:71], v[24:25] op_sel_hi:[1,0]
    v_pk_mul_f32 v[78:79], v[78:79], v[26:27] op_sel_hi:[1,0]
    v_cvt_pk_bf16_f32 v32, v64, v65
    v_cvt_pk_bf16_f32 v36, v72, v73
    v_cvt_pk_bf16_f32 v33, v66, v67
    v_cvt_pk_bf16_f32 v37, v74, v75
    v_cvt_pk_bf16_f32 v34, v68, v69
    v_cvt_pk_bf16_f32 v38, v76, v77
    v_cvt_pk_bf16_f32 v35, v70, v71
    v_cvt_pk_bf16_f32 v39, v78, v79
    v_max3_f32 v24, v88, v89, v90
    v_min3_f32 v26, v88, v89, v90
    v_max3_f32 v24, v24, v91, v92
    v_min3_f32 v26, v26, v91, v92
    v_max3_f32 v24, v24, v93, v94
    v_min3_f32 v26, v26, v93, v94
    v_max_f32 v24, v24, v95
    v_min_f32 v26, v26, v95
    v_mov_b32 v25, v24
    v_mov_b32 v27, v26
    v_nop
    v_permlane32_swap_b32 v24, v25
    v_permlane32_swap_b32 v26, v27
    v_max_f32 v24, v24, v25
    v_min_f32 v26, v26, v27
    v_mul_f32 v24, s50, v24
    s_lshl_b32 s3, s2, 9
    s_add_u32 s3, s3, 64
    s_buffer_load_dword s4, s[32:35], s3 glc
    v_mul_f32 v26, s50, v26
    v_pk_fma_f32 v[64:65], v[88:89], s[50:51], v[24:25] op_sel_hi:[1,0,0] neg_lo:[0,0,1] neg_hi:[0,0,1]
    v_pk_fma_f32 v[72:73], v[88:89], s[50:51], v[26:27] op_sel_hi:[1,0,0] neg_lo:[1,0,0] neg_hi:[1,0,0]
    v_pk_fma_f32 v[66:67], v[90:91], s[50:51], v[24:25] op_sel_hi:[1,0,0] neg_lo:[0,0,1] neg_hi:[0,0,1]
    v_pk_fma_f32 v[74:75], v[90:91], s[50:51], v[26:27] op_sel_hi:[1,0,0] neg_lo:[1,0,0] neg_hi:[1,0,0]
    v_pk_fma_f32 v[68:69], v[92:93], s[50:51], v[24:25] op_sel_hi:[1,0,0] neg_lo:[0,0,1] neg_hi:[0,0,1]
    v_pk_fma_f32 v[76:77], v[92:93], s[50:51], v[26:27] op_sel_hi:[1,0,0] neg_lo:[1,0,0] neg_hi:[1,0,0]
    v_pk_fma_f32 v[70:71], v[94:95], s[50:51], v[24:25] op_sel_hi:[1,0,0] neg_lo:[0,0,1] neg_hi:[0,0,1]
    v_pk_fma_f32 v[78:79], v[94:95], s[50:51], v[26:27] op_sel_hi:[1,0,0] neg_lo:[1,0,0] neg_hi:[1,0,0]
    v_exp_f32 v64, v64
    v_exp_f32 v72, v72
    v_exp_f32 v65, v65
    v_exp_f32 v73, v73
    v_exp_f32 v66, v66
    v_exp_f32 v74, v74
    v_exp_f32 v67, v67
    v_exp_f32 v75, v75
    v_exp_f32 v68, v68
    v_exp_f32 v76, v76
    v_exp_f32 v69, v69
    v_exp_f32 v77, v77
    v_exp_f32 v70, v70
    v_exp_f32 v78, v78
    v_exp_f32 v71, v71
    v_exp_f32 v79, v79
    v_pk_add_f32 v[24:25], v[64:65], v[66:67]
    v_pk_add_f32 v[26:27], v[72:73], v[74:75]
    v_pk_add_f32 v[24:25], v[24:25], v[68:69]
    v_pk_add_f32 v[26:27], v[26:27], v[76:77]
    v_pk_add_f32 v[24:25], v[24:25], v[70:71]
    v_pk_add_f32 v[26:27], v[26:27], v[78:79]
    v_add_f32 v28, v24, v25
    v_add_f32 v29, v26, v27
    v_mov_b32 v25, v28
    v_mov_b32 v27, v29
    v_nop
    v_permlane32_swap_b32 v28, v25
    v_permlane32_swap_b32 v29, v27
    v_add_f32 v28, v28, v25
    v_add_f32 v29, v29, v27
    v_rcp_f32 v24, v28
    v_rcp_f32 v26, v29
    v_nop
    v_pk_mul_f32 v[64:65], v[64:65], v[24:25] op_sel_hi:[1,0]
    v_pk_mul_f32 v[72:73], v[72:73], v[26:27] op_sel_hi:[1,0]
    v_pk_mul_f32 v[66:67], v[66:67], v[24:25] op_sel_hi:[1,0]
    v_pk_mul_f32 v[74:75], v[74:75], v[26:27] op_sel_hi:[1,0]
    v_pk_mul_f32 v[68:69], v[68:69], v[24:25] op_sel_hi:[1,0]
    v_pk_mul_f32 v[76:77], v[76:77], v[26:27] op_sel_hi:[1,0]
    v_pk_mul_f32 v[70:71], v[70:71], v[24:25] op_sel_hi:[1,0]
    v_pk_mul_f32 v[78:79], v[78:79], v[26:27] op_sel_hi:[1,0]
    v_cvt_pk_bf16_f32 v40, v64, v65
    v_cvt_pk_bf16_f32 v44, v72, v73
    v_cvt_pk_bf16_f32 v41, v66, v67
    v_cvt_pk_bf16_f32 v45, v74, v75
    v_cvt_pk_bf16_f32 v42, v68, v69
    v_cvt_pk_bf16_f32 v46, v76, v77
    v_cvt_pk_bf16_f32 v43, v70, v71
    v_cvt_pk_bf16_f32 v47, v78, v79
    s_branch P1J_142
W23_141:
    s_barrier
    ds_read_b64_tr_b16 v[96:97], v13 offset:0
    ds_read_b64_tr_b16 v[98:99], v13 offset:512
    ds_read_b64_tr_b16 v[100:101], v13 offset:1024
    ds_read_b64_tr_b16 v[102:103], v13 offset:1536
    s_waitcnt lgkmcnt(2)
    v_mfma_f32_32x32x16_bf16 v[64:79], v[96:99], v[128:131], 0
    ds_read_b64_tr_b16 v[104:105], v13 offset:2048
    ds_read_b64_tr_b16 v[106:107], v13 offset:2560
    s_add_u32 s99, s65, 0
    s_add_u32 m0, s62, 0
    s_nop 0
    buffer_load_dwordx4 v7, s[20:23], s99 offen lds
    s_waitcnt lgkmcnt(2)
    v_mfma_f32_32x32x16_bf16 v[64:79], v[100:103], v[132:135], v[64:79]
    ds_read_b64_tr_b16 v[108:109], v13 offset:3072
    ds_read_b64_tr_b16 v[110:111], v13 offset:3584
    s_add_u32 s99, s65, 28672
    s_add_u32 m0, s62, 1024
    s_nop 0
    buffer_load_dwordx4 v7, s[20:23], s99 offen lds
    s_waitcnt lgkmcnt(2)
    v_mfma_f32_32x32x16_bf16 v[64:79], v[104:107], v[136:139], v[64:79]
    ds_read_b64_tr_b16 v[96:97], v13 offset:4096
    ds_read_b64_tr_b16 v[98:99], v13 offset:4608
    s_add_u32 s99, s65, 57344
    s_add_u32 m0, s62, 2048
    s_nop 0
    buffer_load_dwordx4 v7, s[20:23], s99 offen lds
    s_waitcnt lgkmcnt(2)
    v_mfma_f32_32x32x16_bf16 v[64:79], v[108:111], v[140:143], v[64:79]
    ds_read_b64_tr_b16 v[100:101], v13 offset:5120
    ds_read_b64_tr_b16 v[102:103], v13 offset:5632
    s_add_u32 s99, s65, 86016
    s_add_u32 m0, s62, 3072
    s_nop 0
    buffer_load_dwordx4 v7, s[20:23], s99 offen lds
    s_waitcnt lgkmcnt(2)
    v_mfma_f32_32x32x16_bf16 v[64:79], v[96:99], v[144:147], v[64:79]
    ds_read_b64_tr_b16 v[104:105], v13 offset:6144
    ds_read_b64_tr_b16 v[106:107], v13 offset:6656
    s_add_u32 s99, s65, 114688
    s_add_u32 m0, s62, 4096
    s_nop 0
    buffer_load_dwordx4 v7, s[20:23], s99 offen lds
    s_waitcnt lgkmcnt(2)
    v_mfma_f32_32x32x16_bf16 v[64:79], v[100:103], v[148:151], v[64:79]
    ds_read_b64_tr_b16 v[108:109], v13 offset:7168
    ds_read_b64_tr_b16 v[110:111], v13 offset:7680
    s_add_u32 s99, s65, 143360
    s_add_u32 m0, s62, 5120
    s_nop 0
    buffer_load_dwordx4 v7, s[20:23], s99 offen lds
    s_waitcnt lgkmcnt(2)
    v_mfma_f32_32x32x16_bf16 v[64:79], v[104:107], v[152:155], v[64:79]
    ds_read_b64_tr_b16 v[96:97], v13 offset:8192
    ds_read_b64_tr_b16 v[98:99], v13 offset:8704
    s_add_u32 s99, s65, 172032
    s_add_u32 m0, s62, 6144
    s_nop 0
    buffer_load_dwordx4 v7, s[20:23], s99 offen lds
    s_waitcnt lgkmcnt(2)
    v_mfma_f32_32x32x16_bf16 v[64:79], v[108:111], v[156:159], v[64:79]
    ds_read_b64_tr_b16 v[100:101], v13 offset:9216
    ds_read_b64_tr_b16 v[102:103], v13 offset:9728
    s_add_u32 s99, s65, 200704
    s_add_u32 m0, s62, 7168
    s_nop 0
    buffer_load_dwordx4 v7, s[20:23], s99 offen lds
    s_waitcnt lgkmcnt(2)
    v_mfma_f32_32x32x16_bf16 v[64:79], v[96:99], v[160:163], v[64:79]
    ds_read_b64_tr_b16 v[104:105], v13 offset:10240
    ds_read_b64_tr_b16 v[106:107], v13 offset:10752
    s_sub_u32 s99, s63, 262144
    s_sub_u32 m0, s64, 32768
    s_nop 0
    buffer_load_dwordx4 v6, s[16:19], s99 offen lds
    s_waitcnt lgkmcnt(2)
    v_mfma_f32_32x32x16_bf16 v[64:79], v[100:103], v[164:167], v[64:79]
    ds_read_b64_tr_b16 v[108:109], v13 offset:11264
    ds_read_b64_tr_b16 v[110:111], v13 offset:11776
    s_waitcnt lgkmcnt(2)
    v_mfma_f32_32x32x16_bf16 v[64:79], v[104:107], v[168:171], v[64:79]
    ds_read_b64_tr_b16 v[96:97], v13 offset:12288
    ds_read_b64_tr_b16 v[98:99], v13 offset:12800
    s_sub_u32 s99, s63, 253952
    s_sub_u32 m0, s64, 31744
    s_nop 0
    buffer_load_dwordx4 v6, s[16:19], s99 offen lds
    s_waitcnt lgkmcnt(2)
    v_mfma_f32_32x32x16_bf16 v[64:79], v[108:111], v[172:175], v[64:79]
    ds_read_b64_tr_b16 v[100:101], v13 offset:13312
    ds_read_b64_tr_b16 v[102:103], v13 offset:13824
    s_waitcnt lgkmcnt(2)
    v_mfma_f32_32x32x16_bf16 v[64:79], v[96:99], v[176:179], v[64:79]
    ds_read_b64_tr_b16 v[104:105], v13 offset:14336
    ds_read_b64_tr_b16 v[106:107], v13 offset:14848
    s_sub_u32 s99, s63, 245760
    s_sub_u32 m0, s64, 30720
    s_nop 0
    buffer_load_dwordx4 v6, s[16:19], s99 offen lds
    s_waitcnt lgkmcnt(2)
    v_mfma_f32_32x32x16_bf16 v[64:79], v[100:103], v[180:183], v[64:79]
    ds_read_b64_tr_b16 v[108:109], v13 offset:15360
    ds_read_b64_tr_b16 v[110:111], v13 offset:15872
    s_waitcnt lgkmcnt(2)
    v_mfma_f32_32x32x16_bf16 v[64:79], v[104:107], v[184:187], v[64:79]
    ds_read_b64_tr_b16 v[96:97], v13 offset:16384
    ds_read_b64_tr_b16 v[98:99], v13 offset:16896
    s_sub_u32 s99, s63, 237568
    s_sub_u32 m0, s64, 29696
    s_nop 0
    buffer_load_dwordx4 v6, s[16:19], s99 offen lds
    s_waitcnt lgkmcnt(2)
    v_mfma_f32_32x32x16_bf16 v[64:79], v[108:111], v[188:191], v[64:79]
    ds_read_b64_tr_b16 v[100:101], v13 offset:17408
    ds_read_b64_tr_b16 v[102:103], v13 offset:17920
    s_waitcnt lgkmcnt(2)
    v_mfma_f32_32x32x16_bf16 v[64:79], v[96:99], v[192:195], v[64:79]
    ds_read_b64_tr_b16 v[104:105], v13 offset:18432
    ds_read_b64_tr_b16 v[106:107], v13 offset:18944
    s_sub_u32 s99, s63, 229376
    s_sub_u32 m0, s64, 28672
    s_nop 0
    buffer_load_dwordx4 v6, s[16:19], s99 offen lds
    s_waitcnt lgkmcnt(2)
    v_mfma_f32_32x32x16_bf16 v[64:79], v[100:103], v[196:199], v[64:79]
    ds_read_b64_tr_b16 v[108:109], v13 offset:19456
    ds_read_b64_tr_b16 v[110:111], v13 offset:19968
    s_waitcnt lgkmcnt(2)
    v_mfma_f32_32x32x16_bf16 v[64:79], v[104:107], v[200:203], v[64:79]
    ds_read_b64_tr_b16 v[96:97], v13 offset:20480
    ds_read_b64_tr_b16 v[98:99], v13 offset:20992
    s_sub_u32 s99, s63, 221184
    s_sub_u32 m0, s64, 27648
    s_nop 0
    buffer_load_dwordx4 v6, s[16:19], s99 offen lds
    s_waitcnt lgkmcnt(2)
    v_mfma_f32_32x32x16_bf16 v[64:79], v[108:111], v[204:207], v[64:79]
    ds_read_b64_tr_b16 v[100:101], v13 offset:21504
    ds_read_b64_tr_b16 v[102:103], v13 offset:22016
    s_waitcnt lgkmcnt(2)
    v_mfma_f32_32x32x16_bf16 v[64:79], v[96:99], v[208:211], v[64:79]
    ds_read_b64_tr_b16 v[104:105], v13 offset:22528
    ds_read_b64_tr_b16 v[106:107], v13 offset:23040
    s_sub_u32 s99, s63, 212992
    s_sub_u32 m0, s64, 26624
    s_nop 0
    buffer_load_dwordx4 v6, s[16:19], s99 offen lds
    s_waitcnt lgkmcnt(2)
    v_mfma_f32_32x32x16_bf16 v[64:79], v[100:103], v[212:215], v[64:79]
    ds_read_b64_tr_b16 v[108:109], v13 offset:23552
    ds_read_b64_tr_b16 v[110:111], v13 offset:24064
    s_waitcnt lgkmcnt(2)
    v_mfma_f32_32x32x16_bf16 v[64:79], v[104:107], v[216:219], v[64:79]
    ds_read_b64_tr_b16 v[96:97], v13 offset:24576
    ds_read_b64_tr_b16 v[98:99], v13 offset:25088
    s_sub_u32 s99, s63, 204800
    s_sub_u32 m0, s64, 25600
    s_nop 0
    buffer_load_dwordx4 v6, s[16:19], s99 offen lds
    s_waitcnt lgkmcnt(2)
    v_mfma_f32_32x32x16_bf16 v[64:79], v[108:111], v[220:223], v[64:79]
    ds_read_b64_tr_b16 v[100:101], v13 offset:25600
    ds_read_b64_tr_b16 v[102:103], v13 offset:26112
    s_waitcnt lgkmcnt(2)
    v_mfma_f32_32x32x16_bf16 v[64:79], v[96:99], v[224:227], v[64:79]
    ds_read_b64_tr_b16 v[104:105], v13 offset:26624
    ds_read_b64_tr_b16 v[106:107], v13 offset:27136
    s_waitcnt lgkmcnt(2)
    v_mfma_f32_32x32x16_bf16 v[64:79], v[100:103], v[228:231], v[64:79]
    ds_read_b64_tr_b16 v[108:109], v13 offset:27648
    ds_read_b64_tr_b16 v[110:111], v13 offset:28160
    s_waitcnt lgkmcnt(2)
    v_mfma_f32_32x32x16_bf16 v[64:79], v[104:107], v[232:235], v[64:79]
    ds_read_b64_tr_b16 v[96:97], v13 offset:28672
    ds_read_b64_tr_b16 v[98:99], v13 offset:29184
    s_waitcnt lgkmcnt(2)
    v_mfma_f32_32x32x16_bf16 v[64:79], v[108:111], v[236:239], v[64:79]
    ds_read_b64_tr_b16 v[100:101], v13 offset:29696
    ds_read_b64_tr_b16 v[102:103], v13 offset:30208
    s_waitcnt lgkmcnt(2)
    v_mfma_f32_32x32x16_bf16 v[64:79], v[96:99], v[240:243], v[64:79]
    ds_read_b64_tr_b16 v[104:105], v13 offset:30720
    ds_read_b64_tr_b16 v[106:107], v13 offset:31232
    s_waitcnt lgkmcnt(2)
    v_mfma_f32_32x32x16_bf16 v[64:79], v[100:103], v[244:247], v[64:79]
    ds_read_b64_tr_b16 v[108:109], v13 offset:31744
    ds_read_b64_tr_b16 v[110:111], v13 offset:32256
    s_waitcnt lgkmcnt(2)
    v_mfma_f32_32x32x16_bf16 v[64:79], v[104:107], v[248:251], v[64:79]
    s_waitcnt lgkmcnt(0)
    v_mfma_f32_32x32x16_bf16 v[64:79], v[108:111], v[252:255], v[64:79]
    v_mfma_f32_32x32x16_bf16 v[64:79], a[228:231], v[124:127], v[64:79]
    s_nop 11
    v_pk_mul_f32 v[64:65], v[64:65], v[20:21] op_sel:[0,1] op_sel_hi:[1,1]
    v_pk_mul_f32 v[66:67], v[66:67], v[20:21] op_sel:[0,1] op_sel_hi:[1,1]
    v_pk_mul_f32 v[68:69], v[68:69], v[20:21] op_sel:[0,1] op_sel_hi:[1,1]
    v_pk_mul_f32 v[70:71], v[70:71], v[20:21] op_sel:[0,1] op_sel_hi:[1,1]
    v_pk_mul_f32 v[72:73], v[72:73], v[20:21] op_sel:[0,1] op_sel_hi:[1,1]
    v_pk_mul_f32 v[74:75], v[74:75], v[20:21] op_sel:[0,1] op_sel_hi:[1,1]
    v_pk_mul_f32 v[76:77], v[76:77], v[20:21] op_sel:[0,1] op_sel_hi:[1,1]
    v_pk_mul_f32 v[78:79], v[78:79], v[20:21] op_sel:[0,1] op_sel_hi:[1,1]
    v_cvt_pk_bf16_f32 v96, v64, v65
    v_cvt_pk_bf16_f32 v97, v66, v67
    v_cvt_pk_bf16_f32 v98, v68, v69
    v_cvt_pk_bf16_f32 v99, v70, v71
    v_cvt_pk_bf16_f32 v100, v72, v73
    v_cvt_pk_bf16_f32 v101, v74, v75
    v_cvt_pk_bf16_f32 v102, v76, v77
    v_cvt_pk_bf16_f32 v103, v78, v79
    v_mfma_f32_32x32x16_bf16 v[80:95], a[248:251], v[96:99], 0
    s_nop 0
    v_mfma_f32_32x32x16_bf16 v[80:95], a[252:255], v[100:103], v[80:95]
    s_nop 11
    v_max3_f32 v24, v80, v81, v82
    v_min3_f32 v26, v80, v81, v82
    v_max3_f32 v24, v24, v83, v84
    v_min3_f32 v26, v26, v83, v84
    v_max3_f32 v24, v24, v85, v86
    v_min3_f32 v26, v26, v85, v86
    s_sub_u32 s99, s63, 196608
    s_sub_u32 m0, s64, 24576
    s_nop 0
    buffer_load_dwordx4 v6, s[16:19], s99 offen lds
    v_max_f32 v24, v24, v87
    v_min_f32 v26, v26, v87
    v_mov_b32 v25, v24
    v_mov_b32 v27, v26
    v_nop
    v_permlane32_swap_b32 v24, v25
    v_permlane32_swap_b32 v26, v27
    s_sub_u32 s99, s63, 188416
    s_sub_u32 m0, s64, 23552
    s_nop 0
    buffer_load_dwordx4 v6, s[16:19], s99 offen lds
    v_max_f32 v24, v24, v25
    v_min_f32 v26, v26, v27
    v_mul_f32 v24, s50, v24
    v_mul_f32 v26, s50, v26
    v_pk_fma_f32 v[64:65], v[80:81], s[50:51], v[24:25] op_sel_hi:[1,0,0] neg_lo:[0,0,1] neg_hi:[0,0,1]
    v_pk_fma_f32 v[72:73], v[80:81], s[50:51], v[26:27] op_sel_hi:[1,0,0] neg_lo:[1,0,0] neg_hi:[1,0,0]
    v_pk_fma_f32 v[66:67], v[82:83], s[50:51], v[24:25] op_sel_hi:[1,0,0] neg_lo:[0,0,1] neg_hi:[0,0,1]
    s_sub_u32 s99, s63, 180224
    s_sub_u32 m0, s64, 22528
    s_nop 0
    buffer_load_dwordx4 v6, s[16:19], s99 offen lds
    v_pk_fma_f32 v[74:75], v[82:83], s[50:51], v[26:27] op_sel_hi:[1,0,0] neg_lo:[1,0,0] neg_hi:[1,0,0]
    v_pk_fma_f32 v[68:69], v[84:85], s[50:51], v[24:25] op_sel_hi:[1,0,0] neg_lo:[0,0,1] neg_hi:[0,0,1]
    v_pk_fma_f32 v[76:77], v[84:85], s[50:51], v[26:27] op_sel_hi:[1,0,0] neg_lo:[1,0,0] neg_hi:[1,0,0]
    v_pk_fma_f32 v[70:71], v[86:87], s[50:51], v[24:25] op_sel_hi:[1,0,0] neg_lo:[0,0,1] neg_hi:[0,0,1]
    v_pk_fma_f32 v[78:79], v[86:87], s[50:51], v[26:27] op_sel_hi:[1,0,0] neg_lo:[1,0,0] neg_hi:[1,0,0]
    v_exp_f32 v64, v64
    v_exp_f32 v72, v72
    s_sub_u32 s99, s63, 172032
    s_sub_u32 m0, s64, 21504
    s_nop 0
    buffer_load_dwordx4 v6, s[16:19], s99 offen lds
    v_exp_f32 v65, v65
    v_exp_f32 v73, v73
    v_exp_f32 v66, v66
    v_exp_f32 v74, v74
    v_exp_f32 v67, v67
    v_exp_f32 v75, v75
    v_exp_f32 v68, v68
    s_sub_u32 s99, s63, 163840
    s_sub_u32 m0, s64, 20480
    s_nop 0
    buffer_load_dwordx4 v6, s[16:19], s99 offen lds
    v_exp_f32 v76, v76
    v_exp_f32 v69, v69
    v_exp_f32 v77, v77
    v_exp_f32 v70, v70
    v_exp_f32 v78, v78
    v_exp_f32 v71, v71
    v_exp_f32 v79, v79
    s_sub_u32 s99, s63, 155648
    s_sub_u32 m0, s64, 19456
    s_nop 0
    buffer_load_dwordx4 v6, s[16:19], s99 offen lds
    v_pk_add_f32 v[24:25], v[64:65], v[66:67]
    v_pk_add_f32 v[26:27], v[72:73], v[74:75]
    v_pk_add_f32 v[24:25], v[24:25], v[68:69]
    v_pk_add_f32 v[26:27], v[26:27], v[76:77]
    v_pk_add_f32 v[24:25], v[24:25], v[70:71]
    v_pk_add_f32 v[26:27], v[26:27], v[78:79]
    v_add_f32 v28, v24, v25
    s_sub_u32 s99, s63, 147456
    s_sub_u32 m0, s64, 18432
    s_nop 0
    buffer_load_dwordx4 v6, s[16:19], s99 offen lds
    v_add_f32 v29, v26, v27
    v_mov_b32 v25, v28
    v_mov_b32 v27, v29
    v_nop
    v_permlane32_swap_b32 v28, v25
    v_permlane32_swap_b32 v29, v27
    v_add_f32 v28, v28, v25
    s_sub_u32 s99, s63, 139264
    s_sub_u32 m0, s64, 17408
    s_nop 0
    buffer_load_dwordx4 v6, s[16:19], s99 offen lds
    v_add_f32 v29, v29, v27
    v_rcp_f32 v24, v28
    v_rcp_f32 v26, v29
    v_nop
    v_pk_mul_f32 v[64:65], v[64:65], v[24:25] op_sel_hi:[1,0]
    v_pk_mul_f32 v[72:73], v[72:73], v[26:27] op_sel_hi:[1,0]
    v_pk_mul_f32 v[66:67], v[66:67], v[24:25] op_sel_hi:[1,0]
    s_add_u32 s99, s63, 0
    s_add_u32 m0, s64, 0
    s_nop 0
    buffer_load_dwordx4 v6, s[16:19], s99 offen lds
    v_pk_mul_f32 v[74:75], v[74:75], v[26:27] op_sel_hi:[1,0]
    v_pk_mul_f32 v[68:69], v[68:69], v[24:25] op_sel_hi:[1,0]
    v_pk_mul_f32 v[76:77], v[76:77], v[26:27] op_sel_hi:[1,0]
    v_pk_mul_f32 v[70:71], v[70:71], v[24:25] op_sel_hi:[1,0]
    v_pk_mul_f32 v[78:79], v[78:79], v[26:27] op_sel_hi:[1,0]
    v_cvt_pk_bf16_f32 v32, v64, v65
    v_cvt_pk_bf16_f32 v36, v72, v73
    s_add_u32 s99, s63, 8192
    s_add_u32 m0, s64, 1024
    s_nop 0
    buffer_load_dwordx4 v6, s[16:19], s99 offen lds
    v_cvt_pk_bf16_f32 v33, v66, v67
    v_cvt_pk_bf16_f32 v37, v74, v75
    v_cvt_pk_bf16_f32 v34, v68, v69
    v_cvt_pk_bf16_f32 v38, v76, v77
    v_cvt_pk_bf16_f32 v35, v70, v71
    v_cvt_pk_bf16_f32 v39, v78, v79
    v_max3_f32 v24, v88, v89, v90
    s_add_u32 s99, s63, 16384
    s_add_u32 m0, s64, 2048
    s_nop 0
    buffer_load_dwordx4 v6, s[16:19], s99 offen lds
    v_min3_f32 v26, v88, v89, v90
    v_max3_f32 v24, v24, v91, v92
    v_min3_f32 v26, v26, v91, v92
    v_max3_f32 v24, v24, v93, v94
    v_min3_f32 v26, v26, v93, v94
    v_max_f32 v24, v24, v95
    v_min_f32 v26, v26, v95
    s_add_u32 s99, s63, 24576
    s_add_u32 m0, s64, 3072
    s_nop 0
    buffer_load_dwordx4 v6, s[16:19], s99 offen lds
    v_mov_b32 v25, v24
    v_mov_b32 v27, v26
    v_nop
    v_permlane32_swap_b32 v24, v25
    v_permlane32_swap_b32 v26, v27
    v_max_f32 v24, v24, v25
    v_min_f32 v26, v26, v27
    s_add_u32 s99, s63, 32768
    s_add_u32 m0, s64, 4096
    s_nop 0
    buffer_load_dwordx4 v6, s[16:19], s99 offen lds
    v_mul_f32 v24, s50, v24
    s_lshl_b32 s3, s2, 9
    s_add_u32 s3, s3, 64
    s_buffer_load_dword s4, s[32:35], s3 glc
    v_mul_f32 v26, s50, v26
    v_pk_fma_f32 v[64:65], v[88:89], s[50:51], v[24:25] op_sel_hi:[1,0,0] neg_lo:[0,0,1] neg_hi:[0,0,1]
    v_pk_fma_f32 v[72:73], v[88:89], s[50:51], v[26:27] op_sel_hi:[1,0,0] neg_lo:[1,0,0] neg_hi:[1,0,0]
    v_pk_fma_f32 v[66:67], v[90:91], s[50:51], v[24:25] op_sel_hi:[1,0,0] neg_lo:[0,0,1] neg_hi:[0,0,1]
    v_pk_fma_f32 v[74:75], v[90:91], s[50:51], v[26:27] op_sel_hi:[1,0,0] neg_lo:[1,0,0] neg_hi:[1,0,0]
    v_pk_fma_f32 v[68:69], v[92:93], s[50:51], v[24:25] op_sel_hi:[1,0,0] neg_lo:[0,0,1] neg_hi:[0,0,1]
    s_add_u32 s99, s63, 40960
    s_add_u32 m0, s64, 5120
    s_nop 0
    buffer_load_dwordx4 v6, s[16:19], s99 offen lds
    v_pk_fma_f32 v[76:77], v[92:93], s[50:51], v[26:27] op_sel_hi:[1,0,0] neg_lo:[1,0,0] neg_hi:[1,0,0]
    v_pk_fma_f32 v[70:71], v[94:95], s[50:51], v[24:25] op_sel_hi:[1,0,0] neg_lo:[0,0,1] neg_hi:[0,0,1]
    v_pk_fma_f32 v[78:79], v[94:95], s[50:51], v[26:27] op_sel_hi:[1,0,0] neg_lo:[1,0,0] neg_hi:[1,0,0]
    v_exp_f32 v64, v64
    v_exp_f32 v72, v72
    v_exp_f32 v65, v65
    v_exp_f32 v73, v73
    s_add_u32 s99, s63, 49152
    s_add_u32 m0, s64, 6144
    s_nop 0
    buffer_load_dwordx4 v6, s[16:19], s99 offen lds
    v_exp_f32 v66, v66
    v_exp_f32 v74, v74
    v_exp_f32 v67, v67
    v_exp_f32 v75, v75
    v_exp_f32 v68, v68
    v_exp_f32 v76, v76
    v_exp_f32 v69, v69
    s_add_u32 s99, s63, 57344
    s_add_u32 m0, s64, 7168
    s_nop 0
    buffer_load_dwordx4 v6, s[16:19], s99 offen lds
    v_exp_f32 v77, v77
    v_exp_f32 v70, v70
    v_exp_f32 v78, v78
    v_exp_f32 v71, v71
    v_exp_f32 v79, v79
    v_pk_add_f32 v[24:25], v[64:65], v[66:67]
    v_pk_add_f32 v[26:27], v[72:73], v[74:75]
    s_add_u32 s99, s63, 65536
    s_add_u32 m0, s64, 8192
    s_nop 0
    buffer_load_dwordx4 v6, s[16:19], s99 offen lds
    v_pk_add_f32 v[24:25], v[24:25], v[68:69]
    v_pk_add_f32 v[26:27], v[26:27], v[76:77]
    v_pk_add_f32 v[24:25], v[24:25], v[70:71]
    v_pk_add_f32 v[26:27], v[26:27], v[78:79]
    v_add_f32 v28, v24, v25
    v_add_f32 v29, v26, v27
    v_mov_b32 v25, v28
    s_add_u32 s99, s63, 73728
    s_add_u32 m0, s64, 9216
    s_nop 0
    buffer_load_dwordx4 v6, s[16:19], s99 offen lds
    v_mov_b32 v27, v29
    v_nop
    v_permlane32_swap_b32 v28, v25
    v_permlane32_swap_b32 v29, v27
    v_add_f32 v28, v28, v25
    v_add_f32 v29, v29, v27
    v_rcp_f32 v24, v28
    s_add_u32 s99, s63, 81920
    s_add_u32 m0, s64, 10240
    s_nop 0
    buffer_load_dwordx4 v6, s[16:19], s99 offen lds
    v_rcp_f32 v26, v29
    v_nop
    v_pk_mul_f32 v[64:65], v[64:65], v[24:25] op_sel_hi:[1,0]
    v_pk_mul_f32 v[72:73], v[72:73], v[26:27] op_sel_hi:[1,0]
    v_pk_mul_f32 v[66:67], v[66:67], v[24:25] op_sel_hi:[1,0]
    v_pk_mul_f32 v[74:75], v[74:75], v[26:27] op_sel_hi:[1,0]
    v_pk_mul_f32 v[68:69], v[68:69], v[24:25] op_sel_hi:[1,0]
    s_add_u32 s99, s63, 90112
    s_add_u32 m0, s64, 11264
    s_nop 0
    buffer_load_dwordx4 v6, s[16:19], s99 offen lds
    v_pk_mul_f32 v[76:77], v[76:77], v[26:27] op_sel_hi:[1,0]
    v_pk_mul_f32 v[70:71], v[70:71], v[24:25] op_sel_hi:[1,0]
    v_pk_mul_f32 v[78:79], v[78:79], v[26:27] op_sel_hi:[1,0]
    v_cvt_pk_bf16_f32 v40, v64, v65
    v_cvt_pk_bf16_f32 v44, v72, v73
    v_cvt_pk_bf16_f32 v41, v66, v67
    v_cvt_pk_bf16_f32 v45, v74, v75
    s_add_u32 s99, s63, 98304
    s_add_u32 m0, s64, 12288
    s_nop 0
    buffer_load_dwordx4 v6, s[16:19], s99 offen lds
    v_cvt_pk_bf16_f32 v42, v68, v69
    v_cvt_pk_bf16_f32 v46, v76, v77
    v_cvt_pk_bf16_f32 v43, v70, v71
    v_cvt_pk_bf16_f32 v47, v78, v79
    s_add_u32 s99, s63, 106496
    s_add_u32 m0, s64, 13312
    s_nop 0
    buffer_load_dwordx4 v6, s[16:19], s99 offen lds
    s_add_u32 s99, s63, 114688
    s_add_u32 m0, s64, 14336
    s_nop 0
    buffer_load_dwordx4 v6, s[16:19], s99 offen lds
    s_add_u32 s99, s63, 122880
    s_add_u32 m0, s64, 15360
    s_nop 0
    buffer_load_dwordx4 v6, s[16:19], s99 offen lds
P1J_142:
    s_waitcnt lgkmcnt(0)
    s_cmp_ge_u32 s4, 32
    s_cbranch_scc1 PD_144
    s_mov_b32 s60, 0
PL_143:
    s_buffer_load_dword s4, s[32:35], s3 glc
    s_add_u32 s60, s60, 1
    s_cmp_gt_u32 s60, 0x80000
    s_cbranch_scc1 L_bail
    s_waitcnt lgkmcnt(0)
    s_cmp_lt_u32 s4, 32
    s_cbranch_scc1 PL_143
PD_144:
    s_mul_i32 s74, s46, 69632
    s_add_u32 s74, s74, 1703936
    v_lshlrev_b32 v26, 4, v0
    s_cmp_lg_u32 s44, 3
    s_cbranch_scc1 NOEX_145
    v_lshrrev_b32 v27, 4, v1
    v_mul_u32_u24 v27, 17408, v27
    v_and_b32 v28, 15, v1
    v_lshl_add_u32 v27, v28, 4, v27
    s_add_u32 s98, s74, 4096
    buffer_load_dwordx4 v[192:195], v27, s[32:35], s98 offen sc1
    s_add_u32 s98, s74, 8448
    buffer_load_dwordx4 v[196:199], v27, s[32:35], s98 offen sc1
    s_add_u32 s98, s74, 12800
    buffer_load_dwordx4 v[200:203], v27, s[32:35], s98 offen sc1
    s_add_u32 s98, s74, 17152
    buffer_load_dwordx4 v[204:207], v27, s[32:35], s98 offen sc1
NOEX_145:
    s_add_u32 s98, s74, 0
    buffer_load_dwordx4 v[128:131], v26, s[32:35], s98 offen sc1
    s_add_u32 s98, s74, 4352
    buffer_load_dwordx4 v[132:135], v26, s[32:35], s98 offen sc1
    s_add_u32 s98, s74, 8704
    buffer_load_dwordx4 v[136:139], v26, s[32:35], s98 offen sc1
    s_add_u32 s98, s74, 13056
    buffer_load_dwordx4 v[140:143], v26, s[32:35], s98 offen sc1
    s_add_u32 s98, s74, 17408
    buffer_load_dwordx4 v[144:147], v26, s[32:35], s98 offen sc1
    s_add_u32 s98, s74, 21760
    buffer_load_dwordx4 v[148:151], v26, s[32:35], s98 offen sc1
    s_add_u32 s98, s74, 26112
    buffer_load_dwordx4 v[152:155], v26, s[32:35], s98 offen sc1
    s_add_u32 s98, s74, 30464
    buffer_load_dwordx4 v[156:159], v26, s[32:35], s98 offen sc1
    s_add_u32 s98, s74, 34816
    buffer_load_dwordx4 v[160:163], v26, s[32:35], s98 offen sc1
    s_add_u32 s98, s74, 39168
    buffer_load_dwordx4 v[164:167], v26, s[32:35], s98 offen sc1
    s_add_u32 s98, s74, 43520
    buffer_load_dwordx4 v[168:171], v26, s[32:35], s98 offen sc1
    s_add_u32 s98, s74, 47872
    buffer_load_dwordx4 v[172:175], v26, s[32:35], s98 offen sc1
    s_add_u32 s98, s74, 52224
    buffer_load_dwordx4 v[176:179], v26, s[32:35], s98 offen sc1
    s_add_u32 s98, s74, 56576
    buffer_load_dwordx4 v[180:183], v26, s[32:35], s98 offen sc1
    s_add_u32 s98, s74, 60928
    buffer_load_dwordx4 v[184:187], v26, s[32:35], s98 offen sc1
    s_add_u32 s98, s74, 65280
    buffer_load_dwordx4 v[188:191], v26, s[32:35], s98 offen sc1
    s_cmp_lg_u32 s44, 3
    s_cbranch_scc1 NOEX2_146
    s_waitcnt vmcnt(18)
    v_add_f32 v192, v192, v196
    v_add_f32 v193, v193, v197
    v_add_f32 v194, v194, v198
    v_add_f32 v195, v195, v199
    s_waitcnt vmcnt(17)
    v_add_f32 v192, v192, v200
    v_add_f32 v193, v193, v201
    v_add_f32 v194, v194, v202
    v_add_f32 v195, v195, v203
    s_waitcnt vmcnt(16)
    v_add_f32 v192, v192, v204
    v_add_f32 v193, v193, v205
    v_add_f32 v194, v194, v206
    v_add_f32 v195, v195, v207
    v_mov_b32 v196, v192
    v_mov_b32 v197, v193
    v_mov_b32 v198, v194
    v_mov_b32 v199, v195
    v_permlane32_swap_b32 v192, v196
    v_permlane32_swap_b32 v193, v197
    v_permlane32_swap_b32 v194, v198
    v_permlane32_swap_b32 v195, v199
    v_add_f32 v192, v192, v196
    v_add_f32 v193, v193, v197
    v_add_f32 v194, v194, v198
    v_add_f32 v195, v195, v199
    v_mov_b32 v196, v192
    v_mov_b32 v197, v193
    v_mov_b32 v198, v194
    v_mov_b32 v199, v195
    v_permlane16_swap_b32 v192, v196
    v_permlane16_swap_b32 v193, v197
    v_permlane16_swap_b32 v194, v198
    v_permlane16_swap_b32 v195, v199
    v_add_f32 v192, v192, v196
    v_add_f32 v193, v193, v197
    v_add_f32 v194, v194, v198
    v_add_f32 v195, v195, v199
    v_cvt_pk_bf16_f32 v196, v192, v193
    v_cvt_pk_bf16_f32 v197, v194, v195
    v_add_u32 v27, 34696, v4
    s_mov_b64 s[58:59], exec
    s_mov_b32 exec_lo, 0xffff
    s_mov_b32 exec_hi, 0
    ds_write_b64 v27, v[196:197]
    s_mov_b64 exec, s[58:59]
NOEX2_146:
    s_waitcnt vmcnt(14)
    v_add_f32 v128, v128, v132
    v_add_f32 v129, v129, v133
    v_add_f32 v130, v130, v134
    v_add_f32 v131, v131, v135
    s_waitcnt vmcnt(13)
    v_add_f32 v128, v128, v136
    v_add_f32 v129, v129, v137
    v_add_f32 v130, v130, v138
    v_add_f32 v131, v131, v139
    s_waitcnt vmcnt(12)
    v_add_f32 v128, v128, v140
    v_add_f32 v129, v129, v141
    v_add_f32 v130, v130, v142
    v_add_f32 v131, v131, v143
    s_waitcnt vmcnt(11)
    v_add_f32 v128, v128, v144
    v_add_f32 v129, v129, v145
    v_add_f32 v130, v130, v146
    v_add_f32 v131, v131, v147
    s_waitcnt vmcnt(10)
    v_add_f32 v128, v128, v148
    v_add_f32 v129, v129, v149
    v_add_f32 v130, v130, v150
    v_add_f32 v131, v131, v151
    s_waitcnt vmcnt(9)
    v_add_f32 v128, v128, v152
    v_add_f32 v129, v129, v153
    v_add_f32 v130, v130, v154
    v_add_f32 v131, v131, v155
    s_waitcnt vmcnt(8)
    v_add_f32 v128, v128, v156
    v_add_f32 v129, v129, v157
    v_add_f32 v130, v130, v158
    v_add_f32 v131, v131, v159
    s_waitcnt vmcnt(7)
    v_add_f32 v128, v128, v160
    v_add_f32 v129, v129, v161
    v_add_f32 v130, v130, v162
    v_add_f32 v131, v131, v163
    s_waitcnt vmcnt(6)
    v_add_f32 v128, v128, v164
    v_add_f32 v129, v129, v165
    v_add_f32 v130, v130, v166
    v_add_f32 v131, v131, v167
    s_waitcnt vmcnt(5)
    v_add_f32 v128, v128, v168
    v_add_f32 v129, v129, v169
    v_add_f32 v130, v130, v170
    v_add_f32 v131, v131, v171
    s_waitcnt vmcnt(4)
    v_add_f32 v128, v128, v172
    v_add_f32 v129, v129, v173
    v_add_f32 v130, v130, v174
    v_add_f32 v131, v131, v175
    s_waitcnt vmcnt(3)
    v_add_f32 v128, v128, v176
    v_add_f32 v129, v129, v177
    v_add_f32 v130, v130, v178
    v_add_f32 v131, v131, v179
    s_waitcnt vmcnt(2)
    v_add_f32 v128, v128, v180
    v_add_f32 v129, v129, v181
    v_add_f32 v130, v130, v182
    v_add_f32 v131, v131, v183
    s_waitcnt vmcnt(1)
    v_add_f32 v128, v128, v184
    v_add_f32 v129, v129, v185
    v_add_f32 v130, v130, v186
    v_add_f32 v131, v131, v187
    s_waitcnt vmcnt(0)
    v_add_f32 v128, v128, v188
    v_add_f32 v129, v129, v189
    v_add_f32 v130, v130, v190
    v_add_f32 v131, v131, v191
    v_cvt_pk_bf16_f32 v132, v128, v129
    v_cvt_pk_bf16_f32 v133, v130, v131
    v_accvgpr_read_b32 v26, a239
    ds_write_b64 v26, v[132:133]
    s_waitcnt lgkmcnt(0)
    s_barrier
    v_accvgpr_read_b32 v26, a237
    ds_read_b128 v[96:99], v26 offset:0
    ds_read_b128 v[100:103], v26 offset:544
    ds_read_b128 v[104:107], v26 offset:1088
    ds_read_b128 v[108:111], v26 offset:1632
    s_waitcnt lgkmcnt(3)
    v_mfma_f32_32x32x16_bf16 v[64:79], v[96:99], v[32:35], 0
    s_waitcnt lgkmcnt(1)
    v_mfma_f32_32x32x16_bf16 v[80:95], v[104:107], v[40:43], 0
    v_mfma_f32_32x32x16_bf16 v[64:79], v[100:103], v[36:39], v[64:79]
    s_waitcnt lgkmcnt(0)
    v_mfma_f32_32x32x16_bf16 v[80:95], v[108:111], v[44:47], v[80:95]
    s_barrier
    s_lshl_b32 s75, s71, 15
    s_lshl_b32 s76, s46, 11
    s_add_u32 s75, s75, s76
    s_add_u32 s75, s75, 6291456
    s_nop 4
    v_add_f32 v26, s53, v72
    v_rcp_f32 v26, v26
    v_add_f32 v27, s53, v88
    v_rcp_f32 v27, v27
    v_mul_f32 v64, v64, v26
    v_mul_f32 v65, v65, v26
    v_mul_f32 v66, v66, v26
    v_mul_f32 v67, v67, v26
    v_mul_f32 v68, v68, v26
    v_mul_f32 v69, v69, v26
    v_mul_f32 v70, v70, v26
    v_mul_f32 v71, v71, v26
    v_cvt_pk_bf16_f32 v128, v64, v65
    v_cvt_pk_bf16_f32 v129, v66, v67
    v_cvt_pk_bf16_f32 v130, v68, v69
    v_cvt_pk_bf16_f32 v131, v70, v71
    buffer_store_dwordx4 v[128:131], v4, s[32:35], s75 offen offset:0 sc1
    v_mul_f32 v80, v80, v27
    v_mul_f32 v81, v81, v27
    v_mul_f32 v82, v82, v27
    v_mul_f32 v83, v83, v27
    v_mul_f32 v84, v84, v27
    v_mul_f32 v85, v85, v27
    v_mul_f32 v86, v86, v27
    v_mul_f32 v87, v87, v27
    v_cvt_pk_bf16_f32 v132, v80, v81
    v_cvt_pk_bf16_f32 v133, v82, v83
    v_cvt_pk_bf16_f32 v134, v84, v85
    v_cvt_pk_bf16_f32 v135, v86, v87
    buffer_store_dwordx4 v[132:135], v4, s[32:35], s75 offen offset:1024 sc1
    s_waitcnt vmcnt(0)
    v_accvgpr_read_b32 v25, a235
    s_mov_b64 s[58:59], exec
    s_mov_b32 exec_lo, 255
    s_mov_b32 exec_hi, 0
    v_mov_b32 v24, 1
    buffer_atomic_add v24, v25, s[32:35], 0 offen offset:68 sc1
    s_mov_b64 exec, s[58:59]
    s_lshl_b32 s78, s72, 15
    s_and_b32 s75, s44, 1
    s_lshl_b32 s75, s75, 14
    s_add_u32 s78, s78, s75
    s_add_u32 s78, s78, 6291456
    s_lshl_b32 s75, s75, 1
    s_add_u32 s75, s75, 98304
    v_add_u32 v112, s75, v14
    v_add_u32 v113, s75, v15
    s_add_u32 s3, s70, 68
    s_buffer_load_dword s4, s[32:35], s3 glc
    s_waitcnt lgkmcnt(0)
    s_cmp_ge_u32 s4, 8
    s_cbranch_scc1 PD_148
    s_mov_b32 s60, 0
PL_147:
    s_buffer_load_dword s4, s[32:35], s3 glc
    s_add_u32 s60, s60, 1
    s_cmp_gt_u32 s60, 0x80000
    s_cbranch_scc1 L_bail
    s_waitcnt lgkmcnt(0)
    s_cmp_lt_u32 s4, 8
    s_cbranch_scc1 PL_147
PD_148:
    s_add_u32 s98, s78, 0
    buffer_load_dwordx4 a[0:3], v4, s[32:35], s98 offen offset:0 sc1
    s_add_u32 s98, s78, 0
    buffer_load_dwordx4 a[4:7], v4, s[32:35], s98 offen offset:1024 sc1
    s_add_u32 s98, s78, 0
    buffer_load_dwordx4 a[8:11], v4, s[32:35], s98 offen offset:2048 sc1
    s_add_u32 s98, s78, 0
    buffer_load_dwordx4 a[12:15], v4, s[32:35], s98 offen offset:3072 sc1
    s_add_u32 s98, s78, 4096
    buffer_load_dwordx4 a[16:19], v4, s[32:35], s98 offen offset:0 sc1
    s_add_u32 s98, s78, 4096
    buffer_load_dwordx4 a[20:23], v4, s[32:35], s98 offen offset:1024 sc1
    s_add_u32 s98, s78, 4096
    buffer_load_dwordx4 a[24:27], v4, s[32:35], s98 offen offset:2048 sc1
    s_add_u32 s98, s78, 4096
    buffer_load_dwordx4 a[28:31], v4, s[32:35], s98 offen offset:3072 sc1
    s_add_u32 s98, s78, 8192
    buffer_load_dwordx4 a[32:35], v4, s[32:35], s98 offen offset:0 sc1
    s_add_u32 s98, s78, 8192
    buffer_load_dwordx4 a[36:39], v4, s[32:35], s98 offen offset:1024 sc1
    ds_read_b64_tr_b16 v[64:65], v112 offset:0
    ds_read_b64_tr_b16 v[66:67], v112 offset:1024
    ds_read_b64_tr_b16 v[68:69], v113 offset:0
    ds_read_b64_tr_b16 v[70:71], v113 offset:1024
    ds_read_b64_tr_b16 v[72:73], v112 offset:2048
    ds_read_b64_tr_b16 v[74:75], v112 offset:3072
    ds_read_b64_tr_b16 v[76:77], v113 offset:2048
    ds_read_b64_tr_b16 v[78:79], v113 offset:3072
    s_waitcnt vmcnt(9) lgkmcnt(6)
    v_mfma_f32_32x32x16_bf16 v[32:47], v[64:67], a[0:3], 0
    ds_read_b64_tr_b16 v[80:81], v112 offset:4096
    ds_read_b64_tr_b16 v[82:83], v112 offset:5120
    s_add_u32 s98, s78, 8192
    buffer_load_dwordx4 a[40:43], v4, s[32:35], s98 offen offset:2048 sc1
    s_waitcnt lgkmcnt(6)
    v_mfma_f32_32x32x16_bf16 v[48:63], v[68:71], a[0:3], 0
    ds_read_b64_tr_b16 v[84:85], v113 offset:4096
    ds_read_b64_tr_b16 v[86:87], v113 offset:5120
    s_waitcnt vmcnt(9) lgkmcnt(6)
    v_mfma_f32_32x32x16_bf16 v[32:47], v[72:75], a[4:7], v[32:47]
    ds_read_b64_tr_b16 v[64:65], v112 offset:6144
    ds_read_b64_tr_b16 v[66:67], v112 offset:7168
    s_add_u32 s98, s78, 8192
    buffer_load_dwordx4 a[44:47], v4, s[32:35], s98 offen offset:3072 sc1
    s_waitcnt lgkmcnt(6)
    v_mfma_f32_32x32x16_bf16 v[48:63], v[76:79], a[4:7], v[48:63]
    ds_read_b64_tr_b16 v[68:69], v113 offset:6144
    ds_read_b64_tr_b16 v[70:71], v113 offset:7168
    s_waitcnt vmcnt(9) lgkmcnt(6)
    v_mfma_f32_32x32x16_bf16 v[32:47], v[80:83], a[8:11], v[32:47]
    ds_read_b64_tr_b16 v[72:73], v112 offset:8192
    ds_read_b64_tr_b16 v[74:75], v112 offset:9216
    s_add_u32 s98, s78, 12288
    buffer_load_dwordx4 a[48:51], v4, s[32:35], s98 offen offset:0 sc1
    s_waitcnt lgkmcnt(6)
    v_mfma_f32_32x32x16_bf16 v[48:63], v[84:87], a[8:11], v[48:63]
    ds_read_b64_tr_b16 v[76:77], v113 offset:8192
    ds_read_b64_tr_b16 v[78:79], v113 offset:9216
    s_waitcnt vmcnt(9) lgkmcnt(6)
    v_mfma_f32_32x32x16_bf16 v[32:47], v[64:67], a[12:15], v[32:47]
    ds_read_b64_tr_b16 v[80:81], v112 offset:10240
    ds_read_b64_tr_b16 v[82:83], v112 offset:11264
    s_add_u32 s98, s78, 12288
    buffer_load_dwordx4 a[52:55], v4, s[32:35], s98 offen offset:1024 sc1
    s_waitcnt lgkmcnt(6)
    v_mfma_f32_32x32x16_bf16 v[48:63], v[68:71], a[12:15], v[48:63]
    ds_read_b64_tr_b16 v[84:85], v113 offset:10240
    ds_read_b64_tr_b16 v[86:87], v113 offset:11264
    s_waitcnt vmcnt(9) lgkmcnt(6)
    v_mfma_f32_32x32x16_bf16 v[32:47], v[72:75], a[16:19], v[32:47]
    ds_read_b64_tr_b16 v[64:65], v112 offset:12288
    ds_read_b64_tr_b16 v[66:67], v112 offset:13312
    s_add_u32 s98, s78, 12288
    buffer_load_dwordx4 a[56:59], v4, s[32:35], s98 offen offset:2048 sc1
    s_waitcnt lgkmcnt(6)
    v_mfma_f32_32x32x16_bf16 v[48:63], v[76:79], a[16:19], v[48:63]
    ds_read_b64_tr_b16 v[68:69], v113 offset:12288
    ds_read_b64_tr_b16 v[70:71], v113 offset:13312
    v_accvgpr_read_b32 v193, a240
    v_lshlrev_b32 v192, 16, v193
    s_waitcnt vmcnt(9) lgkmcnt(6)
    v_mfma_f32_32x32x16_bf16 v[32:47], v[80:83], a[20:23], v[32:47]
    ds_read_b64_tr_b16 v[72:73], v112 offset:14336
    ds_read_b64_tr_b16 v[74:75], v112 offset:15360
    s_add_u32 s98, s78, 12288
    buffer_load_dwordx4 a[60:63], v4, s[32:35], s98 offen offset:3072 sc1
    s_waitcnt lgkmcnt(6)
    v_mfma_f32_32x32x16_bf16 v[48:63], v[84:87], a[20:23], v[48:63]
    ds_read_b64_tr_b16 v[76:77], v113 offset:14336
    ds_read_b64_tr_b16 v[78:79], v113 offset:15360
    v_and_b32 v193, 0xffff0000, v193
    v_accvgpr_read_b32 v195, a241
    s_waitcnt vmcnt(9) lgkmcnt(6)
    v_mfma_f32_32x32x16_bf16 v[32:47], v[64:67], a[24:27], v[32:47]
    ds_read_b64_tr_b16 v[80:81], v112 offset:16384
    ds_read_b64_tr_b16 v[82:83], v112 offset:17408
    s_waitcnt lgkmcnt(6)
    v_mfma_f32_32x32x16_bf16 v[48:63], v[68:71], a[24:27], v[48:63]
    ds_read_b64_tr_b16 v[84:85], v113 offset:16384
    ds_read_b64_tr_b16 v[86:87], v113 offset:17408
    v_lshlrev_b32 v194, 16, v195
    v_and_b32 v195, 0xffff0000, v195
    s_add_u32 s99, s65, 917504
    s_add_u32 m0, s62, 65536
    s_nop 0
    buffer_load_dwordx4 v7, s[20:23], s99 offen lds
    s_waitcnt vmcnt(9) lgkmcnt(6)
    v_mfma_f32_32x32x16_bf16 v[32:47], v[72:75], a[28:31], v[32:47]
    ds_read_b64_tr_b16 v[64:65], v112 offset:18432
    ds_read_b64_tr_b16 v[66:67], v112 offset:19456
    s_waitcnt lgkmcnt(6)
    v_mfma_f32_32x32x16_bf16 v[48:63], v[76:79], a[28:31], v[48:63]
    ds_read_b64_tr_b16 v[68:69], v113 offset:18432
    ds_read_b64_tr_b16 v[70:71], v113 offset:19456
    v_accvgpr_read_b32 v197, a242
    v_lshlrev_b32 v196, 16, v197
    s_add_u32 s99, s65, 946176
    s_add_u32 m0, s62, 66560
    s_nop 0
    buffer_load_dwordx4 v7, s[20:23], s99 offen lds
    s_waitcnt vmcnt(9) lgkmcnt(6)
    v_mfma_f32_32x32x16_bf16 v[32:47], v[80:83], a[32:35], v[32:47]
    ds_read_b64_tr_b16 v[72:73], v112 offset:20480
    ds_read_b64_tr_b16 v[74:75], v112 offset:21504
    s_waitcnt lgkmcnt(6)
    v_mfma_f32_32x32x16_bf16 v[48:63], v[84:87], a[32:35], v[48:63]
    ds_read_b64_tr_b16 v[76:77], v113 offset:20480
    ds_read_b64_tr_b16 v[78:79], v113 offset:21504
    v_and_b32 v197, 0xffff0000, v197
    v_accvgpr_read_b32 v199, a243
    s_add_u32 s99, s65, 974848
    s_add_u32 m0, s62, 67584
    s_nop 0
    buffer_load_dwordx4 v7, s[20:23], s99 offen lds
    s_waitcnt vmcnt(9) lgkmcnt(6)
    v_mfma_f32_32x32x16_bf16 v[32:47], v[64:67], a[36:39], v[32:47]
    ds_read_b64_tr_b16 v[80:81], v112 offset:22528
    ds_read_b64_tr_b16 v[82:83], v112 offset:23552
    s_waitcnt lgkmcnt(6)
    v_mfma_f32_32x32x16_bf16 v[48:63], v[68:71], a[36:39], v[48:63]
    ds_read_b64_tr_b16 v[84:85], v113 offset:22528
    ds_read_b64_tr_b16 v[86:87], v113 offset:23552
    v_lshlrev_b32 v198, 16, v199
    v_and_b32 v199, 0xffff0000, v199
    s_add_u32 s99, s65, 1003520
    s_add_u32 m0, s62, 68608
    s_nop 0
    buffer_load_dwordx4 v7, s[20:23], s99 offen lds
    s_waitcnt vmcnt(9) lgkmcnt(6)
    v_mfma_f32_32x32x16_bf16 v[32:47], v[72:75], a[40:43], v[32:47]
    ds_read_b64_tr_b16 v[64:65], v112 offset:24576
    ds_read_b64_tr_b16 v[66:67], v112 offset:25600
    s_waitcnt lgkmcnt(6)
    v_mfma_f32_32x32x16_bf16 v[48:63], v[76:79], a[40:43], v[48:63]
    ds_read_b64_tr_b16 v[68:69], v113 offset:24576
    ds_read_b64_tr_b16 v[70:71], v113 offset:25600
    v_accvgpr_read_b32 v201, a244
    v_lshlrev_b32 v200, 16, v201
    s_add_u32 s99, s65, 1032192
    s_add_u32 m0, s62, 69632
    s_nop 0
    buffer_load_dwordx4 v7, s[20:23], s99 offen lds
    s_waitcnt vmcnt(9) lgkmcnt(6)
    v_mfma_f32_32x32x16_bf16 v[32:47], v[80:83], a[44:47], v[32:47]
    ds_read_b64_tr_b16 v[72:73], v112 offset:26624
    ds_read_b64_tr_b16 v[74:75], v112 offset:27648
    s_waitcnt lgkmcnt(6)
    v_mfma_f32_32x32x16_bf16 v[48:63], v[84:87], a[44:47], v[48:63]
    ds_read_b64_tr_b16 v[76:77], v113 offset:26624
    ds_read_b64_tr_b16 v[78:79], v113 offset:27648
    v_and_b32 v201, 0xffff0000, v201
    v_accvgpr_read_b32 v203, a245
    s_add_u32 s99, s65, 1060864
    s_add_u32 m0, s62, 70656
    s_nop 0
    buffer_load_dwordx4 v7, s[20:23], s99 offen lds
    s_waitcnt vmcnt(9) lgkmcnt(6)
    v_mfma_f32_32x32x16_bf16 v[32:47], v[64:67], a[48:51], v[32:47]
    ds_read_b64_tr_b16 v[80:81], v112 offset:28672
    ds_read_b64_tr_b16 v[82:83], v112 offset:29696
    s_waitcnt lgkmcnt(6)
    v_mfma_f32_32x32x16_bf16 v[48:63], v[68:71], a[48:51], v[48:63]
    ds_read_b64_tr_b16 v[84:85], v113 offset:28672
    ds_read_b64_tr_b16 v[86:87], v113 offset:29696
    v_lshlrev_b32 v202, 16, v203
    v_and_b32 v203, 0xffff0000, v203
    s_add_u32 s99, s65, 1089536
    s_add_u32 m0, s62, 71680
    s_nop 0
    buffer_load_dwordx4 v7, s[20:23], s99 offen lds
    s_waitcnt vmcnt(9) lgkmcnt(6)
    v_mfma_f32_32x32x16_bf16 v[32:47], v[72:75], a[52:55], v[32:47]
    ds_read_b64_tr_b16 v[64:65], v112 offset:30720
    ds_read_b64_tr_b16 v[66:67], v112 offset:31744
    s_waitcnt lgkmcnt(6)
    v_mfma_f32_32x32x16_bf16 v[48:63], v[76:79], a[52:55], v[48:63]
    ds_read_b64_tr_b16 v[68:69], v113 offset:30720
    ds_read_b64_tr_b16 v[70:71], v113 offset:31744
    v_accvgpr_read_b32 v205, a246
    v_lshlrev_b32 v204, 16, v205
    s_add_u32 s99, s65, 1118208
    s_add_u32 m0, s62, 72704
    s_nop 0
    buffer_load_dwordx4 v7, s[20:23], s99 offen lds
    s_waitcnt vmcnt(9) lgkmcnt(6)
    v_mfma_f32_32x32x16_bf16 v[32:47], v[80:83], a[56:59], v[32:47]
    s_waitcnt lgkmcnt(4)
    v_mfma_f32_32x32x16_bf16 v[48:63], v[84:87], a[56:59], v[48:63]
    v_and_b32 v205, 0xffff0000, v205
    v_accvgpr_read_b32 v207, a247
    s_waitcnt vmcnt(8) lgkmcnt(2)
    v_mfma_f32_32x32x16_bf16 v[32:47], v[64:67], a[60:63], v[32:47]
    s_waitcnt lgkmcnt(0)
    v_mfma_f32_32x32x16_bf16 v[48:63], v[68:71], a[60:63], v[48:63]
    v_lshlrev_b32 v206, 16, v207
    v_and_b32 v207, 0xffff0000, v207
    s_lshl_b32 s84, s44, 12
    s_xor_b32 s85, s84, 4096
    v_add_u32 v26, s84, v4
    v_add_u32 v27, s85, v4
    s_nop 5
    ds_write_b128 v26, v[48:51] offset:32768
    ds_write_b128 v26, v[52:55] offset:33792
    ds_write_b128 v26, v[56:59] offset:34816
    ds_write_b128 v26, v[60:63] offset:35840
    s_waitcnt lgkmcnt(0)
    s_barrier
    ds_read_b128 v[128:131], v27 offset:32768
    ds_read_b128 v[132:135], v27 offset:33792
    ds_read_b128 v[136:139], v27 offset:34816
    ds_read_b128 v[140:143], v27 offset:35840
    s_waitcnt lgkmcnt(3)
    v_pk_add_f32 v[32:33], v[32:33], v[128:129]
    v_pk_add_f32 v[34:35], v[34:35], v[130:131]
    s_waitcnt lgkmcnt(2)
    v_pk_add_f32 v[36:37], v[36:37], v[132:133]
    v_pk_add_f32 v[38:39], v[38:39], v[134:135]
    s_waitcnt lgkmcnt(1)
    v_pk_add_f32 v[40:41], v[40:41], v[136:137]
    v_pk_add_f32 v[42:43], v[42:43], v[138:139]
    s_waitcnt lgkmcnt(0)
    v_pk_add_f32 v[44:45], v[44:45], v[140:141]
    v_pk_add_f32 v[46:47], v[46:47], v[142:143]
    v_pk_add_f32 v[32:33], v[32:33], v[192:193]
    v_pk_add_f32 v[34:35], v[34:35], v[194:195]
    v_pk_add_f32 v[36:37], v[36:37], v[196:197]
    v_pk_add_f32 v[38:39], v[38:39], v[198:199]
    v_pk_add_f32 v[40:41], v[40:41], v[200:201]
    v_pk_add_f32 v[42:43], v[42:43], v[202:203]
    v_pk_add_f32 v[44:45], v[44:45], v[204:205]
    v_pk_add_f32 v[46:47], v[46:47], v[206:207]
    v_cvt_pk_bf16_f32 v160, v32, v33
    v_cvt_pk_bf16_f32 v161, v34, v35
    v_cvt_pk_bf16_f32 v162, v36, v37
    v_cvt_pk_bf16_f32 v163, v38, v39
    v_cvt_pk_bf16_f32 v164, v40, v41
    v_cvt_pk_bf16_f32 v165, v42, v43
    v_cvt_pk_bf16_f32 v166, v44, v45
    v_cvt_pk_bf16_f32 v167, v46, v47
    s_lshl_b32 s76, s72, 15
    s_lshl_b32 s77, s73, 11
    s_add_u32 s76, s76, s77
    s_add_u32 s76, s76, 10485760
    buffer_store_dwordx4 v[160:163], v4, s[32:35], s76 offen sc1
    buffer_store_dwordx4 v[164:167], v4, s[32:35], s76 offen offset:1024 sc1
    v_mov_b32 v168, 0
    v_mov_b32 v169, 0
    v_mov_b32 v172, 0
    v_mov_b32 v173, 0
    v_mov_b32 v170, 0x3f803f80
    v_dot2c_f32_bf16 v168, v160, v170
    v_dot2c_f32_bf16 v169, v160, v160
    v_dot2c_f32_bf16 v172, v161, v170
    v_dot2c_f32_bf16 v173, v161, v161
    v_dot2c_f32_bf16 v168, v162, v170
    v_dot2c_f32_bf16 v169, v162, v162
    v_dot2c_f32_bf16 v172, v163, v170
    v_dot2c_f32_bf16 v173, v163, v163
    v_dot2c_f32_bf16 v168, v164, v170
    v_dot2c_f32_bf16 v169, v164, v164
    v_dot2c_f32_bf16 v172, v165, v170
    v_dot2c_f32_bf16 v173, v165, v165
    v_dot2c_f32_bf16 v168, v166, v170
    v_dot2c_f32_bf16 v169, v166, v166
    v_dot2c_f32_bf16 v172, v167, v170
    v_dot2c_f32_bf16 v173, v167, v167
    s_nop 1
    v_add_f32 v168, v168, v172
    v_add_f32 v169, v169, v173
    v_mov_b32 v171, v168
    v_mov_b32 v172, v169
    v_nop
    v_permlane32_swap_b32 v168, v171
    v_permlane32_swap_b32 v169, v172
    v_add_f32 v168, v168, v171
    v_add_f32 v169, v169, v172
    s_lshl_b32 s76, s72, 12
    s_lshl_b32 s77, s73, 8
    s_add_u32 s76, s76, s77
    s_add_u32 s76, s76, 3145728
    v_lshlrev_b32 v171, 3, v2
    s_mov_b64 s[58:59], exec
    s_mov_b32 exec_hi, 0
    buffer_store_dwordx2 v[168:169], v171, s[32:35], s76 offen sc1
    s_mov_b64 exec, s[58:59]
    v_accvgpr_write_b32 a240, v160
    v_accvgpr_write_b32 a241, v161
    v_accvgpr_write_b32 a242, v162
    v_accvgpr_write_b32 a243, v163
    v_accvgpr_write_b32 a244, v164
    v_accvgpr_write_b32 a245, v165
    v_accvgpr_write_b32 a246, v166
    v_accvgpr_write_b32 a247, v167
    s_waitcnt lgkmcnt(0)
    s_barrier
    s_add_u32 s99, s65, 458752
    s_add_u32 m0, s62, 32768
    s_nop 0
    buffer_load_dwordx4 v7, s[20:23], s99 offen lds
    s_add_u32 s99, s65, 487424
    s_add_u32 m0, s62, 33792
    s_nop 0
    buffer_load_dwordx4 v7, s[20:23], s99 offen lds
    s_add_u32 s99, s65, 516096
    s_add_u32 m0, s62, 34816
    s_nop 0
    buffer_load_dwordx4 v7, s[20:23], s99 offen lds
    s_add_u32 s99, s65, 544768
    s_add_u32 m0, s62, 35840
    s_nop 0
    buffer_load_dwordx4 v7, s[20:23], s99 offen lds
    s_add_u32 s99, s65, 573440
    s_add_u32 m0, s62, 36864
    s_nop 0
    buffer_load_dwordx4 v7, s[20:23], s99 offen lds
    s_add_u32 s99, s65, 602112
    s_add_u32 m0, s62, 37888
    s_nop 0
    buffer_load_dwordx4 v7, s[20:23], s99 offen lds
    s_add_u32 s99, s65, 630784
    s_add_u32 m0, s62, 38912
    s_nop 0
    buffer_load_dwordx4 v7, s[20:23], s99 offen lds
    s_add_u32 s99, s65, 659456
    s_add_u32 m0, s62, 39936
    s_nop 0
    buffer_load_dwordx4 v7, s[20:23], s99 offen lds
    s_waitcnt vmcnt(8)
    v_accvgpr_read_b32 v25, a234
    s_mov_b64 s[58:59], exec
    s_mov_b32 exec_lo, 65535
    s_mov_b32 exec_hi, 0
    v_mov_b32 v24, 1
    buffer_atomic_add v24, v25, s[32:35], 0 offen offset:72 sc1
    s_mov_b64 exec, s[58:59]
    s_add_u32 s99, s65, 1376256
    s_add_u32 m0, s62, 98304
    s_nop 0
    buffer_load_dwordx4 v7, s[20:23], s99 offen lds
    s_add_u32 s99, s65, 1404928
    s_add_u32 m0, s62, 99328
    s_nop 0
    buffer_load_dwordx4 v7, s[20:23], s99 offen lds
    s_add_u32 s99, s65, 1433600
    s_add_u32 m0, s62, 100352
    s_nop 0
    buffer_load_dwordx4 v7, s[20:23], s99 offen lds
    s_add_u32 s99, s65, 1462272
    s_add_u32 m0, s62, 101376
    s_nop 0
    buffer_load_dwordx4 v7, s[20:23], s99 offen lds
    s_add_u32 s99, s65, 1490944
    s_add_u32 m0, s62, 102400
    s_nop 0
    buffer_load_dwordx4 v7, s[20:23], s99 offen lds
    s_add_u32 s99, s65, 1519616
    s_add_u32 m0, s62, 103424
    s_nop 0
    buffer_load_dwordx4 v7, s[20:23], s99 offen lds
    s_add_u32 s99, s65, 1548288
    s_add_u32 m0, s62, 104448
    s_nop 0
    buffer_load_dwordx4 v7, s[20:23], s99 offen lds
    s_add_u32 s99, s65, 1576960
    s_add_u32 m0, s62, 105472
    s_nop 0
    buffer_load_dwordx4 v7, s[20:23], s99 offen lds
    s_add_u32 s99, s66, 0
    s_add_u32 m0, s67, 131072
    s_nop 0
    buffer_load_dwordx4 v4, s[32:35], s99 offen offset:0 lds
    buffer_load_dwordx4 v4, s[32:35], s99 offen offset:1024 lds
    buffer_load_dwordx4 v4, s[32:35], s99 offen offset:2048 lds
    buffer_load_dwordx4 v4, s[32:35], s99 offen offset:3072 lds
    s_add_u32 s99, s66, 4096
    s_add_u32 m0, s67, 135168
    s_nop 0
    buffer_load_dwordx4 v4, s[32:35], s99 offen offset:0 lds
    buffer_load_dwordx4 v4, s[32:35], s99 offen offset:1024 lds
    s_add_u32 s3, s70, 72
    s_buffer_load_dword s4, s[32:35], s3 glc
    s_waitcnt lgkmcnt(0)
    s_cmp_ge_u32 s4, 16
    s_cbranch_scc1 PD_150
    s_mov_b32 s60, 0
PL_149:
    s_buffer_load_dword s4, s[32:35], s3 glc
    s_add_u32 s60, s60, 1
    s_cmp_gt_u32 s60, 0x80000
    s_cbranch_scc1 L_bail
    s_waitcnt lgkmcnt(0)
    s_cmp_lt_u32 s4, 16
    s_cbranch_scc1 PL_149
PD_150:
    s_lshl_b32 s74, s71, 15
    s_add_u32 s74, s74, 10485760
    s_mov_b32 s76, s74
    s_add_u32 s98, s76, 0
    buffer_load_dwordx4 a[0:3], v4, s[32:35], s98 offen offset:0 sc1
    s_add_u32 s98, s76, 0
    buffer_load_dwordx4 a[4:7], v4, s[32:35], s98 offen offset:1024 sc1
    s_add_u32 s98, s76, 0
    buffer_load_dwordx4 a[8:11], v4, s[32:35], s98 offen offset:2048 sc1
    s_add_u32 s98, s76, 0
    buffer_load_dwordx4 a[12:15], v4, s[32:35], s98 offen offset:3072 sc1
    s_add_u32 s98, s76, 4096
    buffer_load_dwordx4 a[16:19], v4, s[32:35], s98 offen offset:0 sc1
    s_add_u32 s98, s76, 4096
    buffer_load_dwordx4 a[20:23], v4, s[32:35], s98 offen offset:1024 sc1
    s_add_u32 s98, s76, 4096
    buffer_load_dwordx4 a[24:27], v4, s[32:35], s98 offen offset:2048 sc1
    s_add_u32 s98, s76, 4096
    buffer_load_dwordx4 a[28:31], v4, s[32:35], s98 offen offset:3072 sc1
    s_mul_i32 s88, s71, 114688
    s_add_u32 s88, s88, 25165824
    s_mul_i32 s89, s46, 3072
    s_add_u32 s89, s89, s88
    s_add_u32 s89, s89, 65536
    s_lshl_b32 s75, s46, 12
    s_add_u32 s88, s88, s75
    s_waitcnt vmcnt(8)
    s_barrier
    v_add_u32 v212, 0, v16
    v_add_u32 v213, 0, v17
    v_add_u32 v214, 0, v18
    v_add_u32 v215, 0, v19
    ds_read_b64_tr_b16 v[144:145], v212 offset:0
    ds_read_b64_tr_b16 v[146:147], v212 offset:1024
    ds_read_b64_tr_b16 v[148:149], v213 offset:0
    ds_read_b64_tr_b16 v[150:151], v213 offset:1024
    ds_read_b64_tr_b16 v[152:153], v214 offset:0
    ds_read_b64_tr_b16 v[154:155], v214 offset:1024
    ds_read_b64_tr_b16 v[156:157], v215 offset:0
    ds_read_b64_tr_b16 v[158:159], v215 offset:1024
    ds_read_b64_tr_b16 v[160:161], v212 offset:2048
    ds_read_b64_tr_b16 v[162:163], v212 offset:3072
    ds_read_b64_tr_b16 v[164:165], v213 offset:2048
    ds_read_b64_tr_b16 v[166:167], v213 offset:3072
    ds_read_b64_tr_b16 v[168:169], v214 offset:2048
    ds_read_b64_tr_b16 v[170:171], v214 offset:3072
    ds_read_b64_tr_b16 v[172:173], v215 offset:2048
    ds_read_b64_tr_b16 v[174:175], v215 offset:3072
    s_waitcnt lgkmcnt(8)
    s_waitcnt vmcnt(7)
    v_mfma_f32_32x32x16_bf16 v[32:47], v[144:147], a[0:3], 0
    ds_read_b64_tr_b16 v[176:177], v212 offset:4096
    ds_read_b64_tr_b16 v[178:179], v212 offset:5120
    s_add_u32 s98, s76, 8192
    buffer_load_dwordx4 a[32:35], v4, s[32:35], s98 offen offset:0 sc1
    v_mfma_f32_32x32x16_bf16 v[48:63], v[148:151], a[0:3], 0
    ds_read_b64_tr_b16 v[180:181], v213 offset:4096
    ds_read_b64_tr_b16 v[182:183], v213 offset:5120
    v_mfma_f32_32x32x16_bf16 v[64:79], v[152:155], a[0:3], 0
    ds_read_b64_tr_b16 v[184:185], v214 offset:4096
    ds_read_b64_tr_b16 v[186:187], v214 offset:5120
    s_add_u32 s98, s76, 8192
    buffer_load_dwordx4 a[36:39], v4, s[32:35], s98 offen offset:1024 sc1
    v_mfma_f32_32x32x16_bf16 v[80:95], v[156:159], a[0:3], 0
    ds_read_b64_tr_b16 v[188:189], v215 offset:4096
    ds_read_b64_tr_b16 v[190:191], v215 offset:5120
    s_waitcnt lgkmcnt(8)
    s_waitcnt vmcnt(8)
    v_mfma_f32_32x32x16_bf16 v[32:47], v[160:163], a[4:7], v[32:47]
    ds_read_b64_tr_b16 v[144:145], v212 offset:6144
    ds_read_b64_tr_b16 v[146:147], v212 offset:7168
    s_add_u32 s98, s76, 8192
    buffer_load_dwordx4 a[40:43], v4, s[32:35], s98 offen offset:2048 sc1
    v_mfma_f32_32x32x16_bf16 v[48:63], v[164:167], a[4:7], v[48:63]
    ds_read_b64_tr_b16 v[148:149], v213 offset:6144
    ds_read_b64_tr_b16 v[150:151], v213 offset:7168
    v_mfma_f32_32x32x16_bf16 v[64:79], v[168:171], a[4:7], v[64:79]
    ds_read_b64_tr_b16 v[152:153], v214 offset:6144
    ds_read_b64_tr_b16 v[154:155], v214 offset:7168
    s_add_u32 s98, s76, 8192
    buffer_load_dwordx4 a[44:47], v4, s[32:35], s98 offen offset:3072 sc1
    v_mfma_f32_32x32x16_bf16 v[80:95], v[172:175], a[4:7], v[80:95]
    ds_read_b64_tr_b16 v[156:157], v215 offset:6144
    ds_read_b64_tr_b16 v[158:159], v215 offset:7168
    s_waitcnt lgkmcnt(8)
    s_waitcnt vmcnt(9)
    v_mfma_f32_32x32x16_bf16 v[32:47], v[176:179], a[8:11], v[32:47]
    ds_read_b64_tr_b16 v[160:161], v212 offset:8192
    ds_read_b64_tr_b16 v[162:163], v212 offset:9216
    s_add_u32 s98, s76, 12288
    buffer_load_dwordx4 a[48:51], v4, s[32:35], s98 offen offset:0 sc1
    v_mfma_f32_32x32x16_bf16 v[48:63], v[180:183], a[8:11], v[48:63]
    ds_read_b64_tr_b16 v[164:165], v213 offset:8192
    ds_read_b64_tr_b16 v[166:167], v213 offset:9216
    v_mfma_f32_32x32x16_bf16 v[64:79], v[184:187], a[8:11], v[64:79]
    ds_read_b64_tr_b16 v[168:169], v214 offset:8192
    ds_read_b64_tr_b16 v[170:171], v214 offset:9216
    s_add_u32 s98, s76, 12288
    buffer_load_dwordx4 a[52:55], v4, s[32:35], s98 offen offset:1024 sc1
    v_mfma_f32_32x32x16_bf16 v[80:95], v[188:191], a[8:11], v[80:95]
    ds_read_b64_tr_b16 v[172:173], v215 offset:8192
    ds_read_b64_tr_b16 v[174:175], v215 offset:9216
    s_waitcnt lgkmcnt(8)
    s_waitcnt vmcnt(10)
    v_mfma_f32_32x32x16_bf16 v[32:47], v[144:147], a[12:15], v[32:47]
    ds_read_b64_tr_b16 v[176:177], v212 offset:10240
    ds_read_b64_tr_b16 v[178:179], v212 offset:11264
    s_add_u32 s98, s76, 12288
    buffer_load_dwordx4 a[56:59], v4, s[32:35], s98 offen offset:2048 sc1
    v_mfma_f32_32x32x16_bf16 v[48:63], v[148:151], a[12:15], v[48:63]
    ds_read_b64_tr_b16 v[180:181], v213 offset:10240
    ds_read_b64_tr_b16 v[182:183], v213 offset:11264
    v_mfma_f32_32x32x16_bf16 v[64:79], v[152:155], a[12:15], v[64:79]
    ds_read_b64_tr_b16 v[184:185], v214 offset:10240
    ds_read_b64_tr_b16 v[186:187], v214 offset:11264
    s_add_u32 s98, s76, 12288
    buffer_load_dwordx4 a[60:63], v4, s[32:35], s98 offen offset:3072 sc1
    v_mfma_f32_32x32x16_bf16 v[80:95], v[156:159], a[12:15], v[80:95]
    ds_read_b64_tr_b16 v[188:189], v215 offset:10240
    ds_read_b64_tr_b16 v[190:191], v215 offset:11264
    s_waitcnt lgkmcnt(8)
    s_waitcnt vmcnt(11)
    v_mfma_f32_32x32x16_bf16 v[32:47], v[160:163], a[16:19], v[32:47]
    ds_read_b64_tr_b16 v[144:145], v212 offset:12288
    ds_read_b64_tr_b16 v[146:147], v212 offset:13312
    s_add_u32 s98, s76, 16384
    buffer_load_dwordx4 a[64:67], v4, s[32:35], s98 offen offset:0 sc1
    v_mfma_f32_32x32x16_bf16 v[48:63], v[164:167], a[16:19], v[48:63]
    ds_read_b64_tr_b16 v[148:149], v213 offset:12288
    ds_read_b64_tr_b16 v[150:151], v213 offset:13312
    v_mfma_f32_32x32x16_bf16 v[64:79], v[168:171], a[16:19], v[64:79]
    ds_read_b64_tr_b16 v[152:153], v214 offset:12288
    ds_read_b64_tr_b16 v[154:155], v214 offset:13312
    s_add_u32 s98, s76, 16384
    buffer_load_dwordx4 a[68:71], v4, s[32:35], s98 offen offset:1024 sc1
    v_mfma_f32_32x32x16_bf16 v[80:95], v[172:175], a[16:19], v[80:95]
    ds_read_b64_tr_b16 v[156:157], v215 offset:12288
    ds_read_b64_tr_b16 v[158:159], v215 offset:13312
    s_waitcnt lgkmcnt(8)
    s_waitcnt vmcnt(12)
    v_mfma_f32_32x32x16_bf16 v[32:47], v[176:179], a[20:23], v[32:47]
    ds_read_b64_tr_b16 v[160:161], v212 offset:14336
    ds_read_b64_tr_b16 v[162:163], v212 offset:15360
    s_add_u32 s98, s76, 16384
    buffer_load_dwordx4 a[72:75], v4, s[32:35], s98 offen offset:2048 sc1
    v_mfma_f32_32x32x16_bf16 v[48:63], v[180:183], a[20:23], v[48:63]
    ds_read_b64_tr_b16 v[164:165], v213 offset:14336
    ds_read_b64_tr_b16 v[166:167], v213 offset:15360
    v_mfma_f32_32x32x16_bf16 v[64:79], v[184:187], a[20:23], v[64:79]
    ds_read_b64_tr_b16 v[168:169], v214 offset:14336
    ds_read_b64_tr_b16 v[170:171], v214 offset:15360
    s_add_u32 s98, s76, 16384
    buffer_load_dwordx4 a[76:79], v4, s[32:35], s98 offen offset:3072 sc1
    v_mfma_f32_32x32x16_bf16 v[80:95], v[188:191], a[20:23], v[80:95]
    ds_read_b64_tr_b16 v[172:173], v215 offset:14336
    ds_read_b64_tr_b16 v[174:175], v215 offset:15360
    v_add_u32 v216, 32768, v16
    v_add_u32 v217, 32768, v17
    v_add_u32 v218, 32768, v18
    v_add_u32 v219, 32768, v19
    s_waitcnt lgkmcnt(8)
    s_waitcnt vmcnt(13)
    v_mfma_f32_32x32x16_bf16 v[32:47], v[144:147], a[24:27], v[32:47]
    ds_read_b64_tr_b16 v[176:177], v216 offset:0
    ds_read_b64_tr_b16 v[178:179], v216 offset:1024
    s_add_u32 s98, s76, 20480
    buffer_load_dwordx4 a[80:83], v4, s[32:35], s98 offen offset:0 sc1
    v_mfma_f32_32x32x16_bf16 v[48:63], v[148:151], a[24:27], v[48:63]
    ds_read_b64_tr_b16 v[180:181], v217 offset:0
    ds_read_b64_tr_b16 v[182:183], v217 offset:1024
    v_mfma_f32_32x32x16_bf16 v[64:79], v[152:155], a[24:27], v[64:79]
    ds_read_b64_tr_b16 v[184:185], v218 offset:0
    ds_read_b64_tr_b16 v[186:187], v218 offset:1024
    s_add_u32 s98, s76, 20480
    buffer_load_dwordx4 a[84:87], v4, s[32:35], s98 offen offset:1024 sc1
    v_mfma_f32_32x32x16_bf16 v[80:95], v[156:159], a[24:27], v[80:95]
    ds_read_b64_tr_b16 v[188:189], v219 offset:0
    ds_read_b64_tr_b16 v[190:191], v219 offset:1024
    s_waitcnt lgkmcnt(8)
    s_waitcnt vmcnt(14)
    v_mfma_f32_32x32x16_bf16 v[32:47], v[160:163], a[28:31], v[32:47]
    ds_read_b64_tr_b16 v[144:145], v216 offset:2048
    ds_read_b64_tr_b16 v[146:147], v216 offset:3072
    s_add_u32 s98, s76, 20480
    buffer_load_dwordx4 a[88:91], v4, s[32:35], s98 offen offset:2048 sc1
    v_mfma_f32_32x32x16_bf16 v[48:63], v[164:167], a[28:31], v[48:63]
    ds_read_b64_tr_b16 v[148:149], v217 offset:2048
    ds_read_b64_tr_b16 v[150:151], v217 offset:3072
    v_mfma_f32_32x32x16_bf16 v[64:79], v[168:171], a[28:31], v[64:79]
    ds_read_b64_tr_b16 v[152:153], v218 offset:2048
    ds_read_b64_tr_b16 v[154:155], v218 offset:3072
    s_add_u32 s98, s76, 20480
    buffer_load_dwordx4 a[92:95], v4, s[32:35], s98 offen offset:3072 sc1
    v_mfma_f32_32x32x16_bf16 v[80:95], v[172:175], a[28:31], v[80:95]
    ds_read_b64_tr_b16 v[156:157], v219 offset:2048
    ds_read_b64_tr_b16 v[158:159], v219 offset:3072
    s_waitcnt lgkmcnt(8)
    s_waitcnt vmcnt(15)
    v_mfma_f32_32x32x16_bf16 v[32:47], v[176:179], a[32:35], v[32:47]
    ds_read_b64_tr_b16 v[160:161], v216 offset:4096
    ds_read_b64_tr_b16 v[162:163], v216 offset:5120
    s_add_u32 s98, s76, 24576
    buffer_load_dwordx4 a[96:99], v4, s[32:35], s98 offen offset:0 sc1
    v_mfma_f32_32x32x16_bf16 v[48:63], v[180:183], a[32:35], v[48:63]
    ds_read_b64_tr_b16 v[164:165], v217 offset:4096
    ds_read_b64_tr_b16 v[166:167], v217 offset:5120
    v_mfma_f32_32x32x16_bf16 v[64:79], v[184:187], a[32:35], v[64:79]
    ds_read_b64_tr_b16 v[168:169], v218 offset:4096
    ds_read_b64_tr_b16 v[170:171], v218 offset:5120
    s_add_u32 s98, s76, 24576
    buffer_load_dwordx4 a[100:103], v4, s[32:35], s98 offen offset:1024 sc1
    v_mfma_f32_32x32x16_bf16 v[80:95], v[188:191], a[32:35], v[80:95]
    ds_read_b64_tr_b16 v[172:173], v219 offset:4096
    ds_read_b64_tr_b16 v[174:175], v219 offset:5120
    s_waitcnt lgkmcnt(8)
    s_waitcnt vmcnt(16)
    v_mfma_f32_32x32x16_bf16 v[32:47], v[144:147], a[36:39], v[32:47]
    ds_read_b64_tr_b16 v[176:177], v216 offset:6144
    ds_read_b64_tr_b16 v[178:179], v216 offset:7168
    s_add_u32 s98, s76, 24576
    buffer_load_dwordx4 a[104:107], v4, s[32:35], s98 offen offset:2048 sc1
    v_mfma_f32_32x32x16_bf16 v[48:63], v[148:151], a[36:39], v[48:63]
    ds_read_b64_tr_b16 v[180:181], v217 offset:6144
    ds_read_b64_tr_b16 v[182:183], v217 offset:7168
    v_mfma_f32_32x32x16_bf16 v[64:79], v[152:155], a[36:39], v[64:79]
    ds_read_b64_tr_b16 v[184:185], v218 offset:6144
    ds_read_b64_tr_b16 v[186:187], v218 offset:7168
    s_add_u32 s98, s76, 24576
    buffer_load_dwordx4 a[108:111], v4, s[32:35], s98 offen offset:3072 sc1
    v_mfma_f32_32x32x16_bf16 v[80:95], v[156:159], a[36:39], v[80:95]
    ds_read_b64_tr_b16 v[188:189], v219 offset:6144
    ds_read_b64_tr_b16 v[190:191], v219 offset:7168
    s_waitcnt lgkmcnt(8)
    s_waitcnt vmcnt(17)
    v_mfma_f32_32x32x16_bf16 v[32:47], v[160:163], a[40:43], v[32:47]
    ds_read_b64_tr_b16 v[144:145], v216 offset:8192
    ds_read_b64_tr_b16 v[146:147], v216 offset:9216
    s_add_u32 s98, s76, 28672
    buffer_load_dwordx4 a[112:115], v4, s[32:35], s98 offen offset:0 sc1
    v_mfma_f32_32x32x16_bf16 v[48:63], v[164:167], a[40:43], v[48:63]
    ds_read_b64_tr_b16 v[148:149], v217 offset:8192
    ds_read_b64_tr_b16 v[150:151], v217 offset:9216
    v_mfma_f32_32x32x16_bf16 v[64:79], v[168:171], a[40:43], v[64:79]
    ds_read_b64_tr_b16 v[152:153], v218 offset:8192
    ds_read_b64_tr_b16 v[154:155], v218 offset:9216
    s_add_u32 s98, s76, 28672
    buffer_load_dwordx4 a[116:119], v4, s[32:35], s98 offen offset:1024 sc1
    v_mfma_f32_32x32x16_bf16 v[80:95], v[172:175], a[40:43], v[80:95]
    ds_read_b64_tr_b16 v[156:157], v219 offset:8192
    ds_read_b64_tr_b16 v[158:159], v219 offset:9216
    s_waitcnt lgkmcnt(8)
    s_waitcnt vmcnt(18)
    v_mfma_f32_32x32x16_bf16 v[32:47], v[176:179], a[44:47], v[32:47]
    ds_read_b64_tr_b16 v[160:161], v216 offset:10240
    ds_read_b64_tr_b16 v[162:163], v216 offset:11264
    s_add_u32 s98, s76, 28672
    buffer_load_dwordx4 a[120:123], v4, s[32:35], s98 offen offset:2048 sc1
    v_mfma_f32_32x32x16_bf16 v[48:63], v[180:183], a[44:47], v[48:63]
    ds_read_b64_tr_b16 v[164:165], v217 offset:10240
    ds_read_b64_tr_b16 v[166:167], v217 offset:11264
    v_mfma_f32_32x32x16_bf16 v[64:79], v[184:187], a[44:47], v[64:79]
    ds_read_b64_tr_b16 v[168:169], v218 offset:10240
    ds_read_b64_tr_b16 v[170:171], v218 offset:11264
    s_add_u32 s98, s76, 28672
    buffer_load_dwordx4 a[124:127], v4, s[32:35], s98 offen offset:3072 sc1
    v_mfma_f32_32x32x16_bf16 v[80:95], v[188:191], a[44:47], v[80:95]
    ds_read_b64_tr_b16 v[172:173], v219 offset:10240
    ds_read_b64_tr_b16 v[174:175], v219 offset:11264
    s_waitcnt lgkmcnt(8)
    s_waitcnt vmcnt(19)
    v_mfma_f32_32x32x16_bf16 v[32:47], v[144:147], a[48:51], v[32:47]
    ds_read_b64_tr_b16 v[176:177], v216 offset:12288
    ds_read_b64_tr_b16 v[178:179], v216 offset:13312
    s_lshl_b32 s75, s71, 12
    s_add_u32 s75, s75, 3145728
    v_lshlrev_b32 v26, 3, v2
    v_lshl_add_u32 v26, v3, 11, v26
    buffer_load_dwordx2 v[112:113], v26, s[32:35], s75 offen offset:0 sc1
    buffer_load_dwordx2 v[114:115], v26, s[32:35], s75 offen offset:256 sc1
    buffer_load_dwordx2 v[116:117], v26, s[32:35], s75 offen offset:512 sc1
    buffer_load_dwordx2 v[118:119], v26, s[32:35], s75 offen offset:768 sc1
    buffer_load_dwordx2 v[120:121], v26, s[32:35], s75 offen offset:1024 sc1
    buffer_load_dwordx2 v[122:123], v26, s[32:35], s75 offen offset:1280 sc1
    buffer_load_dwordx2 v[124:125], v26, s[32:35], s75 offen offset:1536 sc1
    buffer_load_dwordx2 v[126:127], v26, s[32:35], s75 offen offset:1792 sc1
    v_mfma_f32_32x32x16_bf16 v[48:63], v[148:151], a[48:51], v[48:63]
    ds_read_b64_tr_b16 v[180:181], v217 offset:12288
    ds_read_b64_tr_b16 v[182:183], v217 offset:13312
    v_mfma_f32_32x32x16_bf16 v[64:79], v[152:155], a[48:51], v[64:79]
    ds_read_b64_tr_b16 v[184:185], v218 offset:12288
    ds_read_b64_tr_b16 v[186:187], v218 offset:13312
    v_mfma_f32_32x32x16_bf16 v[80:95], v[156:159], a[48:51], v[80:95]
    ds_read_b64_tr_b16 v[188:189], v219 offset:12288
    ds_read_b64_tr_b16 v[190:191], v219 offset:13312
    s_waitcnt lgkmcnt(8)
    s_waitcnt vmcnt(26)
    v_mfma_f32_32x32x16_bf16 v[32:47], v[160:163], a[52:55], v[32:47]
    ds_read_b64_tr_b16 v[144:145], v216 offset:14336
    ds_read_b64_tr_b16 v[146:147], v216 offset:15360
    v_mfma_f32_32x32x16_bf16 v[48:63], v[164:167], a[52:55], v[48:63]
    ds_read_b64_tr_b16 v[148:149], v217 offset:14336
    ds_read_b64_tr_b16 v[150:151], v217 offset:15360
    v_mfma_f32_32x32x16_bf16 v[64:79], v[168:171], a[52:55], v[64:79]
    ds_read_b64_tr_b16 v[152:153], v218 offset:14336
    ds_read_b64_tr_b16 v[154:155], v218 offset:15360
    v_mfma_f32_32x32x16_bf16 v[80:95], v[172:175], a[52:55], v[80:95]
    ds_read_b64_tr_b16 v[156:157], v219 offset:14336
    ds_read_b64_tr_b16 v[158:159], v219 offset:15360
    v_add_u32 v212, 65536, v16
    v_add_u32 v213, 65536, v17
    v_add_u32 v214, 65536, v18
    v_add_u32 v215, 65536, v19
    s_waitcnt lgkmcnt(8)
    s_waitcnt vmcnt(25)
    v_mfma_f32_32x32x16_bf16 v[32:47], v[176:179], a[56:59], v[32:47]
    ds_read_b64_tr_b16 v[160:161], v212 offset:0
    ds_read_b64_tr_b16 v[162:163], v212 offset:1024
    v_mfma_f32_32x32x16_bf16 v[48:63], v[180:183], a[56:59], v[48:63]
    ds_read_b64_tr_b16 v[164:165], v213 offset:0
    ds_read_b64_tr_b16 v[166:167], v213 offset:1024
    v_mfma_f32_32x32x16_bf16 v[64:79], v[184:187], a[56:59], v[64:79]
    ds_read_b64_tr_b16 v[168:169], v214 offset:0
    ds_read_b64_tr_b16 v[170:171], v214 offset:1024
    v_mfma_f32_32x32x16_bf16 v[80:95], v[188:191], a[56:59], v[80:95]
    ds_read_b64_tr_b16 v[172:173], v215 offset:0
    ds_read_b64_tr_b16 v[174:175], v215 offset:1024
    s_waitcnt lgkmcnt(8)
    s_waitcnt vmcnt(24)
    v_mfma_f32_32x32x16_bf16 v[32:47], v[144:147], a[60:63], v[32:47]
    ds_read_b64_tr_b16 v[176:177], v212 offset:2048
    ds_read_b64_tr_b16 v[178:179], v212 offset:3072
    v_mfma_f32_32x32x16_bf16 v[48:63], v[148:151], a[60:63], v[48:63]
    ds_read_b64_tr_b16 v[180:181], v213 offset:2048
    ds_read_b64_tr_b16 v[182:183], v213 offset:3072
    v_mfma_f32_32x32x16_bf16 v[64:79], v[152:155], a[60:63], v[64:79]
    ds_read_b64_tr_b16 v[184:185], v214 offset:2048
    ds_read_b64_tr_b16 v[186:187], v214 offset:3072
    v_mfma_f32_32x32x16_bf16 v[80:95], v[156:159], a[60:63], v[80:95]
    ds_read_b64_tr_b16 v[188:189], v215 offset:2048
    ds_read_b64_tr_b16 v[190:191], v215 offset:3072
    s_waitcnt lgkmcnt(8)
    s_waitcnt vmcnt(23)
    v_mfma_f32_32x32x16_bf16 v[32:47], v[160:163], a[64:67], v[32:47]
    ds_read_b64_tr_b16 v[144:145], v212 offset:4096
    ds_read_b64_tr_b16 v[146:147], v212 offset:5120
    v_mfma_f32_32x32x16_bf16 v[48:63], v[164:167], a[64:67], v[48:63]
    ds_read_b64_tr_b16 v[148:149], v213 offset:4096
    ds_read_b64_tr_b16 v[150:151], v213 offset:5120
    v_mfma_f32_32x32x16_bf16 v[64:79], v[168:171], a[64:67], v[64:79]
    ds_read_b64_tr_b16 v[152:153], v214 offset:4096
    ds_read_b64_tr_b16 v[154:155], v214 offset:5120
    v_mfma_f32_32x32x16_bf16 v[80:95], v[172:175], a[64:67], v[80:95]
    ds_read_b64_tr_b16 v[156:157], v215 offset:4096
    ds_read_b64_tr_b16 v[158:159], v215 offset:5120
    s_waitcnt lgkmcnt(8)
    s_waitcnt vmcnt(22)
    v_mfma_f32_32x32x16_bf16 v[32:47], v[176:179], a[68:71], v[32:47]
    ds_read_b64_tr_b16 v[160:161], v212 offset:6144
    ds_read_b64_tr_b16 v[162:163], v212 offset:7168
    v_mfma_f32_32x32x16_bf16 v[48:63], v[180:183], a[68:71], v[48:63]
    ds_read_b64_tr_b16 v[164:165], v213 offset:6144
    ds_read_b64_tr_b16 v[166:167], v213 offset:7168
    v_mfma_f32_32x32x16_bf16 v[64:79], v[184:187], a[68:71], v[64:79]
    ds_read_b64_tr_b16 v[168:169], v214 offset:6144
    ds_read_b64_tr_b16 v[170:171], v214 offset:7168
    v_mfma_f32_32x32x16_bf16 v[80:95], v[188:191], a[68:71], v[80:95]
    ds_read_b64_tr_b16 v[172:173], v215 offset:6144
    ds_read_b64_tr_b16 v[174:175], v215 offset:7168
    s_waitcnt lgkmcnt(8)
    s_waitcnt vmcnt(21)
    v_mfma_f32_32x32x16_bf16 v[32:47], v[144:147], a[72:75], v[32:47]
    ds_read_b64_tr_b16 v[176:177], v212 offset:8192
    ds_read_b64_tr_b16 v[178:179], v212 offset:9216
    v_mfma_f32_32x32x16_bf16 v[48:63], v[148:151], a[72:75], v[48:63]
    ds_read_b64_tr_b16 v[180:181], v213 offset:8192
    ds_read_b64_tr_b16 v[182:183], v213 offset:9216
    v_mfma_f32_32x32x16_bf16 v[64:79], v[152:155], a[72:75], v[64:79]
    ds_read_b64_tr_b16 v[184:185], v214 offset:8192
    ds_read_b64_tr_b16 v[186:187], v214 offset:9216
    v_mfma_f32_32x32x16_bf16 v[80:95], v[156:159], a[72:75], v[80:95]
    ds_read_b64_tr_b16 v[188:189], v215 offset:8192
    ds_read_b64_tr_b16 v[190:191], v215 offset:9216
    s_waitcnt lgkmcnt(8)
    s_waitcnt vmcnt(20)
    v_mfma_f32_32x32x16_bf16 v[32:47], v[160:163], a[76:79], v[32:47]
    ds_read_b64_tr_b16 v[144:145], v212 offset:10240
    ds_read_b64_tr_b16 v[146:147], v212 offset:11264
    v_mfma_f32_32x32x16_bf16 v[48:63], v[164:167], a[76:79], v[48:63]
    ds_read_b64_tr_b16 v[148:149], v213 offset:10240
    ds_read_b64_tr_b16 v[150:151], v213 offset:11264
    v_mfma_f32_32x32x16_bf16 v[64:79], v[168:171], a[76:79], v[64:79]
    ds_read_b64_tr_b16 v[152:153], v214 offset:10240
    ds_read_b64_tr_b16 v[154:155], v214 offset:11264
    v_mfma_f32_32x32x16_bf16 v[80:95], v[172:175], a[76:79], v[80:95]
    ds_read_b64_tr_b16 v[156:157], v215 offset:10240
    ds_read_b64_tr_b16 v[158:159], v215 offset:11264
    s_waitcnt lgkmcnt(8)
    s_waitcnt vmcnt(19)
    v_mfma_f32_32x32x16_bf16 v[32:47], v[176:179], a[80:83], v[32:47]
    ds_read_b64_tr_b16 v[160:161], v212 offset:12288
    ds_read_b64_tr_b16 v[162:163], v212 offset:13312
    v_mfma_f32_32x32x16_bf16 v[48:63], v[180:183], a[80:83], v[48:63]
    ds_read_b64_tr_b16 v[164:165], v213 offset:12288
    ds_read_b64_tr_b16 v[166:167], v213 offset:13312
    v_mfma_f32_32x32x16_bf16 v[64:79], v[184:187], a[80:83], v[64:79]
    ds_read_b64_tr_b16 v[168:169], v214 offset:12288
    ds_read_b64_tr_b16 v[170:171], v214 offset:13312
    v_mfma_f32_32x32x16_bf16 v[80:95], v[188:191], a[80:83], v[80:95]
    ds_read_b64_tr_b16 v[172:173], v215 offset:12288
    ds_read_b64_tr_b16 v[174:175], v215 offset:13312
    s_waitcnt vmcnt(6)
    v_add_f32 v112, v112, v114
    v_add_f32 v113, v113, v115
    s_waitcnt vmcnt(5)
    v_add_f32 v112, v112, v116
    v_add_f32 v113, v113, v117
    s_waitcnt vmcnt(4)
    v_add_f32 v112, v112, v118
    s_waitcnt lgkmcnt(8)
    v_mfma_f32_32x32x16_bf16 v[32:47], v[144:147], a[84:87], v[32:47]
    ds_read_b64_tr_b16 v[176:177], v212 offset:14336
    ds_read_b64_tr_b16 v[178:179], v212 offset:15360
    v_mfma_f32_32x32x16_bf16 v[48:63], v[148:151], a[84:87], v[48:63]
    ds_read_b64_tr_b16 v[180:181], v213 offset:14336
    ds_read_b64_tr_b16 v[182:183], v213 offset:15360
    v_mfma_f32_32x32x16_bf16 v[64:79], v[152:155], a[84:87], v[64:79]
    ds_read_b64_tr_b16 v[184:185], v214 offset:14336
    ds_read_b64_tr_b16 v[186:187], v214 offset:15360
    v_mfma_f32_32x32x16_bf16 v[80:95], v[156:159], a[84:87], v[80:95]
    ds_read_b64_tr_b16 v[188:189], v215 offset:14336
    ds_read_b64_tr_b16 v[190:191], v215 offset:15360
    v_add_f32 v113, v113, v119
    s_waitcnt vmcnt(3)
    v_add_f32 v112, v112, v120
    v_add_f32 v113, v113, v121
    s_waitcnt vmcnt(2)
    v_add_f32 v112, v112, v122
    v_add_f32 v113, v113, v123
    s_barrier
    v_add_u32 v216, 98304, v16
    v_add_u32 v217, 98304, v17
    v_add_u32 v218, 98304, v18
    v_add_u32 v219, 98304, v19
    s_waitcnt lgkmcnt(8)
    v_mfma_f32_32x32x16_bf16 v[32:47], v[160:163], a[88:91], v[32:47]
    ds_read_b64_tr_b16 v[144:145], v216 offset:0
    ds_read_b64_tr_b16 v[146:147], v216 offset:1024
    v_mfma_f32_32x32x16_bf16 v[48:63], v[164:167], a[88:91], v[48:63]
    ds_read_b64_tr_b16 v[148:149], v217 offset:0
    ds_read_b64_tr_b16 v[150:151], v217 offset:1024
    s_add_u32 s99, s66, 12288
    s_add_u32 m0, s67, 0
    s_nop 0
    buffer_load_dwordx4 v4, s[32:35], s99 offen offset:0 lds
    v_mfma_f32_32x32x16_bf16 v[64:79], v[168:171], a[88:91], v[64:79]
    ds_read_b64_tr_b16 v[152:153], v218 offset:0
    ds_read_b64_tr_b16 v[154:155], v218 offset:1024
    v_mfma_f32_32x32x16_bf16 v[80:95], v[172:175], a[88:91], v[80:95]
    ds_read_b64_tr_b16 v[156:157], v219 offset:0
    ds_read_b64_tr_b16 v[158:159], v219 offset:1024
    buffer_load_dwordx4 v4, s[32:35], s99 offen offset:1024 lds
    s_waitcnt vmcnt(3)
    v_add_f32 v112, v112, v124
    v_add_f32 v113, v113, v125
    s_waitcnt vmcnt(2)
    v_add_f32 v112, v112, v126
    v_add_f32 v113, v113, v127
    v_mov_b32 v26, v112
    s_waitcnt lgkmcnt(8)
    v_mfma_f32_32x32x16_bf16 v[32:47], v[176:179], a[92:95], v[32:47]
    ds_read_b64_tr_b16 v[160:161], v216 offset:2048
    ds_read_b64_tr_b16 v[162:163], v216 offset:3072
    v_mfma_f32_32x32x16_bf16 v[48:63], v[180:183], a[92:95], v[48:63]
    ds_read_b64_tr_b16 v[164:165], v217 offset:2048
    ds_read_b64_tr_b16 v[166:167], v217 offset:3072
    buffer_load_dwordx4 v4, s[32:35], s99 offen offset:2048 lds
    v_mfma_f32_32x32x16_bf16 v[64:79], v[184:187], a[92:95], v[64:79]
    ds_read_b64_tr_b16 v[168:169], v218 offset:2048
    ds_read_b64_tr_b16 v[170:171], v218 offset:3072
    v_mfma_f32_32x32x16_bf16 v[80:95], v[188:191], a[92:95], v[80:95]
    ds_read_b64_tr_b16 v[172:173], v219 offset:2048
    ds_read_b64_tr_b16 v[174:175], v219 offset:3072
    buffer_load_dwordx4 v4, s[32:35], s99 offen offset:3072 lds
    v_mov_b32 v27, v113
    v_nop
    v_permlane32_swap_b32 v112, v26
    v_permlane32_swap_b32 v113, v27
    v_add_f32 v112, v112, v26
    s_waitcnt lgkmcnt(8)
    v_mfma_f32_32x32x16_bf16 v[32:47], v[144:147], a[96:99], v[32:47]
    ds_read_b64_tr_b16 v[176:177], v216 offset:4096
    ds_read_b64_tr_b16 v[178:179], v216 offset:5120
    v_mfma_f32_32x32x16_bf16 v[48:63], v[148:151], a[96:99], v[48:63]
    ds_read_b64_tr_b16 v[180:181], v217 offset:4096
    ds_read_b64_tr_b16 v[182:183], v217 offset:5120
    s_add_u32 s99, s66, 16384
    s_add_u32 m0, s67, 4096
    s_nop 0
    buffer_load_dwordx4 v4, s[32:35], s99 offen offset:0 lds
    v_mfma_f32_32x32x16_bf16 v[64:79], v[152:155], a[96:99], v[64:79]
    ds_read_b64_tr_b16 v[184:185], v218 offset:4096
    ds_read_b64_tr_b16 v[186:187], v218 offset:5120
    v_mfma_f32_32x32x16_bf16 v[80:95], v[156:159], a[96:99], v[80:95]
    ds_read_b64_tr_b16 v[188:189], v219 offset:4096
    ds_read_b64_tr_b16 v[190:191], v219 offset:5120
    buffer_load_dwordx4 v4, s[32:35], s99 offen offset:1024 lds
    v_add_f32 v113, v113, v27
    v_mul_f32 v22, s51, v112
    v_mul_f32 v113, s51, v113
    v_fma_f32 v113, -v22, v22, v113
    v_max_f32 v113, 0, v113
    s_waitcnt lgkmcnt(8)
    v_mfma_f32_32x32x16_bf16 v[32:47], v[160:163], a[100:103], v[32:47]
    ds_read_b64_tr_b16 v[144:145], v216 offset:6144
    ds_read_b64_tr_b16 v[146:147], v216 offset:7168
    v_mfma_f32_32x32x16_bf16 v[48:63], v[164:167], a[100:103], v[48:63]
    ds_read_b64_tr_b16 v[148:149], v217 offset:6144
    ds_read_b64_tr_b16 v[150:151], v217 offset:7168
    s_add_u32 s99, s66, 24576
    s_add_u32 m0, s67, 32768
    s_nop 0
    buffer_load_dwordx4 v4, s[32:35], s99 offen offset:0 lds
    v_mfma_f32_32x32x16_bf16 v[64:79], v[168:171], a[100:103], v[64:79]
    ds_read_b64_tr_b16 v[152:153], v218 offset:6144
    ds_read_b64_tr_b16 v[154:155], v218 offset:7168
    v_mfma_f32_32x32x16_bf16 v[80:95], v[172:175], a[100:103], v[80:95]
    ds_read_b64_tr_b16 v[156:157], v219 offset:6144
    ds_read_b64_tr_b16 v[158:159], v219 offset:7168
    buffer_load_dwordx4 v4, s[32:35], s99 offen offset:1024 lds
    v_add_f32 v113, s52, v113
    v_rsq_f32 v21, v113
    v_sub_f32 v28, 0, v22
    v_cndmask_b32 v28, 0, v28, s[54:55]
    v_cvt_pk_bf16_f32 v204, v28, v28
    s_waitcnt lgkmcnt(8)
    v_mfma_f32_32x32x16_bf16 v[32:47], v[176:179], a[104:107], v[32:47]
    ds_read_b64_tr_b16 v[160:161], v216 offset:8192
    ds_read_b64_tr_b16 v[162:163], v216 offset:9216
    v_mfma_f32_32x32x16_bf16 v[48:63], v[180:183], a[104:107], v[48:63]
    ds_read_b64_tr_b16 v[164:165], v217 offset:8192
    ds_read_b64_tr_b16 v[166:167], v217 offset:9216
    buffer_load_dwordx4 v4, s[32:35], s99 offen offset:2048 lds
    v_mfma_f32_32x32x16_bf16 v[64:79], v[184:187], a[104:107], v[64:79]
    ds_read_b64_tr_b16 v[168:169], v218 offset:8192
    ds_read_b64_tr_b16 v[170:171], v218 offset:9216
    v_mfma_f32_32x32x16_bf16 v[80:95], v[188:191], a[104:107], v[80:95]
    ds_read_b64_tr_b16 v[172:173], v219 offset:8192
    ds_read_b64_tr_b16 v[174:175], v219 offset:9216
    buffer_load_dwordx4 v4, s[32:35], s99 offen offset:3072 lds
    v_lshlrev_b32 v26, 16, v204
    v_sub_f32 v26, v28, v26
    v_cvt_pk_bf16_f32 v204, v28, v26
    v_mov_b32 v205, v204
    v_mov_b32 v206, 0
    s_waitcnt lgkmcnt(8)
    v_mfma_f32_32x32x16_bf16 v[32:47], v[144:147], a[108:111], v[32:47]
    ds_read_b64_tr_b16 v[176:177], v216 offset:10240
    ds_read_b64_tr_b16 v[178:179], v216 offset:11264
    v_mfma_f32_32x32x16_bf16 v[48:63], v[148:151], a[108:111], v[48:63]
    ds_read_b64_tr_b16 v[180:181], v217 offset:10240
    ds_read_b64_tr_b16 v[182:183], v217 offset:11264
    s_add_u32 s99, s66, 28672
    s_add_u32 m0, s67, 36864
    s_nop 0
    buffer_load_dwordx4 v4, s[32:35], s99 offen offset:0 lds
    v_mfma_f32_32x32x16_bf16 v[64:79], v[152:155], a[108:111], v[64:79]
    ds_read_b64_tr_b16 v[184:185], v218 offset:10240
    ds_read_b64_tr_b16 v[186:187], v218 offset:11264
    v_mfma_f32_32x32x16_bf16 v[80:95], v[156:159], a[108:111], v[80:95]
    ds_read_b64_tr_b16 v[188:189], v219 offset:10240
    ds_read_b64_tr_b16 v[190:191], v219 offset:11264
    buffer_load_dwordx4 v4, s[32:35], s99 offen offset:1024 lds
    v_mov_b32 v207, 0
    v_mul_f32 v208, s50, v21
    v_sub_f32 v208, 0, v208
    v_mul_f32 v209, v21, v21
    v_rcp_f32 v209, v209
    s_waitcnt lgkmcnt(8)
    v_mfma_f32_32x32x16_bf16 v[32:47], v[160:163], a[112:115], v[32:47]
    ds_read_b64_tr_b16 v[144:145], v216 offset:12288
    ds_read_b64_tr_b16 v[146:147], v216 offset:13312
    v_mfma_f32_32x32x16_bf16 v[48:63], v[164:167], a[112:115], v[48:63]
    ds_read_b64_tr_b16 v[148:149], v217 offset:12288
    ds_read_b64_tr_b16 v[150:151], v217 offset:13312
    v_mfma_f32_32x32x16_bf16 v[64:79], v[168:171], a[112:115], v[64:79]
    ds_read_b64_tr_b16 v[152:153], v218 offset:12288
    ds_read_b64_tr_b16 v[154:155], v218 offset:13312
    v_mfma_f32_32x32x16_bf16 v[80:95], v[172:175], a[112:115], v[80:95]
    ds_read_b64_tr_b16 v[156:157], v219 offset:12288
    ds_read_b64_tr_b16 v[158:159], v219 offset:13312
    v_add_u32 v236, 0, v6
    v_add_u32 v237, 7168, v6
    v_add_u32 v238, 14336, v6
    v_add_u32 v239, 21504, v6
    s_waitcnt lgkmcnt(8)
    v_mfma_f32_32x32x16_bf16 v[32:47], v[176:179], a[116:119], v[32:47]
    ds_read_b64_tr_b16 v[160:161], v216 offset:14336
    ds_read_b64_tr_b16 v[162:163], v216 offset:15360
    v_mfma_f32_32x32x16_bf16 v[48:63], v[180:183], a[116:119], v[48:63]
    ds_read_b64_tr_b16 v[164:165], v217 offset:14336
    ds_read_b64_tr_b16 v[166:167], v217 offset:15360
    v_mfma_f32_32x32x16_bf16 v[64:79], v[184:187], a[116:119], v[64:79]
    ds_read_b64_tr_b16 v[168:169], v218 offset:14336
    ds_read_b64_tr_b16 v[170:171], v218 offset:15360
    v_mfma_f32_32x32x16_bf16 v[80:95], v[188:191], a[116:119], v[80:95]
    ds_read_b64_tr_b16 v[172:173], v219 offset:14336
    ds_read_b64_tr_b16 v[174:175], v219 offset:15360
    s_barrier
    v_add_u32 v212, 131072, v20
    s_waitcnt lgkmcnt(8)
    v_mfma_f32_32x32x16_bf16 v[32:47], v[144:147], a[120:123], v[32:47]
    ds_read_b64_tr_b16 v[176:177], v212 offset:0
    ds_read_b64_tr_b16 v[178:179], v212 offset:768
    v_mfma_f32_32x32x16_bf16 v[48:63], v[148:151], a[120:123], v[48:63]
    ds_read_b64_tr_b16 v[180:181], v212 offset:32
    ds_read_b64_tr_b16 v[182:183], v212 offset:800
    s_add_u32 s99, s66, 36864
    s_add_u32 m0, s67, 65536
    s_nop 0
    buffer_load_dwordx4 v4, s[32:35], s99 offen offset:0 lds
    v_mfma_f32_32x32x16_bf16 v[64:79], v[152:155], a[120:123], v[64:79]
    ds_read_b64_tr_b16 v[184:185], v212 offset:64
    ds_read_b64_tr_b16 v[186:187], v212 offset:832
    v_mfma_f32_32x32x16_bf16 v[80:95], v[156:159], a[120:123], v[80:95]
    buffer_load_dwordx4 v4, s[32:35], s99 offen offset:1024 lds
    s_waitcnt lgkmcnt(6)
    v_mfma_f32_32x32x16_bf16 v[32:47], v[160:163], a[124:127], v[32:47]
    ds_read_b64_tr_b16 v[144:145], v212 offset:1536
    ds_read_b64_tr_b16 v[146:147], v212 offset:2304
    v_mfma_f32_32x32x16_bf16 v[48:63], v[164:167], a[124:127], v[48:63]
    ds_read_b64_tr_b16 v[148:149], v212 offset:1568
    ds_read_b64_tr_b16 v[150:151], v212 offset:2336
    buffer_load_dwordx4 v4, s[32:35], s99 offen offset:2048 lds
    v_mfma_f32_32x32x16_bf16 v[64:79], v[168:171], a[124:127], v[64:79]
    ds_read_b64_tr_b16 v[152:153], v212 offset:1600
    ds_read_b64_tr_b16 v[154:155], v212 offset:2368
    v_mfma_f32_32x32x16_bf16 v[80:95], v[172:175], a[124:127], v[80:95]
    buffer_load_dwordx4 v4, s[32:35], s99 offen offset:3072 lds
    v_mfma_f32_32x32x16_bf16 v[32:47], a[192:195], v[204:207], v[32:47]
    v_mfma_f32_32x32x16_bf16 v[48:63], a[196:199], v[204:207], v[48:63]
    v_mfma_f32_32x32x16_bf16 v[64:79], a[200:203], v[204:207], v[64:79]
    v_mfma_f32_32x32x16_bf16 v[80:95], a[204:207], v[204:207], v[80:95]
    s_waitcnt lgkmcnt(6)
    v_mfma_f32_32x32x16_bf16 v[96:111], v[176:179], a[0:3], 0
    ds_read_b64_tr_b16 v[160:161], v212 offset:3072
    ds_read_b64_tr_b16 v[162:163], v212 offset:3840
    s_add_u32 s99, s66, 40960
    s_add_u32 m0, s67, 69632
    s_nop 0
    buffer_load_dwordx4 v4, s[32:35], s99 offen offset:0 lds
    s_nop 0
    v_mul_f32 v228, v32, v208
    v_mul_f32 v229, v33, v208
    v_mfma_f32_32x32x16_bf16 v[112:127], v[180:183], a[0:3], 0
    ds_read_b64_tr_b16 v[164:165], v212 offset:3104
    ds_read_b64_tr_b16 v[166:167], v212 offset:3872
    v_mul_f32 v230, v34, v208
    v_mul_f32 v231, v35, v208
    v_mul_f32 v232, v36, v208
    v_mfma_f32_32x32x16_bf16 v[128:143], v[184:187], a[0:3], 0
    ds_read_b64_tr_b16 v[168:169], v212 offset:3136
    ds_read_b64_tr_b16 v[170:171], v212 offset:3904
    v_mul_f32 v233, v37, v208
    v_mul_f32 v234, v38, v208
    v_mul_f32 v235, v39, v208
    s_waitcnt lgkmcnt(6)
    v_mfma_f32_32x32x16_bf16 v[96:111], v[144:147], a[4:7], v[96:111]
    ds_read_b64_tr_b16 v[176:177], v212 offset:4608
    ds_read_b64_tr_b16 v[178:179], v212 offset:5376
    buffer_load_dwordx4 v4, s[32:35], s99 offen offset:1024 lds
    v_exp_f32 v228, v228
    v_mul_f32 v32, v32, v40
    v_mfma_f32_32x32x16_bf16 v[112:127], v[148:151], a[4:7], v[112:127]
    ds_read_b64_tr_b16 v[180:181], v212 offset:4640
    ds_read_b64_tr_b16 v[182:183], v212 offset:5408
    v_exp_f32 v229, v229
    v_mul_f32 v33, v33, v41
    v_exp_f32 v230, v230
    v_mfma_f32_32x32x16_bf16 v[128:143], v[152:155], a[4:7], v[128:143]
    ds_read_b64_tr_b16 v[184:185], v212 offset:4672
    ds_read_b64_tr_b16 v[186:187], v212 offset:5440
    v_mul_f32 v34, v34, v42
    v_exp_f32 v231, v231
    v_mul_f32 v35, v35, v43
    s_waitcnt lgkmcnt(6)
    v_mfma_f32_32x32x16_bf16 v[96:111], v[160:163], a[8:11], v[96:111]
    ds_read_b64_tr_b16 v[144:145], v212 offset:6144
    ds_read_b64_tr_b16 v[146:147], v212 offset:6912
    v_exp_f32 v232, v232
    v_mul_f32 v36, v36, v44
    v_mfma_f32_32x32x16_bf16 v[112:127], v[164:167], a[8:11], v[112:127]
    ds_read_b64_tr_b16 v[148:149], v212 offset:6176
    ds_read_b64_tr_b16 v[150:151], v212 offset:6944
    v_exp_f32 v233, v233
    v_mul_f32 v37, v37, v45
    v_exp_f32 v234, v234
    v_mfma_f32_32x32x16_bf16 v[128:143], v[168:171], a[8:11], v[128:143]
    ds_read_b64_tr_b16 v[152:153], v212 offset:6208
    ds_read_b64_tr_b16 v[154:155], v212 offset:6976
    v_mul_f32 v38, v38, v46
    v_exp_f32 v235, v235
    v_mul_f32 v39, v39, v47
    s_waitcnt lgkmcnt(6)
    v_mfma_f32_32x32x16_bf16 v[96:111], v[176:179], a[12:15], v[96:111]
    ds_read_b64_tr_b16 v[160:161], v212 offset:7680
    ds_read_b64_tr_b16 v[162:163], v212 offset:8448
    v_fma_f32 v228, v228, v209, v209
    v_fma_f32 v229, v229, v209, v209
    v_mfma_f32_32x32x16_bf16 v[112:127], v[180:183], a[12:15], v[112:127]
    ds_read_b64_tr_b16 v[164:165], v212 offset:7712
    ds_read_b64_tr_b16 v[166:167], v212 offset:8480
    v_fma_f32 v230, v230, v209, v209
    v_fma_f32 v231, v231, v209, v209
    v_fma_f32 v232, v232, v209, v209
    v_mfma_f32_32x32x16_bf16 v[128:143], v[184:187], a[12:15], v[128:143]
    ds_read_b64_tr_b16 v[168:169], v212 offset:7744
    ds_read_b64_tr_b16 v[170:171], v212 offset:8512
    v_fma_f32 v233, v233, v209, v209
    v_fma_f32 v234, v234, v209, v209
    v_fma_f32 v235, v235, v209, v209
    s_waitcnt lgkmcnt(6)
    v_mfma_f32_32x32x16_bf16 v[96:111], v[144:147], a[16:19], v[96:111]
    ds_read_b64_tr_b16 v[176:177], v212 offset:9216
    ds_read_b64_tr_b16 v[178:179], v212 offset:9984
    v_rcp_f32 v228, v228
    v_rcp_f32 v229, v229
    v_mfma_f32_32x32x16_bf16 v[112:127], v[148:151], a[16:19], v[112:127]
    ds_read_b64_tr_b16 v[180:181], v212 offset:9248
    ds_read_b64_tr_b16 v[182:183], v212 offset:10016
    v_rcp_f32 v230, v230
    v_rcp_f32 v231, v231
    v_rcp_f32 v232, v232
    v_mfma_f32_32x32x16_bf16 v[128:143], v[152:155], a[16:19], v[128:143]
    ds_read_b64_tr_b16 v[184:185], v212 offset:9280
    ds_read_b64_tr_b16 v[186:187], v212 offset:10048
    v_rcp_f32 v233, v233
    v_rcp_f32 v234, v234
    v_rcp_f32 v235, v235
    s_waitcnt lgkmcnt(6)
    v_mfma_f32_32x32x16_bf16 v[96:111], v[160:163], a[20:23], v[96:111]
    ds_read_b64_tr_b16 v[144:145], v212 offset:10752
    ds_read_b64_tr_b16 v[146:147], v212 offset:11520
    v_mul_f32 v32, v32, v228
    v_mul_f32 v33, v33, v229
    v_mfma_f32_32x32x16_bf16 v[112:127], v[164:167], a[20:23], v[112:127]
    ds_read_b64_tr_b16 v[148:149], v212 offset:10784
    ds_read_b64_tr_b16 v[150:151], v212 offset:11552
    v_mul_f32 v34, v34, v230
    v_mul_f32 v35, v35, v231
    v_mul_f32 v36, v36, v232
    v_mfma_f32_32x32x16_bf16 v[128:143], v[168:171], a[20:23], v[128:143]
    ds_read_b64_tr_b16 v[152:153], v212 offset:10816
    ds_read_b64_tr_b16 v[154:155], v212 offset:11584
    v_mul_f32 v37, v37, v233
    v_mul_f32 v38, v38, v234
    v_mul_f32 v39, v39, v235
    s_waitcnt vmcnt(12)
    s_barrier
    v_add_u32 v216, 0, v20
    s_waitcnt lgkmcnt(6)
    v_mfma_f32_32x32x16_bf16 v[96:111], v[176:179], a[24:27], v[96:111]
    ds_read_b64_tr_b16 v[160:161], v216 offset:0
    ds_read_b64_tr_b16 v[162:163], v216 offset:768
    s_add_u32 s99, s68, 0
    s_add_u32 m0, s5, 98304
    s_nop 0
    buffer_load_dwordx4 v236, s[24:27], s99 offen offset:0 lds
    v_cvt_pk_bf16_f32 v220, v32, v33
    v_cvt_pk_bf16_f32 v221, v34, v35
    v_mfma_f32_32x32x16_bf16 v[112:127], v[180:183], a[24:27], v[112:127]
    ds_read_b64_tr_b16 v[164:165], v216 offset:32
    ds_read_b64_tr_b16 v[166:167], v216 offset:800
    v_cvt_pk_bf16_f32 v222, v36, v37
    v_cvt_pk_bf16_f32 v223, v38, v39
    buffer_store_dwordx4 v[220:223], v4, s[32:35], s88 offen offset:0 sc1
    v_mfma_f32_32x32x16_bf16 v[128:143], v[184:187], a[24:27], v[128:143]
    ds_read_b64_tr_b16 v[168:169], v216 offset:64
    ds_read_b64_tr_b16 v[170:171], v216 offset:832
    v_mul_f32 v228, v48, v208
    v_mul_f32 v229, v49, v208
    v_mul_f32 v230, v50, v208
    s_waitcnt lgkmcnt(6)
    v_mfma_f32_32x32x16_bf16 v[96:111], v[144:147], a[28:31], v[96:111]
    ds_read_b64_tr_b16 v[176:177], v216 offset:1536
    ds_read_b64_tr_b16 v[178:179], v216 offset:2304
    buffer_load_dwordx4 v237, s[24:27], s99 offen offset:1024 lds
    v_mul_f32 v231, v51, v208
    v_mul_f32 v232, v52, v208
    v_mfma_f32_32x32x16_bf16 v[112:127], v[148:151], a[28:31], v[112:127]
    ds_read_b64_tr_b16 v[180:181], v216 offset:1568
    ds_read_b64_tr_b16 v[182:183], v216 offset:2336
    v_mul_f32 v233, v53, v208
    v_mul_f32 v234, v54, v208
    v_mul_f32 v235, v55, v208
    v_mfma_f32_32x32x16_bf16 v[128:143], v[152:155], a[28:31], v[128:143]
    ds_read_b64_tr_b16 v[184:185], v216 offset:1600
    ds_read_b64_tr_b16 v[186:187], v216 offset:2368
    v_exp_f32 v228, v228
    v_mul_f32 v48, v48, v56
    v_exp_f32 v229, v229
    s_waitcnt lgkmcnt(6)
    v_mfma_f32_32x32x16_bf16 v[96:111], v[160:163], a[32:35], v[96:111]
    ds_read_b64_tr_b16 v[144:145], v216 offset:3072
    ds_read_b64_tr_b16 v[146:147], v216 offset:3840
    buffer_load_dwordx4 v238, s[24:27], s99 offen offset:2048 lds
    v_mul_f32 v49, v49, v57
    v_exp_f32 v230, v230
    v_mfma_f32_32x32x16_bf16 v[112:127], v[164:167], a[32:35], v[112:127]
    ds_read_b64_tr_b16 v[148:149], v216 offset:3104
    ds_read_b64_tr_b16 v[150:151], v216 offset:3872
    v_mul_f32 v50, v50, v58
    v_exp_f32 v231, v231
    v_mul_f32 v51, v51, v59
    v_mfma_f32_32x32x16_bf16 v[128:143], v[168:171], a[32:35], v[128:143]
    ds_read_b64_tr_b16 v[152:153], v216 offset:3136
    ds_read_b64_tr_b16 v[154:155], v216 offset:3904
    v_exp_f32 v232, v232
    v_mul_f32 v52, v52, v60
    v_exp_f32 v233, v233
    s_waitcnt lgkmcnt(6)
    v_mfma_f32_32x32x16_bf16 v[96:111], v[176:179], a[36:39], v[96:111]
    ds_read_b64_tr_b16 v[160:161], v216 offset:4608
    ds_read_b64_tr_b16 v[162:163], v216 offset:5376
    buffer_load_dwordx4 v239, s[24:27], s99 offen offset:3072 lds
    v_mul_f32 v53, v53, v61
    v_exp_f32 v234, v234
    v_mfma_f32_32x32x16_bf16 v[112:127], v[180:183], a[36:39], v[112:127]
    ds_read_b64_tr_b16 v[164:165], v216 offset:4640
    ds_read_b64_tr_b16 v[166:167], v216 offset:5408
    v_mul_f32 v54, v54, v62
    v_exp_f32 v235, v235
    v_mul_f32 v55, v55, v63
    v_mfma_f32_32x32x16_bf16 v[128:143], v[184:187], a[36:39], v[128:143]
    ds_read_b64_tr_b16 v[168:169], v216 offset:4672
    ds_read_b64_tr_b16 v[170:171], v216 offset:5440
    v_fma_f32 v228, v228, v209, v209
    v_fma_f32 v229, v229, v209, v209
    v_fma_f32 v230, v230, v209, v209
    s_waitcnt lgkmcnt(6)
    v_mfma_f32_32x32x16_bf16 v[96:111], v[144:147], a[40:43], v[96:111]
    ds_read_b64_tr_b16 v[176:177], v216 offset:6144
    ds_read_b64_tr_b16 v[178:179], v216 offset:6912
    s_add_u32 s99, s68, 32768
    s_add_u32 m0, s5, 102400
    s_nop 0
    buffer_load_dwordx4 v236, s[24:27], s99 offen offset:0 lds
    v_fma_f32 v231, v231, v209, v209
    v_fma_f32 v232, v232, v209, v209
    v_mfma_f32_32x32x16_bf16 v[112:127], v[148:151], a[40:43], v[112:127]
    ds_read_b64_tr_b16 v[180:181], v216 offset:6176
    ds_read_b64_tr_b16 v[182:183], v216 offset:6944
    v_fma_f32 v233, v233, v209, v209
    v_fma_f32 v234, v234, v209, v209
    v_fma_f32 v235, v235, v209, v209
    v_mfma_f32_32x32x16_bf16 v[128:143], v[152:155], a[40:43], v[128:143]
    ds_read_b64_tr_b16 v[184:185], v216 offset:6208
    ds_read_b64_tr_b16 v[186:187], v216 offset:6976
    v_rcp_f32 v228, v228
    v_rcp_f32 v229, v229
    v_rcp_f32 v230, v230
    s_waitcnt lgkmcnt(6)
    v_mfma_f32_32x32x16_bf16 v[96:111], v[160:163], a[44:47], v[96:111]
    ds_read_b64_tr_b16 v[144:145], v216 offset:7680
    ds_read_b64_tr_b16 v[146:147], v216 offset:8448
    buffer_load_dwordx4 v237, s[24:27], s99 offen offset:1024 lds
    v_rcp_f32 v231, v231
    v_rcp_f32 v232, v232
    v_mfma_f32_32x32x16_bf16 v[112:127], v[164:167], a[44:47], v[112:127]
    ds_read_b64_tr_b16 v[148:149], v216 offset:7712
    ds_read_b64_tr_b16 v[150:151], v216 offset:8480
    v_rcp_f32 v233, v233
    v_rcp_f32 v234, v234
    v_rcp_f32 v235, v235
    v_mfma_f32_32x32x16_bf16 v[128:143], v[168:171], a[44:47], v[128:143]
    ds_read_b64_tr_b16 v[152:153], v216 offset:7744
    ds_read_b64_tr_b16 v[154:155], v216 offset:8512
    v_mul_f32 v48, v48, v228
    v_mul_f32 v49, v49, v229
    v_mul_f32 v50, v50, v230
    s_waitcnt lgkmcnt(6)
    v_mfma_f32_32x32x16_bf16 v[96:111], v[176:179], a[48:51], v[96:111]
    ds_read_b64_tr_b16 v[160:161], v216 offset:9216
    ds_read_b64_tr_b16 v[162:163], v216 offset:9984
    buffer_load_dwordx4 v238, s[24:27], s99 offen offset:2048 lds
    v_mul_f32 v51, v51, v231
    v_mul_f32 v52, v52, v232
    v_mfma_f32_32x32x16_bf16 v[112:127], v[180:183], a[48:51], v[112:127]
    ds_read_b64_tr_b16 v[164:165], v216 offset:9248
    ds_read_b64_tr_b16 v[166:167], v216 offset:10016
    v_mul_f32 v53, v53, v233
    v_mul_f32 v54, v54, v234
    v_mul_f32 v55, v55, v235
    v_mfma_f32_32x32x16_bf16 v[128:143], v[184:187], a[48:51], v[128:143]
    ds_read_b64_tr_b16 v[168:169], v216 offset:9280
    ds_read_b64_tr_b16 v[170:171], v216 offset:10048
    v_cvt_pk_bf16_f32 v224, v48, v49
    v_cvt_pk_bf16_f32 v225, v50, v51
    v_cvt_pk_bf16_f32 v226, v52, v53
    s_waitcnt lgkmcnt(6)
    v_mfma_f32_32x32x16_bf16 v[96:111], v[144:147], a[52:55], v[96:111]
    ds_read_b64_tr_b16 v[176:177], v216 offset:10752
    ds_read_b64_tr_b16 v[178:179], v216 offset:11520
    buffer_load_dwordx4 v239, s[24:27], s99 offen offset:3072 lds
    v_cvt_pk_bf16_f32 v227, v54, v55
    buffer_store_dwordx4 v[224:227], v4, s[32:35], s88 offen offset:1024 sc1
    v_mfma_f32_32x32x16_bf16 v[112:127], v[148:151], a[52:55], v[112:127]
    ds_read_b64_tr_b16 v[180:181], v216 offset:10784
    ds_read_b64_tr_b16 v[182:183], v216 offset:11552
    v_mul_f32 v228, v64, v208
    v_mul_f32 v229, v65, v208
    v_mul_f32 v230, v66, v208
    v_mfma_f32_32x32x16_bf16 v[128:143], v[152:155], a[52:55], v[128:143]
    ds_read_b64_tr_b16 v[184:185], v216 offset:10816
    ds_read_b64_tr_b16 v[186:187], v216 offset:11584
    v_mul_f32 v231, v67, v208
    v_mul_f32 v232, v68, v208
    v_mul_f32 v233, v69, v208
    s_waitcnt vmcnt(16)
    s_barrier
    v_add_u32 v212, 32768, v20
    s_waitcnt lgkmcnt(6)
    v_mfma_f32_32x32x16_bf16 v[96:111], v[160:163], a[56:59], v[96:111]
    ds_read_b64_tr_b16 v[144:145], v212 offset:0
    ds_read_b64_tr_b16 v[146:147], v212 offset:768
    s_add_u32 s99, s68, 131072
    s_add_u32 m0, s5, 131072
    s_nop 0
    buffer_load_dwordx4 v236, s[24:27], s99 offen offset:0 lds
    v_mul_f32 v234, v70, v208
    v_mul_f32 v235, v71, v208
    v_mfma_f32_32x32x16_bf16 v[112:127], v[164:167], a[56:59], v[112:127]
    ds_read_b64_tr_b16 v[148:149], v212 offset:32
    ds_read_b64_tr_b16 v[150:151], v212 offset:800
    v_exp_f32 v228, v228
    v_mul_f32 v64, v64, v72
    v_exp_f32 v229, v229
    v_mfma_f32_32x32x16_bf16 v[128:143], v[168:171], a[56:59], v[128:143]
    ds_read_b64_tr_b16 v[152:153], v212 offset:64
    ds_read_b64_tr_b16 v[154:155], v212 offset:832
    v_mul_f32 v65, v65, v73
    v_exp_f32 v230, v230
    v_mul_f32 v66, v66, v74
    s_waitcnt lgkmcnt(6)
    v_mfma_f32_32x32x16_bf16 v[96:111], v[176:179], a[60:63], v[96:111]
    ds_read_b64_tr_b16 v[160:161], v212 offset:1536
    ds_read_b64_tr_b16 v[162:163], v212 offset:2304
    buffer_load_dwordx4 v237, s[24:27], s99 offen offset:1024 lds
    v_exp_f32 v231, v231
    v_mul_f32 v67, v67, v75
    v_mfma_f32_32x32x16_bf16 v[112:127], v[180:183], a[60:63], v[112:127]
    ds_read_b64_tr_b16 v[164:165], v212 offset:1568
    ds_read_b64_tr_b16 v[166:167], v212 offset:2336
    v_exp_f32 v232, v232
    v_mul_f32 v68, v68, v76
    v_exp_f32 v233, v233
    v_mfma_f32_32x32x16_bf16 v[128:143], v[184:187], a[60:63], v[128:143]
    ds_read_b64_tr_b16 v[168:169], v212 offset:1600
    ds_read_b64_tr_b16 v[170:171], v212 offset:2368
    v_mul_f32 v69, v69, v77
    v_exp_f32 v234, v234
    v_mul_f32 v70, v70, v78
    s_waitcnt lgkmcnt(6)
    v_mfma_f32_32x32x16_bf16 v[96:111], v[144:147], a[64:67], v[96:111]
    ds_read_b64_tr_b16 v[176:177], v212 offset:3072
    ds_read_b64_tr_b16 v[178:179], v212 offset:3840
    buffer_load_dwordx4 v238, s[24:27], s99 offen offset:2048 lds
    v_exp_f32 v235, v235
    v_mul_f32 v71, v71, v79
    v_mfma_f32_32x32x16_bf16 v[112:127], v[148:151], a[64:67], v[112:127]
    ds_read_b64_tr_b16 v[180:181], v212 offset:3104
    ds_read_b64_tr_b16 v[182:183], v212 offset:3872
    v_fma_f32 v228, v228, v209, v209
    v_fma_f32 v229, v229, v209, v209
    v_fma_f32 v230, v230, v209, v209
    v_mfma_f32_32x32x16_bf16 v[128:143], v[152:155], a[64:67], v[128:143]
    ds_read_b64_tr_b16 v[184:185], v212 offset:3136
    ds_read_b64_tr_b16 v[186:187], v212 offset:3904
    v_fma_f32 v231, v231, v209, v209
    v_fma_f32 v232, v232, v209, v209
    v_fma_f32 v233, v233, v209, v209
    s_waitcnt lgkmcnt(6)
    v_mfma_f32_32x32x16_bf16 v[96:111], v[160:163], a[68:71], v[96:111]
    ds_read_b64_tr_b16 v[144:145], v212 offset:4608
    ds_read_b64_tr_b16 v[146:147], v212 offset:5376
    buffer_load_dwordx4 v239, s[24:27], s99 offen offset:3072 lds
    v_fma_f32 v234, v234, v209, v209
    v_fma_f32 v235, v235, v209, v209
    v_mfma_f32_32x32x16_bf16 v[112:127], v[164:167], a[68:71], v[112:127]
    ds_read_b64_tr_b16 v[148:149], v212 offset:4640
    ds_read_b64_tr_b16 v[150:151], v212 offset:5408
    v_rcp_f32 v228, v228
    v_rcp_f32 v229, v229
    v_rcp_f32 v230, v230
    v_mfma_f32_32x32x16_bf16 v[128:143], v[168:171], a[68:71], v[128:143]
    ds_read_b64_tr_b16 v[152:153], v212 offset:4672
    ds_read_b64_tr_b16 v[154:155], v212 offset:5440
    v_rcp_f32 v231, v231
    v_rcp_f32 v232, v232
    v_rcp_f32 v233, v233
    s_waitcnt lgkmcnt(6)
    v_mfma_f32_32x32x16_bf16 v[96:111], v[176:179], a[72:75], v[96:111]
    ds_read_b64_tr_b16 v[160:161], v212 offset:6144
    ds_read_b64_tr_b16 v[162:163], v212 offset:6912
    s_add_u32 s99, s68, 163840
    s_add_u32 m0, s5, 135168
    s_nop 0
    buffer_load_dwordx4 v236, s[24:27], s99 offen offset:0 lds
    v_rcp_f32 v234, v234
    v_rcp_f32 v235, v235
    v_mfma_f32_32x32x16_bf16 v[112:127], v[180:183], a[72:75], v[112:127]
    ds_read_b64_tr_b16 v[164:165], v212 offset:6176
    ds_read_b64_tr_b16 v[166:167], v212 offset:6944
    v_mul_f32 v64, v64, v228
    v_mul_f32 v65, v65, v229
    v_mul_f32 v66, v66, v230
    v_mfma_f32_32x32x16_bf16 v[128:143], v[184:187], a[72:75], v[128:143]
    ds_read_b64_tr_b16 v[168:169], v212 offset:6208
    ds_read_b64_tr_b16 v[170:171], v212 offset:6976
    v_mul_f32 v67, v67, v231
    v_mul_f32 v68, v68, v232
    v_mul_f32 v69, v69, v233
    s_waitcnt lgkmcnt(6)
    v_mfma_f32_32x32x16_bf16 v[96:111], v[144:147], a[76:79], v[96:111]
    ds_read_b64_tr_b16 v[176:177], v212 offset:7680
    ds_read_b64_tr_b16 v[178:179], v212 offset:8448
    buffer_load_dwordx4 v237, s[24:27], s99 offen offset:1024 lds
    v_mul_f32 v70, v70, v234
    v_mul_f32 v71, v71, v235
    v_mfma_f32_32x32x16_bf16 v[112:127], v[148:151], a[76:79], v[112:127]
    ds_read_b64_tr_b16 v[180:181], v212 offset:7712
    ds_read_b64_tr_b16 v[182:183], v212 offset:8480
    v_cvt_pk_bf16_f32 v220, v64, v65
    v_cvt_pk_bf16_f32 v221, v66, v67
    v_cvt_pk_bf16_f32 v222, v68, v69
    v_mfma_f32_32x32x16_bf16 v[128:143], v[152:155], a[76:79], v[128:143]
    ds_read_b64_tr_b16 v[184:185], v212 offset:7744
    ds_read_b64_tr_b16 v[186:187], v212 offset:8512
    v_cvt_pk_bf16_f32 v223, v70, v71
    buffer_store_dwordx4 v[220:223], v4, s[32:35], s88 offen offset:2048 sc1
    v_mul_f32 v228, v80, v208
    s_waitcnt lgkmcnt(6)
    v_mfma_f32_32x32x16_bf16 v[96:111], v[160:163], a[80:83], v[96:111]
    ds_read_b64_tr_b16 v[144:145], v212 offset:9216
    ds_read_b64_tr_b16 v[146:147], v212 offset:9984
    buffer_load_dwordx4 v238, s[24:27], s99 offen offset:2048 lds
    v_mul_f32 v229, v81, v208
    v_mul_f32 v230, v82, v208
    v_mfma_f32_32x32x16_bf16 v[112:127], v[164:167], a[80:83], v[112:127]
    ds_read_b64_tr_b16 v[148:149], v212 offset:9248
    ds_read_b64_tr_b16 v[150:151], v212 offset:10016
    v_mul_f32 v231, v83, v208
    v_mul_f32 v232, v84, v208
    v_mul_f32 v233, v85, v208
    v_mfma_f32_32x32x16_bf16 v[128:143], v[168:171], a[80:83], v[128:143]
    ds_read_b64_tr_b16 v[152:153], v212 offset:9280
    ds_read_b64_tr_b16 v[154:155], v212 offset:10048
    v_mul_f32 v234, v86, v208
    v_mul_f32 v235, v87, v208
    v_exp_f32 v228, v228
    s_waitcnt lgkmcnt(6)
    v_mfma_f32_32x32x16_bf16 v[96:111], v[176:179], a[84:87], v[96:111]
    ds_read_b64_tr_b16 v[160:161], v212 offset:10752
    ds_read_b64_tr_b16 v[162:163], v212 offset:11520
    buffer_load_dwordx4 v239, s[24:27], s99 offen offset:3072 lds
    v_mul_f32 v80, v80, v88
    v_exp_f32 v229, v229
    v_mfma_f32_32x32x16_bf16 v[112:127], v[180:183], a[84:87], v[112:127]
    ds_read_b64_tr_b16 v[164:165], v212 offset:10784
    ds_read_b64_tr_b16 v[166:167], v212 offset:11552
    v_mul_f32 v81, v81, v89
    v_exp_f32 v230, v230
    v_mul_f32 v82, v82, v90
    v_mfma_f32_32x32x16_bf16 v[128:143], v[184:187], a[84:87], v[128:143]
    ds_read_b64_tr_b16 v[168:169], v212 offset:10816
    ds_read_b64_tr_b16 v[170:171], v212 offset:11584
    v_exp_f32 v231, v231
    v_mul_f32 v83, v83, v91
    v_exp_f32 v232, v232
    s_waitcnt vmcnt(19)
    s_barrier
    v_add_u32 v216, 65536, v20
    s_waitcnt lgkmcnt(6)
    v_mfma_f32_32x32x16_bf16 v[96:111], v[144:147], a[88:91], v[96:111]
    ds_read_b64_tr_b16 v[176:177], v216 offset:0
    ds_read_b64_tr_b16 v[178:179], v216 offset:768
    s_add_u32 s99, s68, 262144
    s_add_u32 m0, s5, 0
    s_nop 0
    buffer_load_dwordx4 v236, s[24:27], s99 offen offset:0 lds
    v_mul_f32 v84, v84, v92
    v_exp_f32 v233, v233
    v_mfma_f32_32x32x16_bf16 v[112:127], v[148:151], a[88:91], v[112:127]
    ds_read_b64_tr_b16 v[180:181], v216 offset:32
    ds_read_b64_tr_b16 v[182:183], v216 offset:800
    v_mul_f32 v85, v85, v93
    v_exp_f32 v234, v234
    v_mul_f32 v86, v86, v94
    v_mfma_f32_32x32x16_bf16 v[128:143], v[152:155], a[88:91], v[128:143]
    ds_read_b64_tr_b16 v[184:185], v216 offset:64
    ds_read_b64_tr_b16 v[186:187], v216 offset:832
    v_exp_f32 v235, v235
    v_mul_f32 v87, v87, v95
    v_fma_f32 v228, v228, v209, v209
    s_waitcnt lgkmcnt(6)
    v_mfma_f32_32x32x16_bf16 v[96:111], v[160:163], a[92:95], v[96:111]
    ds_read_b64_tr_b16 v[144:145], v216 offset:1536
    ds_read_b64_tr_b16 v[146:147], v216 offset:2304
    buffer_load_dwordx4 v237, s[24:27], s99 offen offset:1024 lds
    v_fma_f32 v229, v229, v209, v209
    v_fma_f32 v230, v230, v209, v209
    v_mfma_f32_32x32x16_bf16 v[112:127], v[164:167], a[92:95], v[112:127]
    ds_read_b64_tr_b16 v[148:149], v216 offset:1568
    ds_read_b64_tr_b16 v[150:151], v216 offset:2336
    v_fma_f32 v231, v231, v209, v209
    v_fma_f32 v232, v232, v209, v209
    v_fma_f32 v233, v233, v209, v209
    v_mfma_f32_32x32x16_bf16 v[128:143], v[168:171], a[92:95], v[128:143]
    ds_read_b64_tr_b16 v[152:153], v216 offset:1600
    ds_read_b64_tr_b16 v[154:155], v216 offset:2368
    v_fma_f32 v234, v234, v209, v209
    v_fma_f32 v235, v235, v209, v209
    v_rcp_f32 v228, v228
    s_waitcnt lgkmcnt(6)
    v_mfma_f32_32x32x16_bf16 v[96:111], v[176:179], a[96:99], v[96:111]
    ds_read_b64_tr_b16 v[160:161], v216 offset:3072
    ds_read_b64_tr_b16 v[162:163], v216 offset:3840
    buffer_load_dwordx4 v238, s[24:27], s99 offen offset:2048 lds
    v_rcp_f32 v229, v229
    v_rcp_f32 v230, v230
    v_mfma_f32_32x32x16_bf16 v[112:127], v[180:183], a[96:99], v[112:127]
    ds_read_b64_tr_b16 v[164:165], v216 offset:3104
    ds_read_b64_tr_b16 v[166:167], v216 offset:3872
    v_rcp_f32 v231, v231
    v_rcp_f32 v232, v232
    v_rcp_f32 v233, v233
    v_mfma_f32_32x32x16_bf16 v[128:143], v[184:187], a[96:99], v[128:143]
    ds_read_b64_tr_b16 v[168:169], v216 offset:3136
    ds_read_b64_tr_b16 v[170:171], v216 offset:3904
    v_rcp_f32 v234, v234
    v_rcp_f32 v235, v235
    v_mul_f32 v80, v80, v228
    s_waitcnt lgkmcnt(6)
    v_mfma_f32_32x32x16_bf16 v[96:111], v[144:147], a[100:103], v[96:111]
    ds_read_b64_tr_b16 v[176:177], v216 offset:4608
    ds_read_b64_tr_b16 v[178:179], v216 offset:5376
    buffer_load_dwordx4 v239, s[24:27], s99 offen offset:3072 lds
    v_mul_f32 v81, v81, v229
    v_mul_f32 v82, v82, v230
    v_mfma_f32_32x32x16_bf16 v[112:127], v[148:151], a[100:103], v[112:127]
    ds_read_b64_tr_b16 v[180:181], v216 offset:4640
    ds_read_b64_tr_b16 v[182:183], v216 offset:5408
    v_mul_f32 v83, v83, v231
    v_mul_f32 v84, v84, v232
    v_mul_f32 v85, v85, v233
    v_mfma_f32_32x32x16_bf16 v[128:143], v[152:155], a[100:103], v[128:143]
    ds_read_b64_tr_b16 v[184:185], v216 offset:4672
    ds_read_b64_tr_b16 v[186:187], v216 offset:5440
    v_mul_f32 v86, v86, v234
    v_mul_f32 v87, v87, v235
    v_cvt_pk_bf16_f32 v224, v80, v81
    s_waitcnt lgkmcnt(6)
    v_mfma_f32_32x32x16_bf16 v[96:111], v[160:163], a[104:107], v[96:111]
    ds_read_b64_tr_b16 v[144:145], v216 offset:6144
    ds_read_b64_tr_b16 v[146:147], v216 offset:6912
    s_add_u32 s99, s68, 294912
    s_add_u32 m0, s5, 4096
    s_nop 0
    buffer_load_dwordx4 v236, s[24:27], s99 offen offset:0 lds
    v_cvt_pk_bf16_f32 v225, v82, v83
    v_cvt_pk_bf16_f32 v226, v84, v85
    v_mfma_f32_32x32x16_bf16 v[112:127], v[164:167], a[104:107], v[112:127]
    ds_read_b64_tr_b16 v[148:149], v216 offset:6176
    ds_read_b64_tr_b16 v[150:151], v216 offset:6944
    v_cvt_pk_bf16_f32 v227, v86, v87
    buffer_store_dwordx4 v[224:227], v4, s[32:35], s88 offen offset:3072 sc1
    v_mfma_f32_32x32x16_bf16 v[128:143], v[168:171], a[104:107], v[128:143]
    ds_read_b64_tr_b16 v[152:153], v216 offset:6208
    ds_read_b64_tr_b16 v[154:155], v216 offset:6976
    s_waitcnt lgkmcnt(6)
    v_mfma_f32_32x32x16_bf16 v[96:111], v[176:179], a[108:111], v[96:111]
    ds_read_b64_tr_b16 v[160:161], v216 offset:7680
    ds_read_b64_tr_b16 v[162:163], v216 offset:8448
    buffer_load_dwordx4 v237, s[24:27], s99 offen offset:1024 lds
    v_mfma_f32_32x32x16_bf16 v[112:127], v[180:183], a[108:111], v[112:127]
    ds_read_b64_tr_b16 v[164:165], v216 offset:7712
    ds_read_b64_tr_b16 v[166:167], v216 offset:8480
    v_mfma_f32_32x32x16_bf16 v[128:143], v[184:187], a[108:111], v[128:143]
    ds_read_b64_tr_b16 v[168:169], v216 offset:7744
    ds_read_b64_tr_b16 v[170:171], v216 offset:8512
    s_waitcnt vmcnt(1)
    v_accvgpr_read_b32 v25, a235
    s_mov_b64 s[58:59], exec
    s_mov_b32 exec_lo, 255
    s_mov_b32 exec_hi, 0
    v_mov_b32 v24, 1
    buffer_atomic_add v24, v25, s[32:35], 0 offen offset:76 sc1
    s_mov_b64 exec, s[58:59]
    s_waitcnt lgkmcnt(6)
    v_mfma_f32_32x32x16_bf16 v[96:111], v[144:147], a[112:115], v[96:111]
    ds_read_b64_tr_b16 v[176:177], v216 offset:9216
    ds_read_b64_tr_b16 v[178:179], v216 offset:9984
    buffer_load_dwordx4 v238, s[24:27], s99 offen offset:2048 lds
    v_mfma_f32_32x32x16_bf16 v[112:127], v[148:151], a[112:115], v[112:127]
    ds_read_b64_tr_b16 v[180:181], v216 offset:9248
    ds_read_b64_tr_b16 v[182:183], v216 offset:10016
    v_mfma_f32_32x32x16_bf16 v[128:143], v[152:155], a[112:115], v[128:143]
    ds_read_b64_tr_b16 v[184:185], v216 offset:9280
    ds_read_b64_tr_b16 v[186:187], v216 offset:10048
    s_waitcnt lgkmcnt(6)
    v_mfma_f32_32x32x16_bf16 v[96:111], v[160:163], a[116:119], v[96:111]
    ds_read_b64_tr_b16 v[144:145], v216 offset:10752
    ds_read_b64_tr_b16 v[146:147], v216 offset:11520
    buffer_load_dwordx4 v239, s[24:27], s99 offen offset:3072 lds
    v_mfma_f32_32x32x16_bf16 v[112:127], v[164:167], a[116:119], v[112:127]
    ds_read_b64_tr_b16 v[148:149], v216 offset:10784
    ds_read_b64_tr_b16 v[150:151], v216 offset:11552
    v_mfma_f32_32x32x16_bf16 v[128:143], v[168:171], a[116:119], v[128:143]
    ds_read_b64_tr_b16 v[152:153], v216 offset:10816
    ds_read_b64_tr_b16 v[154:155], v216 offset:11584
    s_barrier
    s_waitcnt lgkmcnt(6)
    v_mfma_f32_32x32x16_bf16 v[96:111], v[176:179], a[120:123], v[96:111]
    s_add_u32 s99, s68, 393216
    s_add_u32 m0, s5, 32768
    s_nop 0
    buffer_load_dwordx4 v236, s[24:27], s99 offen offset:0 lds
    v_mfma_f32_32x32x16_bf16 v[112:127], v[180:183], a[120:123], v[112:127]
    v_mfma_f32_32x32x16_bf16 v[128:143], v[184:187], a[120:123], v[128:143]
    s_waitcnt lgkmcnt(0)
    v_mfma_f32_32x32x16_bf16 v[96:111], v[144:147], a[124:127], v[96:111]
    buffer_load_dwordx4 v237, s[24:27], s99 offen offset:1024 lds
    v_mfma_f32_32x32x16_bf16 v[112:127], v[148:151], a[124:127], v[112:127]
    v_mfma_f32_32x32x16_bf16 v[128:143], v[152:155], a[124:127], v[128:143]
    v_mfma_f32_32x32x16_bf16 v[96:111], a[208:211], v[204:207], v[96:111]
    v_mfma_f32_32x32x16_bf16 v[112:127], a[212:215], v[204:207], v[112:127]
    v_mfma_f32_32x32x16_bf16 v[128:143], a[216:219], v[204:207], v[128:143]
    s_waitcnt lgkmcnt(0)
    s_barrier
    s_add_u32 s3, s70, 76
    s_buffer_load_dword s4, s[32:35], s3 glc
    s_nop 5
    v_pk_mul_f32 v[228:229], v[96:97], v[208:209] op_sel_hi:[1,0]
    v_pk_mul_f32 v[230:231], v[98:99], v[208:209] op_sel_hi:[1,0]
    v_pk_mul_f32 v[232:233], v[100:101], v[208:209] op_sel_hi:[1,0]
    v_pk_mul_f32 v[234:235], v[102:103], v[208:209] op_sel_hi:[1,0]
    buffer_load_dwordx4 v238, s[24:27], s99 offen offset:2048 lds
    v_exp_f32 v228, v228
    v_exp_f32 v229, v229
    v_exp_f32 v230, v230
    v_exp_f32 v231, v231
    v_exp_f32 v232, v232
    v_exp_f32 v233, v233
    v_exp_f32 v234, v234
    v_exp_f32 v235, v235
    buffer_load_dwordx4 v239, s[24:27], s99 offen offset:3072 lds
    v_pk_mul_f32 v[96:97], v[96:97], v[104:105]
    v_pk_mul_f32 v[98:99], v[98:99], v[106:107]
    v_pk_mul_f32 v[100:101], v[100:101], v[108:109]
    v_pk_mul_f32 v[102:103], v[102:103], v[110:111]
    v_pk_fma_f32 v[228:229], v[228:229], v[208:209], v[208:209] op_sel:[0,1,1] op_sel_hi:[1,1,1]
    v_pk_fma_f32 v[230:231], v[230:231], v[208:209], v[208:209] op_sel:[0,1,1] op_sel_hi:[1,1,1]
    v_pk_fma_f32 v[232:233], v[232:233], v[208:209], v[208:209] op_sel:[0,1,1] op_sel_hi:[1,1,1]
    v_pk_fma_f32 v[234:235], v[234:235], v[208:209], v[208:209] op_sel:[0,1,1] op_sel_hi:[1,1,1]
    s_add_u32 s99, s68, 425984
    s_add_u32 m0, s5, 36864
    s_nop 0
    buffer_load_dwordx4 v236, s[24:27], s99 offen offset:0 lds
    v_rcp_f32 v228, v228
    v_rcp_f32 v229, v229
    v_rcp_f32 v230, v230
    v_rcp_f32 v231, v231
    v_rcp_f32 v232, v232
    v_rcp_f32 v233, v233
    v_rcp_f32 v234, v234
    v_rcp_f32 v235, v235
    buffer_load_dwordx4 v237, s[24:27], s99 offen offset:1024 lds
    v_pk_mul_f32 v[96:97], v[96:97], v[228:229]
    v_pk_mul_f32 v[98:99], v[98:99], v[230:231]
    v_pk_mul_f32 v[100:101], v[100:101], v[232:233]
    v_pk_mul_f32 v[102:103], v[102:103], v[234:235]
    v_cvt_pk_bf16_f32 v220, v96, v97
    v_cvt_pk_bf16_f32 v221, v98, v99
    v_cvt_pk_bf16_f32 v222, v100, v101
    v_cvt_pk_bf16_f32 v223, v102, v103
    buffer_load_dwordx4 v238, s[24:27], s99 offen offset:2048 lds
    buffer_store_dwordx4 v[220:223], v4, s[32:35], s89 offen offset:0 sc1
    v_pk_mul_f32 v[228:229], v[112:113], v[208:209] op_sel_hi:[1,0]
    v_pk_mul_f32 v[230:231], v[114:115], v[208:209] op_sel_hi:[1,0]
    v_pk_mul_f32 v[232:233], v[116:117], v[208:209] op_sel_hi:[1,0]
    v_pk_mul_f32 v[234:235], v[118:119], v[208:209] op_sel_hi:[1,0]
    buffer_load_dwordx4 v239, s[24:27], s99 offen offset:3072 lds
    v_exp_f32 v228, v228
    v_exp_f32 v229, v229
    v_exp_f32 v230, v230
    v_exp_f32 v231, v231
    v_exp_f32 v232, v232
    v_exp_f32 v233, v233
    v_exp_f32 v234, v234
    v_exp_f32 v235, v235
    s_add_u32 s99, s49, 0
    s_add_u32 m0, s5, 65536
    s_nop 0
    buffer_load_dwordx4 v236, s[24:27], s99 offen offset:0 lds
    v_pk_mul_f32 v[112:113], v[112:113], v[120:121]
    v_pk_mul_f32 v[114:115], v[114:115], v[122:123]
    v_pk_mul_f32 v[116:117], v[116:117], v[124:125]
    v_pk_mul_f32 v[118:119], v[118:119], v[126:127]
    v_pk_fma_f32 v[228:229], v[228:229], v[208:209], v[208:209] op_sel:[0,1,1] op_sel_hi:[1,1,1]
    v_pk_fma_f32 v[230:231], v[230:231], v[208:209], v[208:209] op_sel:[0,1,1] op_sel_hi:[1,1,1]
    v_pk_fma_f32 v[232:233], v[232:233], v[208:209], v[208:209] op_sel:[0,1,1] op_sel_hi:[1,1,1]
    v_pk_fma_f32 v[234:235], v[234:235], v[208:209], v[208:209] op_sel:[0,1,1] op_sel_hi:[1,1,1]
    buffer_load_dwordx4 v237, s[24:27], s99 offen offset:1024 lds
    v_rcp_f32 v228, v228
    v_rcp_f32 v229, v229
    v_rcp_f32 v230, v230
    v_rcp_f32 v231, v231
    v_rcp_f32 v232, v232
    v_rcp_f32 v233, v233
    v_rcp_f32 v234, v234
    v_rcp_f32 v235, v235
    buffer_load_dwordx4 v238, s[24:27], s99 offen offset:2048 lds
    v_pk_mul_f32 v[112:113], v[112:113], v[228:229]
    v_pk_mul_f32 v[114:115], v[114:115], v[230:231]
    v_pk_mul_f32 v[116:117], v[116:117], v[232:233]
    v_pk_mul_f32 v[118:119], v[118:119], v[234:235]
    v_cvt_pk_bf16_f32 v224, v112, v113
    v_cvt_pk_bf16_f32 v225, v114, v115
    v_cvt_pk_bf16_f32 v226, v116, v117
    v_cvt_pk_bf16_f32 v227, v118, v119
    buffer_load_dwordx4 v239, s[24:27], s99 offen offset:3072 lds
    buffer_store_dwordx4 v[224:227], v4, s[32:35], s89 offen offset:1024 sc1
    v_pk_mul_f32 v[228:229], v[128:129], v[208:209] op_sel_hi:[1,0]
    v_pk_mul_f32 v[230:231], v[130:131], v[208:209] op_sel_hi:[1,0]
    v_pk_mul_f32 v[232:233], v[132:133], v[208:209] op_sel_hi:[1,0]
    v_pk_mul_f32 v[234:235], v[134:135], v[208:209] op_sel_hi:[1,0]
    s_add_u32 s99, s49, 32768
    s_add_u32 m0, s5, 69632
    s_nop 0
    buffer_load_dwordx4 v236, s[24:27], s99 offen offset:0 lds
    v_exp_f32 v228, v228
    v_exp_f32 v229, v229
    v_exp_f32 v230, v230
    v_exp_f32 v231, v231
    v_exp_f32 v232, v232
    v_exp_f32 v233, v233
    v_exp_f32 v234, v234
    v_exp_f32 v235, v235
    buffer_load_dwordx4 v237, s[24:27], s99 offen offset:1024 lds
    v_pk_mul_f32 v[128:129], v[128:129], v[136:137]
    v_pk_mul_f32 v[130:131], v[130:131], v[138:139]
    v_pk_mul_f32 v[132:133], v[132:133], v[140:141]
    v_pk_mul_f32 v[134:135], v[134:135], v[142:143]
    v_pk_fma_f32 v[228:229], v[228:229], v[208:209], v[208:209] op_sel:[0,1,1] op_sel_hi:[1,1,1]
    v_pk_fma_f32 v[230:231], v[230:231], v[208:209], v[208:209] op_sel:[0,1,1] op_sel_hi:[1,1,1]
    v_pk_fma_f32 v[232:233], v[232:233], v[208:209], v[208:209] op_sel:[0,1,1] op_sel_hi:[1,1,1]
    v_pk_fma_f32 v[234:235], v[234:235], v[208:209], v[208:209] op_sel:[0,1,1] op_sel_hi:[1,1,1]
    buffer_load_dwordx4 v238, s[24:27], s99 offen offset:2048 lds
    v_rcp_f32 v228, v228
    v_rcp_f32 v229, v229
    v_rcp_f32 v230, v230
    v_rcp_f32 v231, v231
    v_rcp_f32 v232, v232
    v_rcp_f32 v233, v233
    v_rcp_f32 v234, v234
    v_rcp_f32 v235, v235
    buffer_load_dwordx4 v239, s[24:27], s99 offen offset:3072 lds
    v_pk_mul_f32 v[128:129], v[128:129], v[228:229]
    v_pk_mul_f32 v[130:131], v[130:131], v[230:231]
    v_pk_mul_f32 v[132:133], v[132:133], v[232:233]
    v_pk_mul_f32 v[134:135], v[134:135], v[234:235]
    v_cvt_pk_bf16_f32 v220, v128, v129
    v_cvt_pk_bf16_f32 v221, v130, v131
    v_cvt_pk_bf16_f32 v222, v132, v133
    v_cvt_pk_bf16_f32 v223, v134, v135
    buffer_store_dwordx4 v[220:223], v4, s[32:35], s89 offen offset:2048 sc1
    s_mul_i32 s90, s72, 114688
    s_add_u32 s90, s90, 25165824
    s_and_b32 s75, s44, 1
    s_mul_i32 s91, s75, 24576
    s_add_u32 s91, s91, s90
    s_add_u32 s91, s91, 65536
    s_lshl_b32 s75, s75, 15
    s_add_u32 s90, s90, s75
    s_and_b32 s75, s44, 1
    s_lshl_b32 s75, s75, 14
    v_add_u32 v112, s75, v14
    v_add_u32 v113, s75, v15
    v_add_u32 v114, s75, v14
    v_add_u32 v114, 65536, v114
    v_add_u32 v115, s75, v15
    v_add_u32 v115, 65536, v115
    v_add_u32 v116, s75, v14
    v_add_u32 v116, 131072, v116
    v_add_u32 v117, s75, v15
    v_add_u32 v117, 131072, v117
    s_waitcnt lgkmcnt(0)
    s_cmp_ge_u32 s4, 8
    s_cbranch_scc1 PD_152
    s_mov_b32 s60, 0
PL_151:
    s_buffer_load_dword s4, s[32:35], s3 glc
    s_add_u32 s60, s60, 1
    s_cmp_gt_u32 s60, 0x80000
    s_cbranch_scc1 L_bail
    s_waitcnt lgkmcnt(0)
    s_cmp_lt_u32 s4, 8
    s_cbranch_scc1 PL_151
PD_152:
    s_add_u32 s98, s90, 0
    buffer_load_dwordx4 a[0:3], v4, s[32:35], s98 offen offset:0 sc1
    s_add_u32 s98, s90, 0
    buffer_load_dwordx4 a[4:7], v4, s[32:35], s98 offen offset:1024 sc1
    s_add_u32 s98, s90, 0
    buffer_load_dwordx4 a[8:11], v4, s[32:35], s98 offen offset:2048 sc1
    s_add_u32 s98, s90, 0
    buffer_load_dwordx4 a[12:15], v4, s[32:35], s98 offen offset:3072 sc1
    s_waitcnt vmcnt(4)
    v_accvgpr_read_b32 v25, a235
    s_mov_b64 s[58:59], exec
    s_mov_b32 exec_lo, 255
    s_mov_b32 exec_hi, 0
    v_mov_b32 v24, 1
    buffer_atomic_add v24, v25, s[32:35], 0 offen offset:80 sc1
    s_mov_b64 exec, s[58:59]
    s_add_u32 s98, s90, 4096
    buffer_load_dwordx4 a[16:19], v4, s[32:35], s98 offen offset:0 sc1
    s_add_u32 s98, s90, 4096
    buffer_load_dwordx4 a[20:23], v4, s[32:35], s98 offen offset:1024 sc1
    s_add_u32 s98, s90, 4096
    buffer_load_dwordx4 a[24:27], v4, s[32:35], s98 offen offset:2048 sc1
    s_add_u32 s98, s90, 4096
    buffer_load_dwordx4 a[28:31], v4, s[32:35], s98 offen offset:3072 sc1
    s_add_u32 s98, s90, 8192
    buffer_load_dwordx4 a[32:35], v4, s[32:35], s98 offen offset:0 sc1
    s_add_u32 s98, s90, 8192
    buffer_load_dwordx4 a[36:39], v4, s[32:35], s98 offen offset:1024 sc1
    s_add_u32 s98, s90, 8192
    buffer_load_dwordx4 a[40:43], v4, s[32:35], s98 offen offset:2048 sc1
    s_add_u32 s98, s90, 8192
    buffer_load_dwordx4 a[44:47], v4, s[32:35], s98 offen offset:3072 sc1
    s_add_u32 s98, s90, 12288
    buffer_load_dwordx4 a[48:51], v4, s[32:35], s98 offen offset:0 sc1
    s_add_u32 s98, s90, 12288
    buffer_load_dwordx4 a[52:55], v4, s[32:35], s98 offen offset:1024 sc1
    s_lshr_b32 s76, s44, 1
    s_lshl_b32 s76, s76, 15
    s_add_u32 s76, s76, s75
    s_add_u32 s76, s76, 98304
    v_add_u32 v118, s76, v4
    s_barrier
    ds_read_b64_tr_b16 v[64:65], v114 offset:32768
    ds_read_b64_tr_b16 v[66:67], v114 offset:33792
    ds_read_b64_tr_b16 v[68:69], v115 offset:32768
    ds_read_b64_tr_b16 v[70:71], v115 offset:33792
    ds_read_b64_tr_b16 v[72:73], v114 offset:34816
    ds_read_b64_tr_b16 v[74:75], v114 offset:35840
    ds_read_b64_tr_b16 v[76:77], v115 offset:34816
    ds_read_b64_tr_b16 v[78:79], v115 offset:35840
    s_waitcnt vmcnt(14) lgkmcnt(6)
    v_mfma_f32_32x32x16_bf16 v[32:47], v[64:67], a[0:3], 0
    ds_read_b64_tr_b16 v[80:81], v114 offset:36864
    ds_read_b64_tr_b16 v[82:83], v114 offset:37888
    s_add_u32 s98, s90, 12288
    buffer_load_dwordx4 a[56:59], v4, s[32:35], s98 offen offset:2048 sc1
    s_waitcnt lgkmcnt(6)
    v_mfma_f32_32x32x16_bf16 v[48:63], v[68:71], a[0:3], 0
    ds_read_b64_tr_b16 v[84:85], v115 offset:36864
    ds_read_b64_tr_b16 v[86:87], v115 offset:37888
    s_waitcnt vmcnt(14) lgkmcnt(6)
    v_mfma_f32_32x32x16_bf16 v[32:47], v[72:75], a[4:7], v[32:47]
    ds_read_b64_tr_b16 v[64:65], v114 offset:38912
    ds_read_b64_tr_b16 v[66:67], v114 offset:39936
    s_add_u32 s98, s90, 12288
    buffer_load_dwordx4 a[60:63], v4, s[32:35], s98 offen offset:3072 sc1
    s_waitcnt lgkmcnt(6)
    v_mfma_f32_32x32x16_bf16 v[48:63], v[76:79], a[4:7], v[48:63]
    ds_read_b64_tr_b16 v[68:69], v115 offset:38912
    ds_read_b64_tr_b16 v[70:71], v115 offset:39936
    s_waitcnt vmcnt(14) lgkmcnt(6)
    v_mfma_f32_32x32x16_bf16 v[32:47], v[80:83], a[8:11], v[32:47]
    ds_read_b64_tr_b16 v[72:73], v114 offset:40960
    ds_read_b64_tr_b16 v[74:75], v114 offset:41984
    s_add_u32 s98, s90, 16384
    buffer_load_dwordx4 a[64:67], v4, s[32:35], s98 offen offset:0 sc1
    s_waitcnt lgkmcnt(6)
    v_mfma_f32_32x32x16_bf16 v[48:63], v[84:87], a[8:11], v[48:63]
    ds_read_b64_tr_b16 v[76:77], v115 offset:40960
    ds_read_b64_tr_b16 v[78:79], v115 offset:41984
    s_waitcnt vmcnt(14) lgkmcnt(6)
    v_mfma_f32_32x32x16_bf16 v[32:47], v[64:67], a[12:15], v[32:47]
    ds_read_b64_tr_b16 v[80:81], v114 offset:43008
    ds_read_b64_tr_b16 v[82:83], v114 offset:44032
    s_add_u32 s98, s90, 16384
    buffer_load_dwordx4 a[68:71], v4, s[32:35], s98 offen offset:1024 sc1
    s_waitcnt lgkmcnt(6)
    v_mfma_f32_32x32x16_bf16 v[48:63], v[68:71], a[12:15], v[48:63]
    ds_read_b64_tr_b16 v[84:85], v115 offset:43008
    ds_read_b64_tr_b16 v[86:87], v115 offset:44032
    s_waitcnt vmcnt(13) lgkmcnt(6)
    v_mfma_f32_32x32x16_bf16 v[32:47], v[72:75], a[16:19], v[32:47]
    ds_read_b64_tr_b16 v[64:65], v114 offset:45056
    ds_read_b64_tr_b16 v[66:67], v114 offset:46080
    s_add_u32 s98, s90, 16384
    buffer_load_dwordx4 a[72:75], v4, s[32:35], s98 offen offset:2048 sc1
    s_waitcnt lgkmcnt(6)
    v_mfma_f32_32x32x16_bf16 v[48:63], v[76:79], a[16:19], v[48:63]
    ds_read_b64_tr_b16 v[68:69], v115 offset:45056
    ds_read_b64_tr_b16 v[70:71], v115 offset:46080
    s_waitcnt vmcnt(13) lgkmcnt(6)
    v_mfma_f32_32x32x16_bf16 v[32:47], v[80:83], a[20:23], v[32:47]
    ds_read_b64_tr_b16 v[72:73], v114 offset:47104
    ds_read_b64_tr_b16 v[74:75], v114 offset:48128
    s_add_u32 s98, s90, 16384
    buffer_load_dwordx4 a[76:79], v4, s[32:35], s98 offen offset:3072 sc1
    s_waitcnt lgkmcnt(6)
    v_mfma_f32_32x32x16_bf16 v[48:63], v[84:87], a[20:23], v[48:63]
    ds_read_b64_tr_b16 v[76:77], v115 offset:47104
    ds_read_b64_tr_b16 v[78:79], v115 offset:48128
    s_waitcnt vmcnt(13) lgkmcnt(6)
    v_mfma_f32_32x32x16_bf16 v[32:47], v[64:67], a[24:27], v[32:47]
    ds_read_b64_tr_b16 v[80:81], v116 offset:0
    ds_read_b64_tr_b16 v[82:83], v116 offset:1024
    s_add_u32 s98, s90, 20480
    buffer_load_dwordx4 a[80:83], v4, s[32:35], s98 offen offset:0 sc1
    s_waitcnt lgkmcnt(6)
    v_mfma_f32_32x32x16_bf16 v[48:63], v[68:71], a[24:27], v[48:63]
    ds_read_b64_tr_b16 v[84:85], v117 offset:0
    ds_read_b64_tr_b16 v[86:87], v117 offset:1024
    s_waitcnt vmcnt(13) lgkmcnt(6)
    v_mfma_f32_32x32x16_bf16 v[32:47], v[72:75], a[28:31], v[32:47]
    ds_read_b64_tr_b16 v[64:65], v116 offset:2048
    ds_read_b64_tr_b16 v[66:67], v116 offset:3072
    s_add_u32 s98, s90, 20480
    buffer_load_dwordx4 a[84:87], v4, s[32:35], s98 offen offset:1024 sc1
    s_waitcnt lgkmcnt(6)
    v_mfma_f32_32x32x16_bf16 v[48:63], v[76:79], a[28:31], v[48:63]
    ds_read_b64_tr_b16 v[68:69], v117 offset:2048
    ds_read_b64_tr_b16 v[70:71], v117 offset:3072
    s_waitcnt vmcnt(13) lgkmcnt(6)
    v_mfma_f32_32x32x16_bf16 v[32:47], v[80:83], a[32:35], v[32:47]
    ds_read_b64_tr_b16 v[72:73], v116 offset:4096
    ds_read_b64_tr_b16 v[74:75], v116 offset:5120
    s_add_u32 s98, s90, 20480
    buffer_load_dwordx4 a[88:91], v4, s[32:35], s98 offen offset:2048 sc1
    s_waitcnt lgkmcnt(6)
    v_mfma_f32_32x32x16_bf16 v[48:63], v[84:87], a[32:35], v[48:63]
    ds_read_b64_tr_b16 v[76:77], v117 offset:4096
    ds_read_b64_tr_b16 v[78:79], v117 offset:5120
    s_waitcnt vmcnt(13) lgkmcnt(6)
    v_mfma_f32_32x32x16_bf16 v[32:47], v[64:67], a[36:39], v[32:47]
    ds_read_b64_tr_b16 v[80:81], v116 offset:6144
    ds_read_b64_tr_b16 v[82:83], v116 offset:7168
    s_add_u32 s98, s90, 20480
    buffer_load_dwordx4 a[92:95], v4, s[32:35], s98 offen offset:3072 sc1
    s_waitcnt lgkmcnt(6)
    v_mfma_f32_32x32x16_bf16 v[48:63], v[68:71], a[36:39], v[48:63]
    ds_read_b64_tr_b16 v[84:85], v117 offset:6144
    ds_read_b64_tr_b16 v[86:87], v117 offset:7168
    s_waitcnt vmcnt(13) lgkmcnt(6)
    v_mfma_f32_32x32x16_bf16 v[32:47], v[72:75], a[40:43], v[32:47]
    ds_read_b64_tr_b16 v[64:65], v116 offset:8192
    ds_read_b64_tr_b16 v[66:67], v116 offset:9216
    s_add_u32 s98, s90, 24576
    buffer_load_dwordx4 a[96:99], v4, s[32:35], s98 offen offset:0 sc1
    s_waitcnt lgkmcnt(6)
    v_mfma_f32_32x32x16_bf16 v[48:63], v[76:79], a[40:43], v[48:63]
    ds_read_b64_tr_b16 v[68:69], v117 offset:8192
    ds_read_b64_tr_b16 v[70:71], v117 offset:9216
    s_waitcnt vmcnt(13) lgkmcnt(6)
    v_mfma_f32_32x32x16_bf16 v[32:47], v[80:83], a[44:47], v[32:47]
    ds_read_b64_tr_b16 v[72:73], v116 offset:10240
    ds_read_b64_tr_b16 v[74:75], v116 offset:11264
    s_add_u32 s98, s90, 24576
    buffer_load_dwordx4 a[100:103], v4, s[32:35], s98 offen offset:1024 sc1
    s_waitcnt lgkmcnt(6)
    v_mfma_f32_32x32x16_bf16 v[48:63], v[84:87], a[44:47], v[48:63]
    ds_read_b64_tr_b16 v[76:77], v117 offset:10240
    ds_read_b64_tr_b16 v[78:79], v117 offset:11264
    s_waitcnt vmcnt(13) lgkmcnt(6)
    v_mfma_f32_32x32x16_bf16 v[32:47], v[64:67], a[48:51], v[32:47]
    ds_read_b64_tr_b16 v[80:81], v116 offset:12288
    ds_read_b64_tr_b16 v[82:83], v116 offset:13312
    s_add_u32 s98, s90, 24576
    buffer_load_dwordx4 a[104:107], v4, s[32:35], s98 offen offset:2048 sc1
    s_waitcnt lgkmcnt(6)
    v_mfma_f32_32x32x16_bf16 v[48:63], v[68:71], a[48:51], v[48:63]
    ds_read_b64_tr_b16 v[84:85], v117 offset:12288
    ds_read_b64_tr_b16 v[86:87], v117 offset:13312
    s_waitcnt vmcnt(13) lgkmcnt(6)
    v_mfma_f32_32x32x16_bf16 v[32:47], v[72:75], a[52:55], v[32:47]
    ds_read_b64_tr_b16 v[64:65], v116 offset:14336
    ds_read_b64_tr_b16 v[66:67], v116 offset:15360
    s_add_u32 s98, s90, 24576
    buffer_load_dwordx4 a[108:111], v4, s[32:35], s98 offen offset:3072 sc1
    s_waitcnt lgkmcnt(6)
    v_mfma_f32_32x32x16_bf16 v[48:63], v[76:79], a[52:55], v[48:63]
    ds_read_b64_tr_b16 v[68:69], v117 offset:14336
    ds_read_b64_tr_b16 v[70:71], v117 offset:15360
    s_waitcnt vmcnt(13) lgkmcnt(6)
    v_mfma_f32_32x32x16_bf16 v[32:47], v[80:83], a[56:59], v[32:47]
    ds_read_b64_tr_b16 v[72:73], v112 offset:0
    ds_read_b64_tr_b16 v[74:75], v112 offset:1024
    s_add_u32 s98, s90, 28672
    buffer_load_dwordx4 a[112:115], v4, s[32:35], s98 offen offset:0 sc1
    s_waitcnt lgkmcnt(6)
    v_mfma_f32_32x32x16_bf16 v[48:63], v[84:87], a[56:59], v[48:63]
    ds_read_b64_tr_b16 v[76:77], v113 offset:0
    ds_read_b64_tr_b16 v[78:79], v113 offset:1024
    s_mov_b64 s[58:59], exec
    s_mov_b64 exec, 1
    v_mov_b32 v120, 0
    v_mov_b32 v23, s70
    buffer_atomic_add v120, v23, s[32:35], 0 offen offset:80 sc0 sc1
    s_mov_b64 exec, s[58:59]
    s_waitcnt vmcnt(14) lgkmcnt(6)
    v_mfma_f32_32x32x16_bf16 v[32:47], v[64:67], a[60:63], v[32:47]
    ds_read_b64_tr_b16 v[80:81], v112 offset:2048
    ds_read_b64_tr_b16 v[82:83], v112 offset:3072
    s_add_u32 s98, s90, 28672
    buffer_load_dwordx4 a[116:119], v4, s[32:35], s98 offen offset:1024 sc1
    s_waitcnt lgkmcnt(6)
    v_mfma_f32_32x32x16_bf16 v[48:63], v[68:71], a[60:63], v[48:63]
    ds_read_b64_tr_b16 v[84:85], v113 offset:2048
    ds_read_b64_tr_b16 v[86:87], v113 offset:3072
    s_barrier
    s_cmp_lg_u32 s44, 0
    s_cbranch_scc1 LW_153
    ds_write_b128 v118, a[128:131] offset:0
    ds_write_b128 v118, a[132:135] offset:1024
    ds_write_b128 v118, a[136:139] offset:2048
    ds_write_b128 v118, a[140:143] offset:3072
LW_153:
    s_waitcnt vmcnt(14) lgkmcnt(6)
    v_mfma_f32_32x32x16_bf16 v[32:47], v[72:75], a[64:67], v[32:47]
    ds_read_b64_tr_b16 v[64:65], v112 offset:4096
    ds_read_b64_tr_b16 v[66:67], v112 offset:5120
    s_add_u32 s98, s90, 28672
    buffer_load_dwordx4 a[120:123], v4, s[32:35], s98 offen offset:2048 sc1
    s_waitcnt lgkmcnt(6)
    v_mfma_f32_32x32x16_bf16 v[48:63], v[76:79], a[64:67], v[48:63]
    ds_read_b64_tr_b16 v[68:69], v113 offset:4096
    ds_read_b64_tr_b16 v[70:71], v113 offset:5120
    s_cmp_lg_u32 s44, 1
    s_cbranch_scc1 LW_154
    ds_write_b128 v118, a[128:131] offset:0
    ds_write_b128 v118, a[132:135] offset:1024
    ds_write_b128 v118, a[136:139] offset:2048
    ds_write_b128 v118, a[140:143] offset:3072
LW_154:
    s_waitcnt vmcnt(14) lgkmcnt(6)
    v_mfma_f32_32x32x16_bf16 v[32:47], v[80:83], a[68:71], v[32:47]
    ds_read_b64_tr_b16 v[72:73], v112 offset:6144
    ds_read_b64_tr_b16 v[74:75], v112 offset:7168
    s_add_u32 s98, s90, 28672
    buffer_load_dwordx4 a[124:127], v4, s[32:35], s98 offen offset:3072 sc1
    s_waitcnt lgkmcnt(6)
    v_mfma_f32_32x32x16_bf16 v[48:63], v[84:87], a[68:71], v[48:63]
    ds_read_b64_tr_b16 v[76:77], v113 offset:6144
    ds_read_b64_tr_b16 v[78:79], v113 offset:7168
    s_cmp_lg_u32 s44, 2
    s_cbranch_scc1 LW_155
    ds_write_b128 v118, a[128:131] offset:0
    ds_write_b128 v118, a[132:135] offset:1024
    ds_write_b128 v118, a[136:139] offset:2048
    ds_write_b128 v118, a[140:143] offset:3072
LW_155:
    s_waitcnt vmcnt(14) lgkmcnt(6)
    v_mfma_f32_32x32x16_bf16 v[32:47], v[64:67], a[72:75], v[32:47]
    ds_read_b64_tr_b16 v[80:81], v112 offset:8192
    ds_read_b64_tr_b16 v[82:83], v112 offset:9216
    s_waitcnt lgkmcnt(6)
    v_mfma_f32_32x32x16_bf16 v[48:63], v[68:71], a[72:75], v[48:63]
    ds_read_b64_tr_b16 v[84:85], v113 offset:8192
    ds_read_b64_tr_b16 v[86:87], v113 offset:9216
    s_cmp_lg_u32 s44, 3
    s_cbranch_scc1 LW_156
    ds_write_b128 v118, a[128:131] offset:0
    ds_write_b128 v118, a[132:135] offset:1024
    ds_write_b128 v118, a[136:139] offset:2048
    ds_write_b128 v118, a[140:143] offset:3072
LW_156:
    s_waitcnt vmcnt(3)
    v_readfirstlane_b32 s4, v120
    s_nop 1
    s_cmp_ge_u32 s4, 8
    s_cbranch_scc1 PD_158
    s_add_u32 s3, s70, 80
    s_mov_b32 s60, 0
PL_157:
    s_buffer_load_dword s4, s[32:35], s3 glc
    s_add_u32 s60, s60, 1
    s_cmp_gt_u32 s60, 0x80000
    s_cbranch_scc1 L_bail
    s_waitcnt lgkmcnt(0)
    s_cmp_lt_u32 s4, 8
    s_cbranch_scc1 PL_157
PD_158:
    s_waitcnt lgkmcnt(6)
    v_mfma_f32_32x32x16_bf16 v[32:47], v[72:75], a[76:79], v[32:47]
    ds_read_b64_tr_b16 v[64:65], v112 offset:10240
    ds_read_b64_tr_b16 v[66:67], v112 offset:11264
    s_add_u32 s98, s91, 0
    buffer_load_dwordx4 a[0:3], v4, s[32:35], s98 offen offset:0 sc1
    s_waitcnt lgkmcnt(6)
    v_mfma_f32_32x32x16_bf16 v[48:63], v[76:79], a[76:79], v[48:63]
    ds_read_b64_tr_b16 v[68:69], v113 offset:10240
    ds_read_b64_tr_b16 v[70:71], v113 offset:11264
    s_cmp_lg_u32 s44, 0
    s_cbranch_scc1 LW_159
    ds_write_b128 v118, a[144:147] offset:4096
    ds_write_b128 v118, a[148:151] offset:5120
    ds_write_b128 v118, a[152:155] offset:6144
    ds_write_b128 v118, a[156:159] offset:7168
LW_159:
    s_waitcnt lgkmcnt(6)
    v_mfma_f32_32x32x16_bf16 v[32:47], v[80:83], a[80:83], v[32:47]
    ds_read_b64_tr_b16 v[72:73], v112 offset:12288
    ds_read_b64_tr_b16 v[74:75], v112 offset:13312
    s_add_u32 s98, s91, 0
    buffer_load_dwordx4 a[4:7], v4, s[32:35], s98 offen offset:1024 sc1
    s_waitcnt lgkmcnt(6)
    v_mfma_f32_32x32x16_bf16 v[48:63], v[84:87], a[80:83], v[48:63]
    ds_read_b64_tr_b16 v[76:77], v113 offset:12288
    ds_read_b64_tr_b16 v[78:79], v113 offset:13312
    s_cmp_lg_u32 s44, 1
    s_cbranch_scc1 LW_160
    ds_write_b128 v118, a[144:147] offset:4096
    ds_write_b128 v118, a[148:151] offset:5120
    ds_write_b128 v118, a[152:155] offset:6144
    ds_write_b128 v118, a[156:159] offset:7168
LW_160:
    s_waitcnt lgkmcnt(6)
    v_mfma_f32_32x32x16_bf16 v[32:47], v[64:67], a[84:87], v[32:47]
    ds_read_b64_tr_b16 v[80:81], v112 offset:14336
    ds_read_b64_tr_b16 v[82:83], v112 offset:15360
    s_add_u32 s98, s91, 0
    buffer_load_dwordx4 a[8:11], v4, s[32:35], s98 offen offset:2048 sc1
    s_waitcnt lgkmcnt(6)
    v_mfma_f32_32x32x16_bf16 v[48:63], v[68:71], a[84:87], v[48:63]
    ds_read_b64_tr_b16 v[84:85], v113 offset:14336
    ds_read_b64_tr_b16 v[86:87], v113 offset:15360
    s_cmp_lg_u32 s44, 2
    s_cbranch_scc1 LW_161
    ds_write_b128 v118, a[144:147] offset:4096
    ds_write_b128 v118, a[148:151] offset:5120
    ds_write_b128 v118, a[152:155] offset:6144
    ds_write_b128 v118, a[156:159] offset:7168
LW_161:
    s_waitcnt lgkmcnt(6)
    v_mfma_f32_32x32x16_bf16 v[32:47], v[72:75], a[88:91], v[32:47]
    ds_read_b64_tr_b16 v[64:65], v112 offset:32768
    ds_read_b64_tr_b16 v[66:67], v112 offset:33792
    s_add_u32 s98, s91, 0
    buffer_load_dwordx4 a[12:15], v4, s[32:35], s98 offen offset:3072 sc1
    s_waitcnt lgkmcnt(6)
    v_mfma_f32_32x32x16_bf16 v[48:63], v[76:79], a[88:91], v[48:63]
    ds_read_b64_tr_b16 v[68:69], v113 offset:32768
    ds_read_b64_tr_b16 v[70:71], v113 offset:33792
    s_cmp_lg_u32 s44, 3
    s_cbranch_scc1 LW_162
    ds_write_b128 v118, a[144:147] offset:4096
    ds_write_b128 v118, a[148:151] offset:5120
    ds_write_b128 v118, a[152:155] offset:6144
    ds_write_b128 v118, a[156:159] offset:7168
LW_162:
    s_waitcnt lgkmcnt(6)
    v_mfma_f32_32x32x16_bf16 v[32:47], v[80:83], a[92:95], v[32:47]
    ds_read_b64_tr_b16 v[72:73], v112 offset:34816
    ds_read_b64_tr_b16 v[74:75], v112 offset:35840
    s_add_u32 s98, s91, 4096
    buffer_load_dwordx4 a[16:19], v4, s[32:35], s98 offen offset:0 sc1
    s_waitcnt lgkmcnt(6)
    v_mfma_f32_32x32x16_bf16 v[48:63], v[84:87], a[92:95], v[48:63]
    ds_read_b64_tr_b16 v[76:77], v113 offset:34816
    ds_read_b64_tr_b16 v[78:79], v113 offset:35840
    s_cmp_lg_u32 s44, 0
    s_cbranch_scc1 LW_163
    ds_write_b128 v118, a[160:163] offset:8192
    ds_write_b128 v118, a[164:167] offset:9216
    ds_write_b128 v118, a[168:171] offset:10240
    ds_write_b128 v118, a[172:175] offset:11264
LW_163:
    s_waitcnt lgkmcnt(6)
    v_mfma_f32_32x32x16_bf16 v[32:47], v[64:67], a[96:99], v[32:47]
    ds_read_b64_tr_b16 v[80:81], v112 offset:36864
    ds_read_b64_tr_b16 v[82:83], v112 offset:37888
    s_add_u32 s98, s91, 4096
    buffer_load_dwordx4 a[20:23], v4, s[32:35], s98 offen offset:1024 sc1
    s_waitcnt lgkmcnt(6)
    v_mfma_f32_32x32x16_bf16 v[48:63], v[68:71], a[96:99], v[48:63]
    ds_read_b64_tr_b16 v[84:85], v113 offset:36864
    ds_read_b64_tr_b16 v[86:87], v113 offset:37888
    s_cmp_lg_u32 s44, 1
    s_cbranch_scc1 LW_164
    ds_write_b128 v118, a[160:163] offset:8192
    ds_write_b128 v118, a[164:167] offset:9216
    ds_write_b128 v118, a[168:171] offset:10240
    ds_write_b128 v118, a[172:175] offset:11264
LW_164:
    s_waitcnt lgkmcnt(6)
    v_mfma_f32_32x32x16_bf16 v[32:47], v[72:75], a[100:103], v[32:47]
    ds_read_b64_tr_b16 v[64:65], v112 offset:38912
    ds_read_b64_tr_b16 v[66:67], v112 offset:39936
    s_add_u32 s98, s91, 4096
    buffer_load_dwordx4 a[24:27], v4, s[32:35], s98 offen offset:2048 sc1
    s_waitcnt lgkmcnt(6)
    v_mfma_f32_32x32x16_bf16 v[48:63], v[76:79], a[100:103], v[48:63]
    ds_read_b64_tr_b16 v[68:69], v113 offset:38912
    ds_read_b64_tr_b16 v[70:71], v113 offset:39936
    s_cmp_lg_u32 s44, 2
    s_cbranch_scc1 LW_165
    ds_write_b128 v118, a[160:163] offset:8192
    ds_write_b128 v118, a[164:167] offset:9216
    ds_write_b128 v118, a[168:171] offset:10240
    ds_write_b128 v118, a[172:175] offset:11264
LW_165:
    s_waitcnt lgkmcnt(6)
    v_mfma_f32_32x32x16_bf16 v[32:47], v[80:83], a[104:107], v[32:47]
    ds_read_b64_tr_b16 v[72:73], v112 offset:40960
    ds_read_b64_tr_b16 v[74:75], v112 offset:41984
    s_add_u32 s98, s91, 4096
    buffer_load_dwordx4 a[28:31], v4, s[32:35], s98 offen offset:3072 sc1
    s_waitcnt lgkmcnt(6)
    v_mfma_f32_32x32x16_bf16 v[48:63], v[84:87], a[104:107], v[48:63]
    ds_read_b64_tr_b16 v[76:77], v113 offset:40960
    ds_read_b64_tr_b16 v[78:79], v113 offset:41984
    s_cmp_lg_u32 s44, 3
    s_cbranch_scc1 LW_166
    ds_write_b128 v118, a[160:163] offset:8192
    ds_write_b128 v118, a[164:167] offset:9216
    ds_write_b128 v118, a[168:171] offset:10240
    ds_write_b128 v118, a[172:175] offset:11264
LW_166:
    s_waitcnt lgkmcnt(6)
    v_mfma_f32_32x32x16_bf16 v[32:47], v[64:67], a[108:111], v[32:47]
    ds_read_b64_tr_b16 v[80:81], v112 offset:43008
    ds_read_b64_tr_b16 v[82:83], v112 offset:44032
    s_add_u32 s98, s91, 8192
    buffer_load_dwordx4 a[32:35], v4, s[32:35], s98 offen offset:0 sc1
    s_waitcnt lgkmcnt(6)
    v_mfma_f32_32x32x16_bf16 v[48:63], v[68:71], a[108:111], v[48:63]
    ds_read_b64_tr_b16 v[84:85], v113 offset:43008
    ds_read_b64_tr_b16 v[86:87], v113 offset:44032
    s_cmp_lg_u32 s44, 0
    s_cbranch_scc1 LW_167
    ds_write_b128 v118, a[176:179] offset:12288
    ds_write_b128 v118, a[180:183] offset:13312
    ds_write_b128 v118, a[184:187] offset:14336
    ds_write_b128 v118, a[188:191] offset:15360
LW_167:
    s_waitcnt lgkmcnt(6)
    v_mfma_f32_32x32x16_bf16 v[32:47], v[72:75], a[112:115], v[32:47]
    ds_read_b64_tr_b16 v[64:65], v112 offset:45056
    ds_read_b64_tr_b16 v[66:67], v112 offset:46080
    s_add_u32 s98, s91, 8192
    buffer_load_dwordx4 a[36:39], v4, s[32:35], s98 offen offset:1024 sc1
    s_waitcnt lgkmcnt(6)
    v_mfma_f32_32x32x16_bf16 v[48:63], v[76:79], a[112:115], v[48:63]
    ds_read_b64_tr_b16 v[68:69], v113 offset:45056
    ds_read_b64_tr_b16 v[70:71], v113 offset:46080
    s_cmp_lg_u32 s44, 1
    s_cbranch_scc1 LW_168
    ds_write_b128 v118, a[176:179] offset:12288
    ds_write_b128 v118, a[180:183] offset:13312
    ds_write_b128 v118, a[184:187] offset:14336
    ds_write_b128 v118, a[188:191] offset:15360
LW_168:
    s_waitcnt vmcnt(12) lgkmcnt(6)
    v_mfma_f32_32x32x16_bf16 v[32:47], v[80:83], a[116:119], v[32:47]
    ds_read_b64_tr_b16 v[72:73], v112 offset:47104
    ds_read_b64_tr_b16 v[74:75], v112 offset:48128
    s_add_u32 s98, s91, 8192
    buffer_load_dwordx4 a[40:43], v4, s[32:35], s98 offen offset:2048 sc1
    s_waitcnt lgkmcnt(6)
    v_mfma_f32_32x32x16_bf16 v[48:63], v[84:87], a[116:119], v[48:63]
    ds_read_b64_tr_b16 v[76:77], v113 offset:47104
    ds_read_b64_tr_b16 v[78:79], v113 offset:48128
    s_cmp_lg_u32 s44, 2
    s_cbranch_scc1 LW_169
    ds_write_b128 v118, a[176:179] offset:12288
    ds_write_b128 v118, a[180:183] offset:13312
    ds_write_b128 v118, a[184:187] offset:14336
    ds_write_b128 v118, a[188:191] offset:15360
LW_169:
    s_waitcnt vmcnt(12) lgkmcnt(6)
    v_mfma_f32_32x32x16_bf16 v[32:47], v[64:67], a[120:123], v[32:47]
    ds_read_b64_tr_b16 v[80:81], v114 offset:0
    ds_read_b64_tr_b16 v[82:83], v114 offset:1024
    s_add_u32 s98, s91, 8192
    buffer_load_dwordx4 a[44:47], v4, s[32:35], s98 offen offset:3072 sc1
    s_waitcnt lgkmcnt(6)
    v_mfma_f32_32x32x16_bf16 v[48:63], v[68:71], a[120:123], v[48:63]
    ds_read_b64_tr_b16 v[84:85], v115 offset:0
    ds_read_b64_tr_b16 v[86:87], v115 offset:1024
    s_cmp_lg_u32 s44, 3
    s_cbranch_scc1 LW_170
    ds_write_b128 v118, a[176:179] offset:12288
    ds_write_b128 v118, a[180:183] offset:13312
    ds_write_b128 v118, a[184:187] offset:14336
    ds_write_b128 v118, a[188:191] offset:15360
LW_170:
    s_waitcnt vmcnt(12) lgkmcnt(6)
    v_mfma_f32_32x32x16_bf16 v[32:47], v[72:75], a[124:127], v[32:47]
    ds_read_b64_tr_b16 v[64:65], v114 offset:2048
    ds_read_b64_tr_b16 v[66:67], v114 offset:3072
    s_add_u32 s98, s91, 12288
    buffer_load_dwordx4 a[48:51], v4, s[32:35], s98 offen offset:0 sc1
    s_waitcnt lgkmcnt(6)
    v_mfma_f32_32x32x16_bf16 v[48:63], v[76:79], a[124:127], v[48:63]
    ds_read_b64_tr_b16 v[68:69], v115 offset:2048
    ds_read_b64_tr_b16 v[70:71], v115 offset:3072
    s_waitcnt vmcnt(12) lgkmcnt(6)
    v_mfma_f32_32x32x16_bf16 v[32:47], v[80:83], a[0:3], v[32:47]
    ds_read_b64_tr_b16 v[72:73], v114 offset:4096
    ds_read_b64_tr_b16 v[74:75], v114 offset:5120
    s_add_u32 s98, s91, 12288
    buffer_load_dwordx4 a[52:55], v4, s[32:35], s98 offen offset:1024 sc1
    s_waitcnt lgkmcnt(6)
    v_mfma_f32_32x32x16_bf16 v[48:63], v[84:87], a[0:3], v[48:63]
    ds_read_b64_tr_b16 v[76:77], v115 offset:4096
    ds_read_b64_tr_b16 v[78:79], v115 offset:5120
    s_waitcnt vmcnt(12) lgkmcnt(6)
    v_mfma_f32_32x32x16_bf16 v[32:47], v[64:67], a[4:7], v[32:47]
    ds_read_b64_tr_b16 v[80:81], v114 offset:6144
    ds_read_b64_tr_b16 v[82:83], v114 offset:7168
    s_add_u32 s98, s91, 12288
    buffer_load_dwordx4 a[56:59], v4, s[32:35], s98 offen offset:2048 sc1
    s_waitcnt lgkmcnt(6)
    v_mfma_f32_32x32x16_bf16 v[48:63], v[68:71], a[4:7], v[48:63]
    ds_read_b64_tr_b16 v[84:85], v115 offset:6144
    ds_read_b64_tr_b16 v[86:87], v115 offset:7168
    s_waitcnt vmcnt(12) lgkmcnt(6)
    v_mfma_f32_32x32x16_bf16 v[32:47], v[72:75], a[8:11], v[32:47]
    ds_read_b64_tr_b16 v[64:65], v114 offset:8192
    ds_read_b64_tr_b16 v[66:67], v114 offset:9216
    s_add_u32 s98, s91, 12288
    buffer_load_dwordx4 a[60:63], v4, s[32:35], s98 offen offset:3072 sc1
    s_waitcnt lgkmcnt(6)
    v_mfma_f32_32x32x16_bf16 v[48:63], v[76:79], a[8:11], v[48:63]
    ds_read_b64_tr_b16 v[68:69], v115 offset:8192
    ds_read_b64_tr_b16 v[70:71], v115 offset:9216
    s_waitcnt vmcnt(12) lgkmcnt(6)
    v_mfma_f32_32x32x16_bf16 v[32:47], v[80:83], a[12:15], v[32:47]
    ds_read_b64_tr_b16 v[72:73], v114 offset:10240
    ds_read_b64_tr_b16 v[74:75], v114 offset:11264
    s_add_u32 s98, s91, 16384
    buffer_load_dwordx4 a[64:67], v4, s[32:35], s98 offen offset:0 sc1
    s_waitcnt lgkmcnt(6)
    v_mfma_f32_32x32x16_bf16 v[48:63], v[84:87], a[12:15], v[48:63]
    ds_read_b64_tr_b16 v[76:77], v115 offset:10240
    ds_read_b64_tr_b16 v[78:79], v115 offset:11264
    s_waitcnt vmcnt(12) lgkmcnt(6)
    v_mfma_f32_32x32x16_bf16 v[32:47], v[64:67], a[16:19], v[32:47]
    ds_read_b64_tr_b16 v[80:81], v114 offset:12288
    ds_read_b64_tr_b16 v[82:83], v114 offset:13312
    s_add_u32 s98, s91, 16384
    buffer_load_dwordx4 a[68:71], v4, s[32:35], s98 offen offset:1024 sc1
    s_waitcnt lgkmcnt(6)
    v_mfma_f32_32x32x16_bf16 v[48:63], v[68:71], a[16:19], v[48:63]
    ds_read_b64_tr_b16 v[84:85], v115 offset:12288
    ds_read_b64_tr_b16 v[86:87], v115 offset:13312
    s_waitcnt vmcnt(12) lgkmcnt(6)
    v_mfma_f32_32x32x16_bf16 v[32:47], v[72:75], a[20:23], v[32:47]
    ds_read_b64_tr_b16 v[64:65], v114 offset:14336
    ds_read_b64_tr_b16 v[66:67], v114 offset:15360
    s_add_u32 s98, s91, 16384
    buffer_load_dwordx4 a[72:75], v4, s[32:35], s98 offen offset:2048 sc1
    s_waitcnt lgkmcnt(6)
    v_mfma_f32_32x32x16_bf16 v[48:63], v[76:79], a[20:23], v[48:63]
    ds_read_b64_tr_b16 v[68:69], v115 offset:14336
    ds_read_b64_tr_b16 v[70:71], v115 offset:15360
    s_waitcnt lgkmcnt(0)
    s_barrier
    s_waitcnt vmcnt(12)
    v_mfma_f32_32x32x16_bf16 v[32:47], v[80:83], a[24:27], v[32:47]
    ds_read_b64_tr_b16 v[72:73], v114 offset:32768
    ds_read_b64_tr_b16 v[74:75], v114 offset:33792
    s_add_u32 s98, s91, 16384
    buffer_load_dwordx4 a[76:79], v4, s[32:35], s98 offen offset:3072 sc1
    v_mfma_f32_32x32x16_bf16 v[48:63], v[84:87], a[24:27], v[48:63]
    ds_read_b64_tr_b16 v[76:77], v115 offset:32768
    ds_read_b64_tr_b16 v[78:79], v115 offset:33792
    s_waitcnt vmcnt(12)
    v_mfma_f32_32x32x16_bf16 v[32:47], v[64:67], a[28:31], v[32:47]
    ds_read_b64_tr_b16 v[80:81], v114 offset:34816
    ds_read_b64_tr_b16 v[82:83], v114 offset:35840
    s_add_u32 s98, s91, 20480
    buffer_load_dwordx4 a[80:83], v4, s[32:35], s98 offen offset:0 sc1
    v_mfma_f32_32x32x16_bf16 v[48:63], v[68:71], a[28:31], v[48:63]
    ds_read_b64_tr_b16 v[84:85], v115 offset:34816
    ds_read_b64_tr_b16 v[86:87], v115 offset:35840
    s_waitcnt vmcnt(12) lgkmcnt(6)
    v_mfma_f32_32x32x16_bf16 v[32:47], v[72:75], a[32:35], v[32:47]
    ds_read_b64_tr_b16 v[64:65], v114 offset:36864
    ds_read_b64_tr_b16 v[66:67], v114 offset:37888
    s_add_u32 s98, s91, 20480
    buffer_load_dwordx4 a[84:87], v4, s[32:35], s98 offen offset:1024 sc1
    s_waitcnt lgkmcnt(6)
    v_mfma_f32_32x32x16_bf16 v[48:63], v[76:79], a[32:35], v[48:63]
    ds_read_b64_tr_b16 v[68:69], v115 offset:36864
    ds_read_b64_tr_b16 v[70:71], v115 offset:37888
    v_accvgpr_read_b32 v193, a240
    v_lshlrev_b32 v192, 16, v193
    s_waitcnt vmcnt(12) lgkmcnt(6)
    v_mfma_f32_32x32x16_bf16 v[32:47], v[80:83], a[36:39], v[32:47]
    ds_read_b64_tr_b16 v[72:73], v114 offset:38912
    ds_read_b64_tr_b16 v[74:75], v114 offset:39936
    s_add_u32 s98, s91, 20480
    buffer_load_dwordx4 a[88:91], v4, s[32:35], s98 offen offset:2048 sc1
    s_waitcnt lgkmcnt(6)
    v_mfma_f32_32x32x16_bf16 v[48:63], v[84:87], a[36:39], v[48:63]
    ds_read_b64_tr_b16 v[76:77], v115 offset:38912
    ds_read_b64_tr_b16 v[78:79], v115 offset:39936
    v_and_b32 v193, 0xffff0000, v193
    v_accvgpr_read_b32 v195, a241
    s_waitcnt vmcnt(12) lgkmcnt(6)
    v_mfma_f32_32x32x16_bf16 v[32:47], v[64:67], a[40:43], v[32:47]
    ds_read_b64_tr_b16 v[80:81], v114 offset:40960
    ds_read_b64_tr_b16 v[82:83], v114 offset:41984
    s_add_u32 s98, s91, 20480
    buffer_load_dwordx4 a[92:95], v4, s[32:35], s98 offen offset:3072 sc1
    s_waitcnt lgkmcnt(6)
    v_mfma_f32_32x32x16_bf16 v[48:63], v[68:71], a[40:43], v[48:63]
    ds_read_b64_tr_b16 v[84:85], v115 offset:40960
    ds_read_b64_tr_b16 v[86:87], v115 offset:41984
    v_lshlrev_b32 v194, 16, v195
    v_and_b32 v195, 0xffff0000, v195
    s_waitcnt vmcnt(12) lgkmcnt(6)
    v_mfma_f32_32x32x16_bf16 v[32:47], v[72:75], a[44:47], v[32:47]
    ds_read_b64_tr_b16 v[64:65], v114 offset:43008
    ds_read_b64_tr_b16 v[66:67], v114 offset:44032
    s_waitcnt lgkmcnt(6)
    v_mfma_f32_32x32x16_bf16 v[48:63], v[76:79], a[44:47], v[48:63]
    ds_read_b64_tr_b16 v[68:69], v115 offset:43008
    ds_read_b64_tr_b16 v[70:71], v115 offset:44032
    v_accvgpr_read_b32 v197, a242
    v_lshlrev_b32 v196, 16, v197
    s_waitcnt vmcnt(11) lgkmcnt(6)
    v_mfma_f32_32x32x16_bf16 v[32:47], v[80:83], a[48:51], v[32:47]
    ds_read_b64_tr_b16 v[72:73], v114 offset:45056
    ds_read_b64_tr_b16 v[74:75], v114 offset:46080
    s_waitcnt lgkmcnt(6)
    v_mfma_f32_32x32x16_bf16 v[48:63], v[84:87], a[48:51], v[48:63]
    ds_read_b64_tr_b16 v[76:77], v115 offset:45056
    ds_read_b64_tr_b16 v[78:79], v115 offset:46080
    v_and_b32 v197, 0xffff0000, v197
    v_accvgpr_read_b32 v199, a243
    s_waitcnt vmcnt(10) lgkmcnt(6)
    v_mfma_f32_32x32x16_bf16 v[32:47], v[64:67], a[52:55], v[32:47]
    ds_read_b64_tr_b16 v[80:81], v114 offset:47104
    ds_read_b64_tr_b16 v[82:83], v114 offset:48128
    s_waitcnt lgkmcnt(6)
    v_mfma_f32_32x32x16_bf16 v[48:63], v[68:71], a[52:55], v[48:63]
    ds_read_b64_tr_b16 v[84:85], v115 offset:47104
    ds_read_b64_tr_b16 v[86:87], v115 offset:48128
    v_lshlrev_b32 v198, 16, v199
    v_and_b32 v199, 0xffff0000, v199
    s_waitcnt vmcnt(9) lgkmcnt(6)
    v_mfma_f32_32x32x16_bf16 v[32:47], v[72:75], a[56:59], v[32:47]
    ds_read_b64_tr_b16 v[64:65], v116 offset:0
    ds_read_b64_tr_b16 v[66:67], v116 offset:1024
    s_waitcnt lgkmcnt(6)
    v_mfma_f32_32x32x16_bf16 v[48:63], v[76:79], a[56:59], v[48:63]
    ds_read_b64_tr_b16 v[68:69], v117 offset:0
    ds_read_b64_tr_b16 v[70:71], v117 offset:1024
    v_accvgpr_read_b32 v201, a244
    v_lshlrev_b32 v200, 16, v201
    s_waitcnt vmcnt(8) lgkmcnt(6)
    v_mfma_f32_32x32x16_bf16 v[32:47], v[80:83], a[60:63], v[32:47]
    ds_read_b64_tr_b16 v[72:73], v116 offset:2048
    ds_read_b64_tr_b16 v[74:75], v116 offset:3072
    s_waitcnt lgkmcnt(6)
    v_mfma_f32_32x32x16_bf16 v[48:63], v[84:87], a[60:63], v[48:63]
    ds_read_b64_tr_b16 v[76:77], v117 offset:2048
    ds_read_b64_tr_b16 v[78:79], v117 offset:3072
    v_and_b32 v201, 0xffff0000, v201
    v_accvgpr_read_b32 v203, a245
    s_waitcnt vmcnt(7) lgkmcnt(6)
    v_mfma_f32_32x32x16_bf16 v[32:47], v[64:67], a[64:67], v[32:47]
    ds_read_b64_tr_b16 v[80:81], v116 offset:4096
    ds_read_b64_tr_b16 v[82:83], v116 offset:5120
    s_waitcnt lgkmcnt(6)
    v_mfma_f32_32x32x16_bf16 v[48:63], v[68:71], a[64:67], v[48:63]
    ds_read_b64_tr_b16 v[84:85], v117 offset:4096
    ds_read_b64_tr_b16 v[86:87], v117 offset:5120
    v_lshlrev_b32 v202, 16, v203
    v_and_b32 v203, 0xffff0000, v203
    s_waitcnt vmcnt(6) lgkmcnt(6)
    v_mfma_f32_32x32x16_bf16 v[32:47], v[72:75], a[68:71], v[32:47]
    ds_read_b64_tr_b16 v[64:65], v116 offset:6144
    ds_read_b64_tr_b16 v[66:67], v116 offset:7168
    s_waitcnt lgkmcnt(6)
    v_mfma_f32_32x32x16_bf16 v[48:63], v[76:79], a[68:71], v[48:63]
    ds_read_b64_tr_b16 v[68:69], v117 offset:6144
    ds_read_b64_tr_b16 v[70:71], v117 offset:7168
    v_accvgpr_read_b32 v205, a246
    v_lshlrev_b32 v204, 16, v205
    s_waitcnt vmcnt(5) lgkmcnt(6)
    v_mfma_f32_32x32x16_bf16 v[32:47], v[80:83], a[72:75], v[32:47]
    ds_read_b64_tr_b16 v[72:73], v116 offset:8192
    ds_read_b64_tr_b16 v[74:75], v116 offset:9216
    s_waitcnt lgkmcnt(6)
    v_mfma_f32_32x32x16_bf16 v[48:63], v[84:87], a[72:75], v[48:63]
    ds_read_b64_tr_b16 v[76:77], v117 offset:8192
    ds_read_b64_tr_b16 v[78:79], v117 offset:9216
    v_and_b32 v205, 0xffff0000, v205
    v_accvgpr_read_b32 v207, a247
    s_waitcnt vmcnt(4) lgkmcnt(6)
    v_mfma_f32_32x32x16_bf16 v[32:47], v[64:67], a[76:79], v[32:47]
    ds_read_b64_tr_b16 v[80:81], v116 offset:10240
    ds_read_b64_tr_b16 v[82:83], v116 offset:11264
    s_waitcnt lgkmcnt(6)
    v_mfma_f32_32x32x16_bf16 v[48:63], v[68:71], a[76:79], v[48:63]
    ds_read_b64_tr_b16 v[84:85], v117 offset:10240
    ds_read_b64_tr_b16 v[86:87], v117 offset:11264
    v_lshlrev_b32 v206, 16, v207
    v_and_b32 v207, 0xffff0000, v207
    s_waitcnt vmcnt(3) lgkmcnt(6)
    v_mfma_f32_32x32x16_bf16 v[32:47], v[72:75], a[80:83], v[32:47]
    ds_read_b64_tr_b16 v[64:65], v116 offset:12288
    ds_read_b64_tr_b16 v[66:67], v116 offset:13312
    s_waitcnt lgkmcnt(6)
    v_mfma_f32_32x32x16_bf16 v[48:63], v[76:79], a[80:83], v[48:63]
    ds_read_b64_tr_b16 v[68:69], v117 offset:12288
    ds_read_b64_tr_b16 v[70:71], v117 offset:13312
    s_waitcnt vmcnt(2) lgkmcnt(6)
    v_mfma_f32_32x32x16_bf16 v[32:47], v[80:83], a[84:87], v[32:47]
    ds_read_b64_tr_b16 v[72:73], v116 offset:14336
    ds_read_b64_tr_b16 v[74:75], v116 offset:15360
    s_waitcnt lgkmcnt(6)
    v_mfma_f32_32x32x16_bf16 v[48:63], v[84:87], a[84:87], v[48:63]
    ds_read_b64_tr_b16 v[76:77], v117 offset:14336
    ds_read_b64_tr_b16 v[78:79], v117 offset:15360
    s_waitcnt vmcnt(1) lgkmcnt(6)
    v_mfma_f32_32x32x16_bf16 v[32:47], v[64:67], a[88:91], v[32:47]
    s_waitcnt lgkmcnt(4)
    v_mfma_f32_32x32x16_bf16 v[48:63], v[68:71], a[88:91], v[48:63]
    s_waitcnt vmcnt(0) lgkmcnt(2)
    v_mfma_f32_32x32x16_bf16 v[32:47], v[72:75], a[92:95], v[32:47]
    s_waitcnt lgkmcnt(0)
    v_mfma_f32_32x32x16_bf16 v[48:63], v[76:79], a[92:95], v[48:63]
    s_lshl_b32 s84, s44, 12
    s_xor_b32 s85, s84, 4096
    v_add_u32 v26, s84, v4
    v_add_u32 v27, s85, v4
    v_add_u32 v26, 65536, v26
    v_add_u32 v27, 65536, v27
    s_nop 5
    ds_write_b128 v26, v[48:51] offset:0
    ds_write_b128 v26, v[52:55] offset:1024
    ds_write_b128 v26, v[56:59] offset:2048
    ds_write_b128 v26, v[60:63] offset:3072
    s_waitcnt lgkmcnt(0)
    s_barrier
    ds_read_b128 v[128:131], v27 offset:0
    ds_read_b128 v[132:135], v27 offset:1024
    ds_read_b128 v[136:139], v27 offset:2048
    ds_read_b128 v[140:143], v27 offset:3072
    s_waitcnt lgkmcnt(3)
    v_pk_add_f32 v[32:33], v[32:33], v[128:129]
    v_pk_add_f32 v[34:35], v[34:35], v[130:131]
    s_waitcnt lgkmcnt(2)
    v_pk_add_f32 v[36:37], v[36:37], v[132:133]
    v_pk_add_f32 v[38:39], v[38:39], v[134:135]
    s_waitcnt lgkmcnt(1)
    v_pk_add_f32 v[40:41], v[40:41], v[136:137]
    v_pk_add_f32 v[42:43], v[42:43], v[138:139]
    s_waitcnt lgkmcnt(0)
    v_pk_add_f32 v[44:45], v[44:45], v[140:141]
    v_pk_add_f32 v[46:47], v[46:47], v[142:143]
    v_pk_add_f32 v[32:33], v[32:33], v[192:193]
    v_pk_add_f32 v[34:35], v[34:35], v[194:195]
    v_pk_add_f32 v[36:37], v[36:37], v[196:197]
    v_pk_add_f32 v[38:39], v[38:39], v[198:199]
    v_pk_add_f32 v[40:41], v[40:41], v[200:201]
    v_pk_add_f32 v[42:43], v[42:43], v[202:203]
    v_pk_add_f32 v[44:45], v[44:45], v[204:205]
    v_pk_add_f32 v[46:47], v[46:47], v[206:207]
    v_cvt_pk_bf16_f32 v160, v32, v33
    v_cvt_pk_bf16_f32 v161, v34, v35
    v_cvt_pk_bf16_f32 v162, v36, v37
    v_cvt_pk_bf16_f32 v163, v38, v39
    v_cvt_pk_bf16_f32 v164, v40, v41
    v_cvt_pk_bf16_f32 v165, v42, v43
    v_cvt_pk_bf16_f32 v166, v44, v45
    v_cvt_pk_bf16_f32 v167, v46, v47
    s_lshl_b32 s76, s72, 15
    s_lshl_b32 s77, s73, 6
    s_add_u32 s76, s76, s77
    v_lshlrev_b32 v168, 10, v2
    v_lshl_add_u32 v168, v3, 4, v168
    v_permlane32_swap_b32 v160, v162
    v_permlane32_swap_b32 v161, v163
    v_permlane32_swap_b32 v164, v166
    v_permlane32_swap_b32 v165, v167
    buffer_store_dwordx4 v[160:163], v168, s[28:31], s76 offen offset:0
    buffer_store_dwordx4 v[164:167], v168, s[28:31], s76 offen offset:32
    s_branch L_end
L_bail:
    s_mov_b64 exec, -1
    v_mov_b32 v23, 0
    v_mov_b32 v24, 0xdead
    buffer_store_dword v24, v23, s[36:39], 0 offen offset:192
    s_waitcnt vmcnt(0)
L_end:
    s_endpgm
L_code_end:
.section .rodata,"a"
.p2align 6
.amdhsa_kernel interleave_layers__linear_kernel_hedgehog__glu_gated_swiglu__prompt_kernel
  .amdhsa_next_free_vgpr 512
  .amdhsa_next_free_sgpr 102
  .amdhsa_accum_offset 256
  .amdhsa_group_segment_fixed_size 0
  .amdhsa_kernarg_size 88
  .amdhsa_user_sgpr_count 2
  .amdhsa_user_sgpr_kernarg_segment_ptr 1
  .amdhsa_system_sgpr_workgroup_id_x 1
.end_amdhsa_kernel
```
